```python
import torch

def _softmax(x, axis=-1):
    return torch.softmax(x, dim=axis)
def _gelu(x):
    return torch.nn.functional.gelu(x, approximate="tanh")
def _silu(x):
    return torch.nn.functional.silu(x)
def _sigmoid(x):
    return torch.sigmoid(x)
def _layernorm(x, axis=-1, eps=1e-5):
    m = x.mean(dim=axis, keepdim=True)
    v = x.var(dim=axis, keepdim=True, unbiased=False)
    return (x - m) / torch.sqrt(v + eps)
def _scatter_add(tgt, idx, src, axis=0):
    return tgt.clone().index_add_(axis, idx, src)
def _segment_sum(src, seg, n):
    out = torch.zeros((n,) + src.shape[1:], dtype=src.dtype)
    return out.index_add_(0, seg, src)
def _pad(x, pw):
    flat = tuple(v for pair in reversed(pw) for v in pair)
    return torch.nn.functional.pad(x, flat)

kernel_name = 'recurrent_scan__sliding_block_cached__dense_activation_relu__prompt'

def setup_inputs():

    _w = (lambda a: (lambda t: t.to(torch.bfloat16) if t.is_floating_point() else t)(torch.as_tensor(a)))
    def _A_setup():
        B, Sq, D = 1, 2048, 448
        Hq, Hkv, Sk, Dh = 16, 8, 2048, 256
        assert Hq % Hkv == 0, (Hq, Hkv)
        return {
            "x": _w((lambda *s: torch.randn(*s, dtype=torch.bfloat16) * 0.05)(B, Sq, D)),
            "k_cache": _w((lambda *s: torch.randn(*s, dtype=torch.bfloat16) * 0.8)(B, Hkv, Sk, Dh)),
            "v_cache": _w((lambda *s: torch.randn(*s, dtype=torch.bfloat16) * 0.2)(B, Hkv, Sk, Dh)),
            "wq": _w((lambda *s: torch.randn(*s, dtype=torch.bfloat16) * 0.8)(D, Hq * Dh) * (D ** -0.5)),
            "wo": _w((lambda *s: torch.randn(*s, dtype=torch.bfloat16) * 0.2)(Hq * Dh, D) * ((Hq * Dh) ** -0.5)),
        }
    _A_in = _A_setup()

    def _B_setup():
        B, S, D, Dff = 1, 2048, 448, 1792
        return {
            "x": _w((lambda *s: torch.randn(*s, dtype=torch.bfloat16) * 0.05)(B, S, D)),
            "w1": _w((lambda *s: torch.randn(*s, dtype=torch.bfloat16) * 0.1)(D, Dff)),
            "w2": _w((lambda *s: torch.randn(*s, dtype=torch.bfloat16) * 0.1)(Dff, D)),
        }
    _B_in = _B_setup()

    return {
        "A_x": _A_in["x"],
        "A_k_cache": _A_in["k_cache"],
        "A_v_cache": _A_in["v_cache"],
        "A_wq": _A_in["wq"],
        "A_wo": _A_in["wo"],
        "B_x": _B_in["x"],
        "B_w1": _B_in["w1"],
        "B_w2": _B_in["w2"],
    }

def reference(A_x, A_k_cache, A_v_cache, A_wq, A_wo, B_x, B_w1, B_w2):
    def _A_ref(x, k_cache, v_cache, wq, wo):
        B, Sq, D = x.shape
        Hq, Dh = 16, 256
        Hkv, Sk = k_cache.shape[1], k_cache.shape[2]
        W = min(4096, max(256, Sk // 4))
        rep = Hq // Hkv
        q = (lambda x, *d: x.permute(*d))((x @ wq).reshape(B, Sq, Hq, Dh), 0, 2, 1, 3)
        k = (lambda x, n, axis: torch.repeat_interleave(x, n, dim=axis))(k_cache[:, :, Sk - W:, :], rep, axis=1)
        v = (lambda x, n, axis: torch.repeat_interleave(x, n, dim=axis))(v_cache[:, :, Sk - W:, :], rep, axis=1)
        scores = torch.einsum("bhqd,bhkd->bhqk", q, k) * (Dh ** -0.5)
        p = _softmax(scores, axis=-1)
        o = torch.einsum("bhqk,bhkd->bhqd", p, v)
        return (lambda x, *d: x.permute(*d))(o, 0, 2, 1, 3).reshape(B, Sq, Hq * Dh) @ wo

    def _B_ref(x, w1, w2):
        h = torch.einsum("bsd,df->bsf", x, w1)
        zero = torch.zeros_like(h)
        h = torch.maximum(h, zero)
        return torch.einsum("bsf,fd->bsd", h, w2)

    x = A_x
    xn = _layernorm(x, axis=-1)
    s = _A_ref(xn, A_k_cache, A_v_cache, A_wq, A_wo)
    g = _silu(_B_ref(xn, B_w1, B_w2))
    return x + s * g
```

```asm
; @launch grid=(256,1,1) block=(256,1,1) lds=163840
.amdgcn_target "amdgcn-amd-amdhsa--gfx950"
.text
.globl recurrent_scan__sliding_block_cached__dense_activation_relu__prompt_kernel
.p2align 8
.type recurrent_scan__sliding_block_cached__dense_activation_relu__prompt_kernel,@function
recurrent_scan__sliding_block_cached__dense_activation_relu__prompt_kernel:
    s_cmp_ge_u32 s2, 256
    s_cbranch_scc1 L_end
    s_load_dwordx16 s[4:19], s[0:1], 0
    s_load_dwordx4 s[20:23], s[0:1], 64
    s_load_dwordx2 s[24:25], s[0:1], 80
    v_lshrrev_b32 v3, 6, v0
    v_and_b32 v0, 63, v0
    s_and_b32 s69, s2, 7
    v_readfirstlane_b32 s64, v3
    s_lshr_b32 s70, s2, 3
    s_and_b32 s71, s69, 3
    s_lshl_b32 s71, s71, 2
    s_and_b32 s65, s70, 3
    s_add_u32 s65, s65, s71
    s_lshr_b32 s71, s69, 2
    s_lshl_b32 s71, s71, 3
    s_lshr_b32 s94, s70, 2
    s_add_u32 s66, s94, s71
    s_lshl_b32 s67, s64, 12
    s_lshr_b32 s92, s2, 3
    s_lshl_b32 s93, s64, 6
    s_add_u32 s93, s93, 0
    v_add_u32 v236, s93, v0
    v_min_u32 v236, 15, v236
    s_mul_i32 s93, s92, 16
    v_add_u32 v236, s93, v236
    v_lshlrev_b32 v236, 7, v236
    s_getpc_b64 s[26:27]
L_pc:
    global_load_dword v252, v236, s[26:27]
    v_lshrrev_b32 v6, 3, v0
    v_and_b32 v7, 7, v0
    v_lshrrev_b32 v4, 1, v6
    v_xor_b32 v4, v4, v7
    v_lshlrev_b32 v4, 4, v4
    v_xor_b32 v5, 64, v4
    s_lshl_b32 s70, s66, 2
    s_add_u32 s70, s70, s64
    s_mul_i32 s70, s70, 28672
    v_mul_u32_u24 v3, 896, v6
    v_add_u32 v3, s70, v3
    v_add_u32 v224, v3, v4
    v_add_u32 v225, v3, v5
    v_add_u32 v226, 12288, v224
    v_add_u32 v227, 18432, v225
    v_add_u32 v225, 6144, v225
    s_mov_b32 m0, s67
    s_mov_b32 s68, 0
    v_min_u32 v238, 13, v0
    v_subrev_u32 v239, 7, v238
    v_min_u32 v239, v239, v238
    v_sub_u32 v238, v238, v239
    v_lshlrev_b32 v238, 11, v238
    v_lshl_add_u32 v238, v239, 7, v238
    s_mul_i32 s71, s65, 896
    s_add_u32 s71, s71, s70
    s_mov_b32 s30, 1835008
    s_mov_b32 s31, 0x00020000
    s_waitcnt lgkmcnt(0)
    s_mov_b32 s28, s4
    s_mov_b32 s29, s5
    buffer_load_dword a57, v238, s[28:31], s71 offen
    buffer_load_dwordx4 v224, s[28:31], s68 offen offset:0  lds
    buffer_load_dwordx4 v225, s[28:31], s68 offen offset:1024  lds
    s_add_u32 m0, s67, 16384
    s_movk_i32 s68, 128
    buffer_load_dwordx4 v224, s[28:31], s68 offen offset:0  lds
    buffer_load_dwordx4 v225, s[28:31], s68 offen offset:1024  lds
    s_lshl_b32 s69, s65, 9
    s_sub_u32 s71, 3670016, s69
    s_add_u32 s36, s10, s69
    s_addc_u32 s37, s11, 0
    s_mov_b32 s38, s71
    s_mov_b32 s39, 0x00020000
    s_lshl_b32 s93, s64, 6
    s_add_u32 s93, s93, 0
    v_add_u32 v27, s93, v0
    v_min_u32 v27, 27, v27
    s_mul_i32 s93, s66, 28
    v_add_u32 v27, s93, v27
    v_and_b32 v26, 0, v27
    v_lshrrev_b32 v27, 0, v27
    v_mul_u32_u24 v27, 8192, v27
    v_lshl_add_u32 v27, v26, 7, v27
    buffer_load_dword a60, v27, s[36:39], 0 offen
    s_lshl_b32 s93, s64, 6
    s_add_u32 s93, s93, 0
    v_add_u32 v27, s93, v0
    v_min_u32 v27, 111, v27
    s_mul_i32 s93, s94, 112
    v_add_u32 v27, s93, v27
    v_and_b32 v26, 1, v27
    v_lshrrev_b32 v27, 1, v27
    v_mul_u32_u24 v27, 8192, v27
    v_lshl_add_u32 v27, v26, 7, v27
    s_mov_b32 s60, s20
    s_mov_b32 s61, s21
    s_mov_b32 s62, 1835008
    s_mov_b32 s63, 0x00020000
    s_lshl_b32 s69, s64, 7
    v_lshlrev_b32 v36, 9, v6
    v_add_u32 v40, s69, v36
    v_add_u32 v36, v40, v4
    v_add_u32 v37, v40, v5
    v_add_u32 v38, 6144, v36
    v_add_u32 v39, 9216, v37
    v_add_u32 v37, 3072, v37
    v_and_b32 v3, 6, v6
    v_xor_b32 v3, v3, v7
    v_lshlrev_b32 v3, 4, v3
    v_add_u32 v40, v40, v3
    v_add_u32 v41, 3072, v40
    v_add_u32 v42, 6144, v40
    v_add_u32 v43, 9216, v40
    v_and_b32 v4, 0, v6
    v_add_u32 v4, v4, v6
    v_lshl_add_u32 v32, v4, 13, v3
    v_mul_u32_u24 v4, 3584, v4
    v_add_u32 v220, v4, v3
    v_add_u32 v221, 27648, v220
    v_add_u32 v33, 64512, v32
    v_add_u32 v222, 55296, v220
    v_add_u32 v34, 129024, v32
    v_add_u32 v223, 82944, v220
    v_add_u32 v35, 193536, v32
    s_lshl_b32 s70, s65, 8
    s_sub_u32 s71, 1605632, s70
    s_cmp_lt_u32 s65, 14
    s_cselect_b32 s71, s71, 0
    s_cselect_b32 s70, s70, 0
    s_add_u32 s32, s16, s70
    s_addc_u32 s33, s17, 0
    s_mov_b32 s34, s71
    s_mov_b32 s35, 0x00020000
    s_lshr_b32 s69, s65, 1
    s_lshl_b32 s69, s69, 20
    s_add_u32 s69, s69, 786432
    s_add_u32 s40, s6, s69
    s_addc_u32 s41, s7, 0
    s_mov_b32 s42, 262144
    s_mov_b32 s43, 0x00020000
    s_add_u32 s44, s8, s69
    s_addc_u32 s45, s9, 0
    s_mov_b32 s46, 262144
    s_mov_b32 s47, 0x00020000
    s_mul_i32 s69, s65, 229376
    s_add_u32 s48, s12, s69
    s_addc_u32 s49, s13, 0
    s_mov_b32 s50, 229376
    s_mov_b32 s51, 0x00020000
    s_lshr_b32 s97, s2, 3
    s_and_b32 s97, s97, 15
    s_cmp_ge_u32 s97, 7
    s_cselect_b32 s3, 1, 0
    s_mul_i32 s70, s3, 7
    s_sub_u32 s70, s97, s70
    s_lshl_b32 s69, s70, 7
    s_sub_u32 s71, 1605632, s69
    s_cmp_lt_u32 s97, 14
    s_cselect_b32 s71, s71, 0
    s_cselect_b32 s69, s69, 0
    s_add_u32 s52, s18, s69
    s_addc_u32 s53, s19, 0
    s_mov_b32 s54, s71
    s_mov_b32 s55, 0x00020000
    s_mov_b32 s56, s24
    s_mov_b32 s57, s25
    s_mov_b32 s58, 37748736
    s_mov_b32 s59, 0x00020000
    s_mul_i32 s12, s64, 262144
    s_cmp_lt_u32 s64, 2
    s_mov_b32 s71, 0xfff80080
    s_cselect_b32 s69, 3145728, s71
    s_add_u32 s13, s12, s69
    s_mul_i32 s14, s64, 114688
    s_cmp_lt_u32 s64, 2
    s_mov_b32 s71, 0xfffc8080
    s_cselect_b32 s69, 1376256, s71
    s_add_u32 s15, s14, s69
    v_mul_u32_u24 v4, 896, v6
    v_add_u32 v4, v4, v3
    s_mul_i32 s69, s64, 28672
    s_mul_i32 s71, s64, 401408
    v_add_u32 v5, s69, v4
    v_accvgpr_write_b32 a48, v5
    v_add_u32 v5, s71, v4
    v_accvgpr_write_b32 a52, v5
    v_add_u32 v4, 6144, v4
    v_add_u32 v5, s69, v4
    v_accvgpr_write_b32 a49, v5
    v_add_u32 v5, s71, v4
    v_accvgpr_write_b32 a53, v5
    v_add_u32 v4, 6144, v4
    v_add_u32 v5, s69, v4
    v_accvgpr_write_b32 a50, v5
    v_add_u32 v5, s71, v4
    v_accvgpr_write_b32 a54, v5
    v_add_u32 v4, 6144, v4
    v_add_u32 v5, s69, v4
    v_accvgpr_write_b32 a51, v5
    v_add_u32 v5, s71, v4
    v_accvgpr_write_b32 a55, v5
    v_lshlrev_b32 v1, 4, v0
    v_lshrrev_b32 v3, 2, v0
    v_lshlrev_b32 v4, 7, v3
    v_and_b32 v5, 3, v0
    v_lshl_add_u32 v4, v5, 3, v4
    v_bfe_u32 v6, v0, 3, 2
    v_xor_b32 v7, 0, v6
    v_lshl_add_u32 v8, v7, 5, v4
    v_add_u32 v12, 0x10000, v8
    v_add_u32 v16, 0x20000, v8
    v_xor_b32 v7, 1, v6
    v_lshl_add_u32 v9, v7, 5, v4
    v_add_u32 v13, 0x10000, v9
    v_add_u32 v17, 0x20000, v9
    v_xor_b32 v7, 2, v6
    v_lshl_add_u32 v10, v7, 5, v4
    v_add_u32 v14, 0x10000, v10
    v_add_u32 v18, 0x20000, v10
    v_xor_b32 v7, 3, v6
    v_lshl_add_u32 v11, v7, 5, v4
    v_add_u32 v15, 0x10000, v11
    v_add_u32 v19, 0x20000, v11
    v_and_b32 v3, 15, v0
    v_lshrrev_b32 v4, 1, v3
    v_lshrrev_b32 v5, 4, v0
    v_xor_b32 v4, v4, v5
    v_lshlrev_b32 v7, 7, v3
    v_lshl_add_u32 v20, v4, 4, v7
    v_xor_b32 v21, 64, v20
    v_add_u32 v22, 0x10000, v20
    v_add_u32 v23, 0x10000, v21
    v_add_u32 v24, 0x20000, v20
    v_add_u32 v25, 0x20000, v21
    v_add_u32 v228, s67, v20
    v_add_u32 v229, s67, v21
    v_add_u32 v230, s67, v22
    v_add_u32 v231, s67, v23
    v_lshrrev_b32 v241, 3, v0
    v_bfe_u32 v242, v0, 1, 1
    v_xor_b32 v241, v241, v242
    v_lshlrev_b32 v241, 4, v241
    v_lshrrev_b32 v242, 2, v0
    v_lshl_add_u32 v241, v242, 7, v241
    v_and_b32 v242, 1, v0
    v_lshl_add_u32 v241, v242, 3, v241
    v_add_u32 v240, s67, v241
    v_xor_b32 v241, 32, v240
    v_xor_b32 v242, 64, v240
    v_xor_b32 v243, 96, v240
    v_add_u32 v244, 0x10000, v240
    v_add_u32 v245, 0x10000, v241
    v_add_u32 v246, 0x10000, v242
    v_add_u32 v247, 0x10000, v243
    s_and_b32 s19, s2, 7
    s_lshl_b32 s19, s19, 1
    s_lshr_b32 s69, s2, 7
    s_add_u32 s19, s19, s69
    s_lshl_b32 s24, s69, 1
    s_add_u32 s24, s24, s3
    s_lshl_b32 s71, s19, 1
    s_add_u32 s71, s71, s3
    s_lshl_b32 s69, s71, 2
    s_add_u32 s69, s69, s64
    s_mul_i32 s69, s69, 14336
    s_lshl_b32 s89, s70, 7
    s_add_u32 s69, s69, s89
    v_lshrrev_b32 v3, 3, v0
    v_mul_u32_u24 v3, 896, v3
    v_and_b32 v5, 7, v0
    v_lshl_add_u32 v3, v5, 4, v3
    v_add_u32 v3, s69, v3
    v_accvgpr_write_b32 a56, v3
    s_lshl_b32 s71, s71, 1
    s_lshr_b32 s69, s64, 1
    s_add_u32 s89, s71, s69
    s_lshl_b32 s91, s89, 9
    s_mul_i32 s89, s89, 7
    s_add_u32 s89, s89, s70
    s_lshl_b32 s89, s89, 2
    s_add_u32 s91, s91, 0x2300000
    s_and_b32 s69, s64, 1
    s_add_u32 s89, s89, s69
    s_lshl_b32 s89, s89, 14
    s_mul_i32 s87, s71, 114688
    s_add_u32 s87, s87, 0x1c00000
    s_cmp_lt_u32 s97, 14
    s_cselect_b32 s20, 0, 0x7f000000
    s_add_u32 s21, s87, s20
    s_mul_i32 s69, s64, 28672
    s_add_u32 s87, s87, s69
    s_mov_b32 s0, s2
    s_mov_b32 s2, s70
    s_lshl_b32 s25, s94, 1
    s_and_b32 s69, s65, 1
    s_add_u32 s25, s25, s69
    s_lshl_b32 s70, s66, 2
    s_add_u32 s70, s70, s64
    s_lshl_b32 s90, s70, 9
    s_add_u32 s90, s90, s65
    v_min_u32 v30, 2, v0
    v_lshlrev_b32 v30, 7, v30
    s_add_u32 s90, s90, 0x2300000
    s_mul_i32 s86, s70, 114688
    s_min_u32 s71, s65, 13
    s_lshl_b32 s71, s71, 13
    s_add_u32 s86, s86, s71
    s_add_u32 s86, s86, 0x1c00000
    s_cmp_lt_u32 s65, 14
    s_cselect_b32 s71, 0, 0x7f000000
    v_add_u32 v2, s71, v1
    v_mov_b32 v28, 0
    v_mov_b32 v29, 1
    s_add_u32 m0, s67, 32768
    s_movk_i32 s68, 256
    buffer_load_dwordx4 v224, s[28:31], s68 offen offset:0  lds
    buffer_load_dwordx4 v225, s[28:31], s68 offen offset:1024  lds
    s_add_u32 m0, s67, 49152
    s_movk_i32 s68, 384
    buffer_load_dwordx4 v224, s[28:31], s68 offen offset:0  lds
    buffer_load_dwordx4 v225, s[28:31], s68 offen offset:1024  lds
    s_add_u32 m0, s67, 65536
    s_movk_i32 s68, 512
    buffer_load_dwordx4 v224, s[28:31], s68 offen offset:0  lds
    buffer_load_dwordx4 v225, s[28:31], s68 offen offset:1024  lds
    s_add_u32 m0, s67, 81920
    s_movk_i32 s68, 640
    buffer_load_dwordx4 v224, s[28:31], s68 offen offset:0  lds
    buffer_load_dwordx4 v225, s[28:31], s68 offen offset:1024  lds
    s_add_u32 m0, s67, 98304
    s_movk_i32 s68, 768
    buffer_load_dwordx4 v224, s[28:31], s68 offen offset:0  lds
    buffer_load_dwordx4 v225, s[28:31], s68 offen offset:1024  lds
    s_lshl_b32 s88, s66, 2
    s_add_u32 s88, s88, s64
    s_mul_i32 s88, s88, 458752
    s_cmp_ge_u32 s65, 7
    s_cselect_b32 s3, 1, 0
    s_sub_u32 s95, s65, 7
    s_min_u32 s95, s95, s65
    s_sub_u32 s92, s95, 7
    s_min_u32 s95, s95, s92
    s_cmp_lt_u32 s65, 14
    s_cselect_b32 s3, s3, s65
    s_cselect_b32 s96, 2048, 0
    s_lshl_b32 s3, s3, 10
    s_add_u32 s88, s88, s3
    s_mov_b32 s4, 0x22222222
    s_mov_b32 s5, 0x22222222
    s_mov_b32 s6, 0xcccccccc
    s_mov_b32 s7, 0xcccccccc
    s_mov_b32 s8, 0x88888888
    s_mov_b32 s9, 0x88888888
    s_mov_b32 s10, 0xf0000f
    s_mov_b32 s11, 0xf0000f00
    v_mov_b32 v172, 0x3f803f80
    v_mov_b32 v173, 0x3f803f80
    v_mov_b32 v174, 0x3f803f80
    v_mov_b32 v175, 0x3f803f80
    s_mov_b32 s69, 0x3b124925
    s_mov_b32 s70, 0x3727c5ac
    s_mov_b32 s71, 0x3db8aa3b
    s_mov_b64 exec, 0
    s_cmp_eq_u32 s64, 0
    s_cbranch_scc1 L_pg0
    s_cmp_eq_u32 s64, 1
    s_cbranch_scc1 L_pg1
    s_cmp_eq_u32 s64, 2
    s_cbranch_scc1 L_pg2
    s_branch L_pg3
.p2align 12
L_main:
    s_mov_b64 exec, -1
    s_waitcnt vmcnt(13)
    ds_read_b128 v[44:47], v228 offset:0
    ds_read_b128 v[52:55], v229 offset:0
    s_add_u32 m0, s67, 0
    s_movk_i32 s68, 0
    buffer_load_dwordx4 v226, s[28:31], s68 offen offset:2048  lds
    buffer_load_dwordx4 v227, s[28:31], s68 offen offset:3072  lds
    s_waitcnt vmcnt(13)
    ds_read_b128 v[60:63], v228 offset:16384
    ds_read_b128 v[68:71], v229 offset:16384
    s_add_u32 m0, s67, 16384
    s_movk_i32 s68, 128
    buffer_load_dwordx4 v226, s[28:31], s68 offen offset:2048  lds
    buffer_load_dwordx4 v227, s[28:31], s68 offen offset:3072  lds
    s_waitcnt vmcnt(12)
    ds_read_b128 v[76:79], v228 offset:32768
    ds_read_b128 v[84:87], v229 offset:32768
    s_add_u32 m0, s67, 32768
    s_movk_i32 s68, 256
    buffer_load_dwordx4 v226, s[28:31], s68 offen offset:2048  lds
    buffer_load_dwordx4 v227, s[28:31], s68 offen offset:3072  lds
    s_waitcnt lgkmcnt(4)
    v_mfma_f32_16x16x32_bf16 v[176:179], v[172:175], v[44:47], 0
    v_mfma_f32_16x16x32_bf16 v[184:187], v[44:47], v[44:47], 0
    v_mfma_f32_16x16x32_bf16 v[176:179], v[172:175], v[52:55], v[176:179]
    v_mfma_f32_16x16x32_bf16 v[184:187], v[52:55], v[52:55], v[184:187]
    s_waitcnt vmcnt(12)
    ds_read_b128 v[92:95], v228 offset:49152
    ds_read_b128 v[100:103], v229 offset:49152
    s_add_u32 m0, s67, 49152
    s_movk_i32 s68, 384
    buffer_load_dwordx4 v226, s[28:31], s68 offen offset:2048  lds
    buffer_load_dwordx4 v227, s[28:31], s68 offen offset:3072  lds
    s_waitcnt lgkmcnt(4)
    v_mfma_f32_16x16x32_bf16 v[176:179], v[172:175], v[60:63], v[176:179]
    v_mfma_f32_16x16x32_bf16 v[184:187], v[60:63], v[60:63], v[184:187]
    v_mfma_f32_16x16x32_bf16 v[176:179], v[172:175], v[68:71], v[176:179]
    v_mfma_f32_16x16x32_bf16 v[184:187], v[68:71], v[68:71], v[184:187]
    s_waitcnt vmcnt(12)
    ds_read_b128 v[108:111], v230 offset:0
    ds_read_b128 v[116:119], v231 offset:0
    s_add_u32 m0, s67, 65536
    s_movk_i32 s68, 512
    buffer_load_dwordx4 v226, s[28:31], s68 offen offset:2048  lds
    buffer_load_dwordx4 v227, s[28:31], s68 offen offset:3072  lds
    s_waitcnt lgkmcnt(4)
    v_mfma_f32_16x16x32_bf16 v[176:179], v[172:175], v[76:79], v[176:179]
    v_mfma_f32_16x16x32_bf16 v[184:187], v[76:79], v[76:79], v[184:187]
    v_mfma_f32_16x16x32_bf16 v[176:179], v[172:175], v[84:87], v[176:179]
    v_mfma_f32_16x16x32_bf16 v[184:187], v[84:87], v[84:87], v[184:187]
    s_waitcnt vmcnt(12)
    ds_read_b128 v[124:127], v230 offset:16384
    ds_read_b128 v[132:135], v231 offset:16384
    s_add_u32 m0, s67, 81920
    s_movk_i32 s68, 640
    buffer_load_dwordx4 v226, s[28:31], s68 offen offset:2048  lds
    buffer_load_dwordx4 v227, s[28:31], s68 offen offset:3072  lds
    s_waitcnt lgkmcnt(4)
    v_mfma_f32_16x16x32_bf16 v[176:179], v[172:175], v[92:95], v[176:179]
    v_mfma_f32_16x16x32_bf16 v[184:187], v[92:95], v[92:95], v[184:187]
    v_mfma_f32_16x16x32_bf16 v[176:179], v[172:175], v[100:103], v[176:179]
    v_mfma_f32_16x16x32_bf16 v[184:187], v[100:103], v[100:103], v[184:187]
    s_waitcnt vmcnt(12)
    ds_read_b128 v[140:143], v230 offset:32768
    ds_read_b128 v[148:151], v231 offset:32768
    s_add_u32 m0, s67, 98304
    s_movk_i32 s68, 768
    buffer_load_dwordx4 v226, s[28:31], s68 offen offset:2048  lds
    buffer_load_dwordx4 v227, s[28:31], s68 offen offset:3072  lds
    s_waitcnt lgkmcnt(4)
    v_mfma_f32_16x16x32_bf16 v[176:179], v[172:175], v[108:111], v[176:179]
    v_mfma_f32_16x16x32_bf16 v[184:187], v[108:111], v[108:111], v[184:187]
    v_mfma_f32_16x16x32_bf16 v[176:179], v[172:175], v[116:119], v[176:179]
    v_mfma_f32_16x16x32_bf16 v[184:187], v[116:119], v[116:119], v[184:187]
    s_waitcnt lgkmcnt(2)
    v_mfma_f32_16x16x32_bf16 v[176:179], v[172:175], v[124:127], v[176:179]
    s_add_u32 m0, s67, 114688
    s_add_u32 s68, s12, 0
    v_mfma_f32_16x16x32_bf16 v[184:187], v[124:127], v[124:127], v[184:187]
    buffer_load_dwordx4 v32, s[36:39], s68 offen offset:0 sc1 lds
    v_mfma_f32_16x16x32_bf16 v[176:179], v[172:175], v[132:135], v[176:179]
    buffer_load_dwordx4 v33, s[36:39], s68 offen offset:1024 sc1 lds
    v_mfma_f32_16x16x32_bf16 v[184:187], v[132:135], v[132:135], v[184:187]
    buffer_load_dwordx4 v34, s[36:39], s68 offen offset:2048 sc1 lds
    s_waitcnt lgkmcnt(0)
    v_mfma_f32_16x16x32_bf16 v[176:179], v[172:175], v[140:143], v[176:179]
    buffer_load_dwordx4 v35, s[36:39], s68 offen offset:3072 sc1 lds
    v_mfma_f32_16x16x32_bf16 v[184:187], v[140:143], v[140:143], v[184:187]
    buffer_load_dword a61, v27, s[36:39], 0 offen
    v_mfma_f32_16x16x32_bf16 v[176:179], v[172:175], v[148:151], v[176:179]
    v_mfma_f32_16x16x32_bf16 v[184:187], v[148:151], v[148:151], v[184:187]
    s_or_b64 s[16:17], s[4:5], s[8:9]
    ds_read_b64_tr_b16 a[128:129], v240 offset:0
    s_nop 5
    v_cndmask_b32 v184, v184, v185, s[4:5]
    ds_read_b64_tr_b16 a[130:131], v241 offset:0
    v_cndmask_b32 v186, v186, v187, s[8:9]
    ds_read_b64_tr_b16 a[132:133], v242 offset:0
    v_mul_f32 v176, s69, v176
    ds_read_b64_tr_b16 a[134:135], v243 offset:0
    v_cndmask_b32 v184, v184, v186, s[6:7]
    ds_read_b64_tr_b16 a[136:137], v240 offset:16384
    v_cndmask_b32 v184, 0, v184, s[10:11]
    ds_read_b64_tr_b16 a[138:139], v241 offset:16384
    v_mov_b32 v177, v184
    ds_read_b64_tr_b16 a[140:141], v242 offset:16384
    s_nop 0
    v_permlane32_swap_b32 v184, v177
    ds_read_b64_tr_b16 a[142:143], v243 offset:16384
    v_add_f32 v184, v184, v177
    ds_read_b64_tr_b16 a[144:145], v240 offset:32768
    v_mov_b32 v177, v184
    ds_read_b64_tr_b16 a[146:147], v241 offset:32768
    s_nop 0
    v_permlane16_swap_b32 v184, v177
    ds_read_b64_tr_b16 a[148:149], v242 offset:32768
    v_add_f32 v184, v184, v177
    ds_read_b64_tr_b16 a[150:151], v243 offset:32768
    v_mul_f32 v184, s69, v184
    ds_read_b64_tr_b16 a[152:153], v240 offset:49152
    v_fma_f32 v184, -v176, v176, v184
    ds_read_b64_tr_b16 a[154:155], v241 offset:49152
    v_max_f32 v184, 0, v184
    v_cvt_pk_bf16_f32 v176, v176, v176
    v_cvt_pk_bf16_f32 v184, v184, v184
    v_lshlrev_b32 v176, 16, v176
    v_lshlrev_b32 v184, 16, v184
    v_add_f32 v184, s70, v184
    v_cvt_pk_bf16_f32 v184, v184, v184
    v_lshlrev_b32 v184, 16, v184
    v_sqrt_f32 v184, v184
    s_nop 0
    v_cvt_pk_bf16_f32 v184, v184, v184
    v_lshlrev_b32 v184, 16, v184
    v_rcp_f32 v184, v184
    s_nop 0
    v_mul_f32 v184, s71, v184
    v_cvt_pk_bf16_f32 v184, v184, v184
    v_and_b32 v192, 0xffff, v184
    v_lshlrev_b32 v193, 16, v184
    v_mul_f32 v194, -v176, v193
    v_cndmask_b32 v192, v192, v193, s[16:17]
    v_mov_b32 v176, v194
    v_cndmask_b32 v192, 0, v192, s[10:11]
    v_mov_b32 v177, v194
    v_cndmask_b32 v193, 0, v192, s[6:7]
    v_mov_b32 v178, v194
    v_cndmask_b32 v192, v192, 0, s[6:7]
    v_mov_b32 v179, v194
    s_waitcnt lgkmcnt(10)
    s_nop 0
    v_mfma_f32_16x16x16_bf16 v[200:203], a[128:129], v[192:193], v[176:179]
    ds_read_b64_tr_b16 a[156:157], v242 offset:49152
    v_mfma_f32_16x16x16_bf16 v[204:207], a[130:131], v[192:193], v[176:179]
    ds_read_b64_tr_b16 a[158:159], v243 offset:49152
    v_mfma_f32_16x16x16_bf16 v[208:211], a[132:133], v[192:193], v[176:179]
    ds_read_b64_tr_b16 a[160:161], v244 offset:0
    s_nop 2
    v_cvt_pk_bf16_f32 v44, v200, v201
    v_cvt_pk_bf16_f32 v45, v202, v203
    v_mfma_f32_16x16x16_bf16 v[212:215], a[134:135], v[192:193], v[176:179]
    ds_read_b64_tr_b16 a[162:163], v245 offset:0
    v_cvt_pk_bf16_f32 v46, v204, v205
    v_cvt_pk_bf16_f32 v47, v206, v207
    s_waitcnt lgkmcnt(10)
    v_mfma_f32_16x16x16_bf16 v[200:203], a[136:137], v[192:193], v[176:179]
    ds_read_b64_tr_b16 a[164:165], v246 offset:0
    v_cvt_pk_bf16_f32 v52, v208, v209
    v_cvt_pk_bf16_f32 v53, v210, v211
    v_mfma_f32_16x16x16_bf16 v[204:207], a[138:139], v[192:193], v[176:179]
    ds_read_b64_tr_b16 a[166:167], v247 offset:0
    v_cvt_pk_bf16_f32 v54, v212, v213
    v_cvt_pk_bf16_f32 v55, v214, v215
    v_mfma_f32_16x16x16_bf16 v[208:211], a[140:141], v[192:193], v[176:179]
    ds_read_b64_tr_b16 a[168:169], v244 offset:16384
    v_cvt_pk_bf16_f32 v60, v200, v201
    v_cvt_pk_bf16_f32 v61, v202, v203
    v_mfma_f32_16x16x16_bf16 v[212:215], a[142:143], v[192:193], v[176:179]
    ds_read_b64_tr_b16 a[170:171], v245 offset:16384
    v_cvt_pk_bf16_f32 v62, v204, v205
    v_cvt_pk_bf16_f32 v63, v206, v207
    s_waitcnt lgkmcnt(10)
    v_mfma_f32_16x16x16_bf16 v[200:203], a[144:145], v[192:193], v[176:179]
    ds_read_b64_tr_b16 a[172:173], v246 offset:16384
    v_cvt_pk_bf16_f32 v68, v208, v209
    v_cvt_pk_bf16_f32 v69, v210, v211
    v_mfma_f32_16x16x16_bf16 v[204:207], a[146:147], v[192:193], v[176:179]
    ds_read_b64_tr_b16 a[174:175], v247 offset:16384
    v_cvt_pk_bf16_f32 v70, v212, v213
    v_cvt_pk_bf16_f32 v71, v214, v215
    v_mfma_f32_16x16x16_bf16 v[208:211], a[148:149], v[192:193], v[176:179]
    ds_read_b64_tr_b16 a[176:177], v244 offset:32768
    v_cvt_pk_bf16_f32 v76, v200, v201
    v_cvt_pk_bf16_f32 v77, v202, v203
    v_mfma_f32_16x16x16_bf16 v[212:215], a[150:151], v[192:193], v[176:179]
    ds_read_b64_tr_b16 a[178:179], v245 offset:32768
    v_cvt_pk_bf16_f32 v78, v204, v205
    v_cvt_pk_bf16_f32 v79, v206, v207
    s_waitcnt lgkmcnt(10)
    v_mfma_f32_16x16x16_bf16 v[200:203], a[152:153], v[192:193], v[176:179]
    ds_read_b64_tr_b16 a[180:181], v246 offset:32768
    v_cvt_pk_bf16_f32 v84, v208, v209
    v_cvt_pk_bf16_f32 v85, v210, v211
    v_mfma_f32_16x16x16_bf16 v[204:207], a[154:155], v[192:193], v[176:179]
    ds_read_b64_tr_b16 a[182:183], v247 offset:32768
    v_cvt_pk_bf16_f32 v86, v212, v213
    v_cvt_pk_bf16_f32 v87, v214, v215
    s_waitcnt vmcnt(17)
    ds_read_b128 v[48:51], v228 offset:2048
    ds_read_b128 v[56:59], v229 offset:2048
    s_waitcnt vmcnt(15)
    ds_read_b128 v[64:67], v228 offset:18432
    ds_read_b128 v[72:75], v229 offset:18432
    v_cvt_pk_bf16_f32 v92, v200, v201
    v_cvt_pk_bf16_f32 v93, v202, v203
    v_cvt_pk_bf16_f32 v94, v204, v205
    v_cvt_pk_bf16_f32 v95, v206, v207
    s_waitcnt lgkmcnt(2)
    v_mfma_f32_16x16x32_bf16 v[180:183], v[172:175], v[48:51], 0
    s_waitcnt vmcnt(13)
    ds_read_b128 v[80:83], v228 offset:34816
    v_mfma_f32_16x16x32_bf16 v[188:191], v[48:51], v[48:51], 0
    ds_read_b128 v[88:91], v229 offset:34816
    s_waitcnt vmcnt(11)
    v_mfma_f32_16x16x32_bf16 v[180:183], v[172:175], v[56:59], v[180:183]
    ds_read_b128 v[96:99], v228 offset:51200
    v_mfma_f32_16x16x32_bf16 v[188:191], v[56:59], v[56:59], v[188:191]
    ds_read_b128 v[104:107], v229 offset:51200
    s_waitcnt vmcnt(9) lgkmcnt(4)
    v_mfma_f32_16x16x32_bf16 v[180:183], v[172:175], v[64:67], v[180:183]
    ds_read_b128 v[112:115], v230 offset:2048
    v_mfma_f32_16x16x32_bf16 v[188:191], v[64:67], v[64:67], v[188:191]
    ds_read_b128 v[120:123], v231 offset:2048
    s_waitcnt vmcnt(7)
    v_mfma_f32_16x16x32_bf16 v[180:183], v[172:175], v[72:75], v[180:183]
    ds_read_b128 v[128:131], v230 offset:18432
    v_mfma_f32_16x16x32_bf16 v[188:191], v[72:75], v[72:75], v[188:191]
    ds_read_b128 v[136:139], v231 offset:18432
    s_waitcnt vmcnt(5) lgkmcnt(6)
    v_mfma_f32_16x16x32_bf16 v[180:183], v[172:175], v[80:83], v[180:183]
    ds_read_b128 v[144:147], v230 offset:34816
    v_mfma_f32_16x16x32_bf16 v[188:191], v[80:83], v[80:83], v[188:191]
    ds_read_b128 v[152:155], v231 offset:34816
    s_add_u32 m0, s67, 131072
    v_mfma_f32_16x16x32_bf16 v[180:183], v[172:175], v[88:91], v[180:183]
    s_add_u32 s68, s12, 1048576
    buffer_load_dwordx4 v32, s[36:39], s68 offen offset:0 sc1 lds
    v_mfma_f32_16x16x32_bf16 v[188:191], v[88:91], v[88:91], v[188:191]
    buffer_load_dwordx4 v33, s[36:39], s68 offen offset:1024 sc1 lds
    s_waitcnt lgkmcnt(6)
    v_mfma_f32_16x16x32_bf16 v[180:183], v[172:175], v[96:99], v[180:183]
    buffer_load_dwordx4 v34, s[36:39], s68 offen offset:2048 sc1 lds
    v_mfma_f32_16x16x32_bf16 v[188:191], v[96:99], v[96:99], v[188:191]
    buffer_load_dwordx4 v35, s[36:39], s68 offen offset:3072 sc1 lds
    s_add_u32 m0, s67, 147456
    v_mfma_f32_16x16x32_bf16 v[180:183], v[172:175], v[104:107], v[180:183]
    s_add_u32 s68, s12, 2097152
    buffer_load_dwordx4 v32, s[36:39], s68 offen offset:0 sc1 lds
    v_mfma_f32_16x16x32_bf16 v[188:191], v[104:107], v[104:107], v[188:191]
    buffer_load_dwordx4 v33, s[36:39], s68 offen offset:1024 sc1 lds
    s_waitcnt lgkmcnt(4)
    v_mfma_f32_16x16x32_bf16 v[180:183], v[172:175], v[112:115], v[180:183]
    buffer_load_dwordx4 v34, s[36:39], s68 offen offset:2048 sc1 lds
    v_mfma_f32_16x16x32_bf16 v[188:191], v[112:115], v[112:115], v[188:191]
    buffer_load_dwordx4 v35, s[36:39], s68 offen offset:3072 sc1 lds
    s_lshl_b32 s93, s64, 6
    v_mfma_f32_16x16x32_bf16 v[180:183], v[172:175], v[120:123], v[180:183]
    s_add_u32 s93, s93, 0
    v_add_u32 v27, s93, v0
    v_min_u32 v27, 111, v27
    v_mfma_f32_16x16x32_bf16 v[188:191], v[120:123], v[120:123], v[188:191]
    s_mul_i32 s93, s94, 112
    v_add_u32 v27, s93, v27
    v_and_b32 v26, 1, v27
    s_waitcnt lgkmcnt(2)
    v_mfma_f32_16x16x32_bf16 v[180:183], v[172:175], v[128:131], v[180:183]
    v_lshrrev_b32 v27, 1, v27
    v_mul_u32_u24 v27, 8192, v27
    v_lshl_add_u32 v27, v26, 7, v27
    v_mfma_f32_16x16x32_bf16 v[188:191], v[128:131], v[128:131], v[188:191]
    buffer_load_dword a62, v27, s[36:39], 0 offen offset:256
    s_lshl_b32 s93, s64, 6
    v_mfma_f32_16x16x32_bf16 v[180:183], v[172:175], v[136:139], v[180:183]
    s_add_u32 s93, s93, 0
    v_add_u32 v27, s93, v0
    v_min_u32 v27, 111, v27
    v_mfma_f32_16x16x32_bf16 v[188:191], v[136:139], v[136:139], v[188:191]
    s_mul_i32 s93, s94, 112
    v_add_u32 v27, s93, v27
    v_and_b32 v26, 1, v27
    s_waitcnt lgkmcnt(0)
    v_mfma_f32_16x16x32_bf16 v[180:183], v[172:175], v[144:147], v[180:183]
    v_lshrrev_b32 v27, 1, v27
    v_mul_u32_u24 v27, 3584, v27
    v_lshl_add_u32 v27, v26, 7, v27
    v_mfma_f32_16x16x32_bf16 v[188:191], v[144:147], v[144:147], v[188:191]
    buffer_load_dword a63, v27, s[32:35], 0 offen
    v_mfma_f32_16x16x32_bf16 v[180:183], v[172:175], v[152:155], v[180:183]
    buffer_store_byte v28, v30, s[56:59], s90 offen sc1
    v_mfma_f32_16x16x32_bf16 v[188:191], v[152:155], v[152:155], v[188:191]
    v_mfma_f32_16x16x16_bf16 v[208:211], a[156:157], v[192:193], v[176:179]
    ds_read_b64_tr_b16 a[184:185], v240 offset:2048
    v_mfma_f32_16x16x16_bf16 v[212:215], a[158:159], v[192:193], v[176:179]
    ds_read_b64_tr_b16 a[186:187], v241 offset:2048
    s_nop 3
    v_cndmask_b32 v188, v188, v189, s[4:5]
    v_cndmask_b32 v190, v190, v191, s[8:9]
    v_mfma_f32_16x16x16_bf16 v[200:203], a[160:161], v[192:193], v[176:179]
    ds_read_b64_tr_b16 a[188:189], v242 offset:2048
    v_cvt_pk_bf16_f32 v100, v208, v209
    v_cvt_pk_bf16_f32 v101, v210, v211
    v_mul_f32 v180, s69, v180
    v_cndmask_b32 v188, v188, v190, s[6:7]
    v_mfma_f32_16x16x16_bf16 v[204:207], a[162:163], v[192:193], v[176:179]
    ds_read_b64_tr_b16 a[190:191], v243 offset:2048
    v_cvt_pk_bf16_f32 v102, v212, v213
    v_cvt_pk_bf16_f32 v103, v214, v215
    v_cndmask_b32 v188, 0, v188, s[10:11]
    v_mov_b32 v181, v188
    v_mfma_f32_16x16x16_bf16 v[208:211], a[164:165], v[192:193], v[176:179]
    ds_read_b64_tr_b16 a[192:193], v240 offset:18432
    v_cvt_pk_bf16_f32 v108, v200, v201
    v_cvt_pk_bf16_f32 v109, v202, v203
    v_permlane32_swap_b32 v188, v181
    v_add_f32 v188, v188, v181
    v_mfma_f32_16x16x16_bf16 v[212:215], a[166:167], v[192:193], v[176:179]
    ds_read_b64_tr_b16 a[194:195], v241 offset:18432
    v_cvt_pk_bf16_f32 v110, v204, v205
    v_cvt_pk_bf16_f32 v111, v206, v207
    v_mov_b32 v181, v188
    s_nop 1
    v_permlane16_swap_b32 v188, v181
    v_mfma_f32_16x16x16_bf16 v[200:203], a[168:169], v[192:193], v[176:179]
    ds_read_b64_tr_b16 a[196:197], v242 offset:18432
    v_cvt_pk_bf16_f32 v116, v208, v209
    v_cvt_pk_bf16_f32 v117, v210, v211
    v_add_f32 v188, v188, v181
    v_mul_f32 v188, s69, v188
    v_mfma_f32_16x16x16_bf16 v[204:207], a[170:171], v[192:193], v[176:179]
    ds_read_b64_tr_b16 a[198:199], v243 offset:18432
    v_cvt_pk_bf16_f32 v118, v212, v213
    v_cvt_pk_bf16_f32 v119, v214, v215
    v_fma_f32 v188, -v180, v180, v188
    v_max_f32 v188, 0, v188
    v_mfma_f32_16x16x16_bf16 v[208:211], a[172:173], v[192:193], v[176:179]
    ds_read_b64_tr_b16 a[200:201], v240 offset:34816
    v_cvt_pk_bf16_f32 v124, v200, v201
    v_cvt_pk_bf16_f32 v125, v202, v203
    v_cvt_pk_bf16_f32 v180, v180, v180
    v_cvt_pk_bf16_f32 v188, v188, v188
    v_mfma_f32_16x16x16_bf16 v[212:215], a[174:175], v[192:193], v[176:179]
    ds_read_b64_tr_b16 a[202:203], v241 offset:34816
    v_cvt_pk_bf16_f32 v126, v204, v205
    v_cvt_pk_bf16_f32 v127, v206, v207
    v_lshlrev_b32 v180, 16, v180
    v_lshlrev_b32 v188, 16, v188
    v_mfma_f32_16x16x16_bf16 v[200:203], a[176:177], v[192:193], v[176:179]
    ds_read_b64_tr_b16 a[204:205], v242 offset:34816
    v_cvt_pk_bf16_f32 v132, v208, v209
    v_cvt_pk_bf16_f32 v133, v210, v211
    v_add_f32 v188, s70, v188
    v_cvt_pk_bf16_f32 v188, v188, v188
    v_mfma_f32_16x16x16_bf16 v[204:207], a[178:179], v[192:193], v[176:179]
    ds_read_b64_tr_b16 a[206:207], v243 offset:34816
    v_cvt_pk_bf16_f32 v134, v212, v213
    v_cvt_pk_bf16_f32 v135, v214, v215
    v_lshlrev_b32 v188, 16, v188
    v_sqrt_f32 v188, v188
    v_mfma_f32_16x16x16_bf16 v[208:211], a[180:181], v[192:193], v[176:179]
    ds_read_b64_tr_b16 a[208:209], v240 offset:51200
    v_cvt_pk_bf16_f32 v140, v200, v201
    v_cvt_pk_bf16_f32 v141, v202, v203
    v_cvt_pk_bf16_f32 v188, v188, v188
    v_lshlrev_b32 v188, 16, v188
    v_mfma_f32_16x16x16_bf16 v[212:215], a[182:183], v[192:193], v[176:179]
    ds_read_b64_tr_b16 a[210:211], v241 offset:51200
    v_cvt_pk_bf16_f32 v142, v204, v205
    v_cvt_pk_bf16_f32 v143, v206, v207
    v_rcp_f32 v188, v188
    s_nop 0
    v_mul_f32 v188, s71, v188
    v_cvt_pk_bf16_f32 v148, v208, v209
    v_cvt_pk_bf16_f32 v149, v210, v211
    v_cvt_pk_bf16_f32 v150, v212, v213
    v_cvt_pk_bf16_f32 v151, v214, v215
    ds_read_b64_tr_b16 a[212:213], v242 offset:51200
    v_cvt_pk_bf16_f32 v188, v188, v188
    v_and_b32 v196, 0xffff, v188
    ds_read_b64_tr_b16 a[214:215], v243 offset:51200
    v_lshlrev_b32 v197, 16, v188
    v_mul_f32 v198, -v180, v197
    ds_read_b64_tr_b16 a[216:217], v244 offset:2048
    v_cndmask_b32 v196, v196, v197, s[16:17]
    v_mov_b32 v180, v198
    ds_read_b64_tr_b16 a[218:219], v245 offset:2048
    v_cndmask_b32 v196, 0, v196, s[10:11]
    v_mov_b32 v181, v198
    ds_read_b64_tr_b16 a[220:221], v246 offset:2048
    v_cndmask_b32 v197, 0, v196, s[6:7]
    v_mov_b32 v182, v198
    ds_read_b64_tr_b16 a[222:223], v247 offset:2048
    v_cndmask_b32 v196, v196, 0, s[6:7]
    v_mov_b32 v183, v198
    s_waitcnt lgkmcnt(15)
    s_nop 0
    v_mfma_f32_16x16x16_bf16 v[200:203], a[184:185], v[196:197], v[180:183]
    ds_read_b64_tr_b16 a[224:225], v244 offset:18432
    v_mfma_f32_16x16x16_bf16 v[204:207], a[186:187], v[196:197], v[180:183]
    ds_read_b64_tr_b16 a[226:227], v245 offset:18432
    v_mfma_f32_16x16x16_bf16 v[208:211], a[188:189], v[196:197], v[180:183]
    ds_read_b64_tr_b16 a[228:229], v246 offset:18432
    s_nop 2
    v_cvt_pk_bf16_f32 v48, v200, v201
    v_cvt_pk_bf16_f32 v49, v202, v203
    v_mfma_f32_16x16x16_bf16 v[212:215], a[190:191], v[196:197], v[180:183]
    ds_read_b64_tr_b16 a[230:231], v247 offset:18432
    v_cvt_pk_bf16_f32 v50, v204, v205
    v_cvt_pk_bf16_f32 v51, v206, v207
    s_waitcnt lgkmcnt(15)
    v_mfma_f32_16x16x16_bf16 v[200:203], a[192:193], v[196:197], v[180:183]
    ds_read_b64_tr_b16 a[232:233], v244 offset:34816
    v_cvt_pk_bf16_f32 v56, v208, v209
    v_cvt_pk_bf16_f32 v57, v210, v211
    v_mfma_f32_16x16x16_bf16 v[204:207], a[194:195], v[196:197], v[180:183]
    ds_read_b64_tr_b16 a[234:235], v245 offset:34816
    v_cvt_pk_bf16_f32 v58, v212, v213
    v_cvt_pk_bf16_f32 v59, v214, v215
    v_mfma_f32_16x16x16_bf16 v[208:211], a[196:197], v[196:197], v[180:183]
    ds_read_b64_tr_b16 a[236:237], v246 offset:34816
    v_cvt_pk_bf16_f32 v64, v200, v201
    v_cvt_pk_bf16_f32 v65, v202, v203
    v_mfma_f32_16x16x16_bf16 v[212:215], a[198:199], v[196:197], v[180:183]
    ds_read_b64_tr_b16 a[238:239], v247 offset:34816
    v_cvt_pk_bf16_f32 v66, v204, v205
    v_cvt_pk_bf16_f32 v67, v206, v207
    s_waitcnt lgkmcnt(15)
    v_mfma_f32_16x16x16_bf16 v[200:203], a[200:201], v[196:197], v[180:183]
    s_waitcnt vmcnt(12)
    v_cvt_pk_bf16_f32 v72, v208, v209
    v_cvt_pk_bf16_f32 v73, v210, v211
    v_mfma_f32_16x16x16_bf16 v[204:207], a[202:203], v[196:197], v[180:183]
    s_barrier
    v_cvt_pk_bf16_f32 v74, v212, v213
    v_cvt_pk_bf16_f32 v75, v214, v215
    v_mfma_f32_16x16x16_bf16 v[208:211], a[204:205], v[196:197], v[180:183]
    ds_read_b64_tr_b16 a[0:1], v12 offset:49152
    v_cvt_pk_bf16_f32 v80, v200, v201
    v_cvt_pk_bf16_f32 v81, v202, v203
    v_mfma_f32_16x16x16_bf16 v[212:215], a[206:207], v[196:197], v[180:183]
    ds_read_b64_tr_b16 a[2:3], v12 offset:51200
    v_cvt_pk_bf16_f32 v82, v204, v205
    v_cvt_pk_bf16_f32 v83, v206, v207
    s_waitcnt lgkmcnt(14)
    v_mfma_f32_16x16x16_bf16 v[200:203], a[208:209], v[196:197], v[180:183]
    ds_read_b64_tr_b16 a[4:5], v12 offset:53248
    v_cvt_pk_bf16_f32 v88, v208, v209
    v_cvt_pk_bf16_f32 v89, v210, v211
    v_mfma_f32_16x16x16_bf16 v[204:207], a[210:211], v[196:197], v[180:183]
    ds_read_b64_tr_b16 a[6:7], v12 offset:55296
    v_cvt_pk_bf16_f32 v90, v212, v213
    v_cvt_pk_bf16_f32 v91, v214, v215
    v_mfma_f32_16x16x16_bf16 v[208:211], a[212:213], v[196:197], v[180:183]
    ds_read_b64_tr_b16 a[8:9], v13 offset:49152
    v_cvt_pk_bf16_f32 v96, v200, v201
    v_cvt_pk_bf16_f32 v97, v202, v203
    v_mfma_f32_16x16x16_bf16 v[212:215], a[214:215], v[196:197], v[180:183]
    ds_read_b64_tr_b16 a[10:11], v13 offset:51200
    v_cvt_pk_bf16_f32 v98, v204, v205
    v_cvt_pk_bf16_f32 v99, v206, v207
    s_waitcnt lgkmcnt(14)
    v_mfma_f32_16x16x16_bf16 v[200:203], a[216:217], v[196:197], v[180:183]
    ds_read_b64_tr_b16 a[12:13], v13 offset:53248
    v_cvt_pk_bf16_f32 v104, v208, v209
    v_cvt_pk_bf16_f32 v105, v210, v211
    v_mfma_f32_16x16x16_bf16 v[204:207], a[218:219], v[196:197], v[180:183]
    ds_read_b64_tr_b16 a[14:15], v13 offset:55296
    v_cvt_pk_bf16_f32 v106, v212, v213
    v_cvt_pk_bf16_f32 v107, v214, v215
    v_mfma_f32_16x16x16_bf16 v[208:211], a[220:221], v[196:197], v[180:183]
    ds_read_b64_tr_b16 a[16:17], v14 offset:49152
    v_cvt_pk_bf16_f32 v112, v200, v201
    v_cvt_pk_bf16_f32 v113, v202, v203
    v_mfma_f32_16x16x16_bf16 v[212:215], a[222:223], v[196:197], v[180:183]
    ds_read_b64_tr_b16 a[18:19], v14 offset:51200
    v_cvt_pk_bf16_f32 v114, v204, v205
    v_cvt_pk_bf16_f32 v115, v206, v207
    s_waitcnt lgkmcnt(14)
    v_mfma_f32_16x16x16_bf16 v[200:203], a[224:225], v[196:197], v[180:183]
    ds_read_b64_tr_b16 a[20:21], v14 offset:53248
    v_cvt_pk_bf16_f32 v120, v208, v209
    v_cvt_pk_bf16_f32 v121, v210, v211
    v_mfma_f32_16x16x16_bf16 v[204:207], a[226:227], v[196:197], v[180:183]
    ds_read_b64_tr_b16 a[22:23], v14 offset:55296
    v_cvt_pk_bf16_f32 v122, v212, v213
    v_cvt_pk_bf16_f32 v123, v214, v215
    v_mfma_f32_16x16x16_bf16 v[208:211], a[228:229], v[196:197], v[180:183]
    ds_read_b64_tr_b16 a[24:25], v15 offset:49152
    v_cvt_pk_bf16_f32 v128, v200, v201
    v_cvt_pk_bf16_f32 v129, v202, v203
    v_mfma_f32_16x16x16_bf16 v[212:215], a[230:231], v[196:197], v[180:183]
    ds_read_b64_tr_b16 a[26:27], v15 offset:51200
    v_cvt_pk_bf16_f32 v130, v204, v205
    v_cvt_pk_bf16_f32 v131, v206, v207
    s_waitcnt lgkmcnt(14)
    v_mfma_f32_16x16x16_bf16 v[200:203], a[232:233], v[196:197], v[180:183]
    ds_read_b64_tr_b16 a[28:29], v15 offset:53248
    v_cvt_pk_bf16_f32 v136, v208, v209
    v_cvt_pk_bf16_f32 v137, v210, v211
    v_mfma_f32_16x16x16_bf16 v[204:207], a[234:235], v[196:197], v[180:183]
    ds_read_b64_tr_b16 a[30:31], v15 offset:55296
    v_cvt_pk_bf16_f32 v138, v212, v213
    v_cvt_pk_bf16_f32 v139, v214, v215
    v_mfma_f32_16x16x16_bf16 v[208:211], a[236:237], v[196:197], v[180:183]
    v_cvt_pk_bf16_f32 v144, v200, v201
    v_cvt_pk_bf16_f32 v145, v202, v203
    v_mfma_f32_16x16x16_bf16 v[212:215], a[238:239], v[196:197], v[180:183]
    s_nop 0
    v_cvt_pk_bf16_f32 v146, v204, v205
    v_cvt_pk_bf16_f32 v147, v206, v207
    s_nop 1
    v_cvt_pk_bf16_f32 v152, v208, v209
    v_cvt_pk_bf16_f32 v153, v210, v211
    s_nop 0
    v_cvt_pk_bf16_f32 v154, v212, v213
    v_cvt_pk_bf16_f32 v155, v214, v215
    s_waitcnt lgkmcnt(8)
    v_mfma_f32_16x16x32_bf16 v[156:159], a[0:3], v[44:47], 0
    ds_read_b64_tr_b16 a[32:33], v12 offset:57344
    s_add_u32 m0, s67, 0
    v_mfma_f32_16x16x32_bf16 v[156:159], a[4:7], v[52:55], v[156:159]
    ds_read_b64_tr_b16 a[34:35], v12 offset:59392
    v_mfma_f32_16x16x32_bf16 v[160:163], a[8:11], v[44:47], 0
    ds_read_b64_tr_b16 a[36:37], v12 offset:61440
    s_add_u32 s71, s95, 0
    v_mfma_f32_16x16x32_bf16 v[160:163], a[12:15], v[52:55], v[160:163]
    ds_read_b64_tr_b16 a[38:39], v12 offset:63488
    s_sub_u32 s3, s71, 7
    v_mfma_f32_16x16x32_bf16 v[168:171], a[12:15], v[56:59], 0
    ds_read_b64_tr_b16 a[40:41], v13 offset:57344
    s_min_u32 s71, s71, s3
    v_mfma_f32_16x16x32_bf16 v[168:171], a[8:11], v[48:51], v[168:171]
    ds_read_b64_tr_b16 a[42:43], v13 offset:59392
    s_add_u32 s68, s13, 0
    v_mfma_f32_16x16x32_bf16 v[164:167], a[4:7], v[56:59], 0
    ds_read_b64_tr_b16 a[44:45], v13 offset:61440
    s_lshl_b32 s72, s71, 7
    v_mfma_f32_16x16x32_bf16 v[164:167], a[0:3], v[48:51], v[164:167]
    ds_read_b64_tr_b16 a[46:47], v13 offset:63488
    s_waitcnt lgkmcnt(8)
    v_mfma_f32_16x16x32_bf16 v[180:183], a[16:19], v[48:51], 0
    ds_read_b64_tr_b16 a[0:1], v14 offset:57344
    s_lshl_b32 s71, s71, 16
    v_mfma_f32_16x16x32_bf16 v[180:183], a[20:23], v[56:59], v[180:183]
    ds_read_b64_tr_b16 a[2:3], v14 offset:59392
    s_add_u32 s79, s88, s71
    v_mfma_f32_16x16x32_bf16 v[184:187], a[24:27], v[48:51], 0
    ds_read_b64_tr_b16 a[4:5], v14 offset:61440
    buffer_load_dwordx4 v32, s[36:39], s68 offen offset:0 sc1 lds
    v_mfma_f32_16x16x32_bf16 v[184:187], a[28:31], v[56:59], v[184:187]
    ds_read_b64_tr_b16 a[6:7], v14 offset:63488
    s_add_u32 s88, s88, s96
    v_mfma_f32_16x16x32_bf16 v[176:179], a[28:31], v[52:55], 0
    ds_read_b64_tr_b16 a[8:9], v15 offset:57344
    s_add_u32 s71, s95, 1
    v_mfma_f32_16x16x32_bf16 v[176:179], a[24:27], v[44:47], v[176:179]
    ds_read_b64_tr_b16 a[10:11], v15 offset:59392
    s_sub_u32 s3, s71, 7
    v_mfma_f32_16x16x32_bf16 v[172:175], a[20:23], v[52:55], 0
    ds_read_b64_tr_b16 a[12:13], v15 offset:61440
    s_min_u32 s71, s71, s3
    v_mfma_f32_16x16x32_bf16 v[172:175], a[16:19], v[44:47], v[172:175]
    ds_read_b64_tr_b16 a[14:15], v15 offset:63488
    s_waitcnt vmcnt(4) lgkmcnt(8)
    v_mfma_f32_16x16x32_bf16 v[156:159], a[32:35], v[60:63], v[156:159]
    s_barrier
    ds_read_b64_tr_b16 a[16:17], v16 offset:0
    v_mfma_f32_16x16x32_bf16 v[156:159], a[36:39], v[68:71], v[156:159]
    ds_read_b64_tr_b16 a[18:19], v16 offset:2048
    buffer_load_dwordx4 v33, s[36:39], s68 offen offset:1024 sc1 lds
    v_mfma_f32_16x16x32_bf16 v[160:163], a[40:43], v[60:63], v[160:163]
    ds_read_b64_tr_b16 a[20:21], v16 offset:4096
    s_lshl_b32 s73, s71, 7
L_pg0:
    s_cbranch_execz L_pg4
    v_mfma_f32_16x16x32_bf16 v[160:163], a[44:47], v[68:71], v[160:163]
    ds_read_b64_tr_b16 a[22:23], v16 offset:6144
    s_lshl_b32 s71, s71, 16
    v_mfma_f32_16x16x32_bf16 v[168:171], a[44:47], v[72:75], v[168:171]
    ds_read_b64_tr_b16 a[24:25], v17 offset:0
    buffer_load_dwordx4 v34, s[36:39], s68 offen offset:2048 sc1 lds
    v_mfma_f32_16x16x32_bf16 v[168:171], a[40:43], v[64:67], v[168:171]
    ds_read_b64_tr_b16 a[26:27], v17 offset:2048
    s_add_u32 s80, s88, s71
    v_mfma_f32_16x16x32_bf16 v[164:167], a[36:39], v[72:75], v[164:167]
    ds_read_b64_tr_b16 a[28:29], v17 offset:4096
    s_add_u32 s88, s88, s96
    v_mfma_f32_16x16x32_bf16 v[164:167], a[32:35], v[64:67], v[164:167]
    ds_read_b64_tr_b16 a[30:31], v17 offset:6144
    s_waitcnt lgkmcnt(8)
    v_mfma_f32_16x16x32_bf16 v[180:183], a[0:3], v[64:67], v[180:183]
    ds_read_b64_tr_b16 a[32:33], v18 offset:0
    s_add_u32 s71, s95, 2
    v_mfma_f32_16x16x32_bf16 v[180:183], a[4:7], v[72:75], v[180:183]
    ds_read_b64_tr_b16 a[34:35], v18 offset:2048
    buffer_load_dwordx4 v35, s[36:39], s68 offen offset:3072 sc1 lds
    v_mfma_f32_16x16x32_bf16 v[184:187], a[8:11], v[64:67], v[184:187]
    ds_read_b64_tr_b16 a[36:37], v18 offset:4096
    s_add_u32 m0, s67, 16384
    v_mfma_f32_16x16x32_bf16 v[184:187], a[12:15], v[72:75], v[184:187]
    ds_read_b64_tr_b16 a[38:39], v18 offset:6144
    s_sub_u32 s3, s71, 7
    v_mfma_f32_16x16x32_bf16 v[176:179], a[12:15], v[68:71], v[176:179]
    ds_read_b64_tr_b16 a[40:41], v19 offset:0
    s_add_u32 s68, s12, 524416
    v_mfma_f32_16x16x32_bf16 v[176:179], a[8:11], v[60:63], v[176:179]
    ds_read_b64_tr_b16 a[42:43], v19 offset:2048
    s_min_u32 s71, s71, s3
    v_mfma_f32_16x16x32_bf16 v[172:175], a[4:7], v[68:71], v[172:175]
    ds_read_b64_tr_b16 a[44:45], v19 offset:4096
    s_lshl_b32 s74, s71, 7
    v_mfma_f32_16x16x32_bf16 v[172:175], a[0:3], v[60:63], v[172:175]
    ds_read_b64_tr_b16 a[46:47], v19 offset:6144
    s_waitcnt lgkmcnt(8)
    v_mfma_f32_16x16x32_bf16 v[156:159], a[16:19], v[76:79], v[156:159]
    ds_read_b64_tr_b16 a[0:1], v16 offset:8192
    buffer_load_dwordx4 v32, s[36:39], s68 offen offset:0 sc1 lds
    v_mfma_f32_16x16x32_bf16 v[156:159], a[20:23], v[84:87], v[156:159]
    ds_read_b64_tr_b16 a[2:3], v16 offset:10240
    s_lshl_b32 s71, s71, 16
    v_mfma_f32_16x16x32_bf16 v[160:163], a[24:27], v[76:79], v[160:163]
    ds_read_b64_tr_b16 a[4:5], v16 offset:12288
    s_add_u32 s81, s88, s71
    v_mfma_f32_16x16x32_bf16 v[160:163], a[28:31], v[84:87], v[160:163]
    ds_read_b64_tr_b16 a[6:7], v16 offset:14336
    buffer_load_dwordx4 v33, s[36:39], s68 offen offset:1024 sc1 lds
    v_mfma_f32_16x16x32_bf16 v[168:171], a[28:31], v[88:91], v[168:171]
    ds_read_b64_tr_b16 a[8:9], v17 offset:8192
    s_add_u32 s88, s88, s96
    v_mfma_f32_16x16x32_bf16 v[168:171], a[24:27], v[80:83], v[168:171]
    ds_read_b64_tr_b16 a[10:11], v17 offset:10240
    s_add_u32 s71, s95, 3
    v_mfma_f32_16x16x32_bf16 v[164:167], a[20:23], v[88:91], v[164:167]
    ds_read_b64_tr_b16 a[12:13], v17 offset:12288
    buffer_load_dwordx4 v34, s[36:39], s68 offen offset:2048 sc1 lds
    v_mfma_f32_16x16x32_bf16 v[164:167], a[16:19], v[80:83], v[164:167]
    ds_read_b64_tr_b16 a[14:15], v17 offset:14336
    s_waitcnt lgkmcnt(8)
    v_mfma_f32_16x16x32_bf16 v[180:183], a[32:35], v[80:83], v[180:183]
    ds_read_b64_tr_b16 a[16:17], v18 offset:8192
    s_sub_u32 s3, s71, 7
    v_mfma_f32_16x16x32_bf16 v[180:183], a[36:39], v[88:91], v[180:183]
    ds_read_b64_tr_b16 a[18:19], v18 offset:10240
    buffer_load_dwordx4 v35, s[36:39], s68 offen offset:3072 sc1 lds
    v_mfma_f32_16x16x32_bf16 v[184:187], a[40:43], v[80:83], v[184:187]
    ds_read_b64_tr_b16 a[20:21], v18 offset:12288
    s_add_u32 m0, s67, 32768
    v_mfma_f32_16x16x32_bf16 v[184:187], a[44:47], v[88:91], v[184:187]
    ds_read_b64_tr_b16 a[22:23], v18 offset:14336
    s_min_u32 s71, s71, s3
    v_mfma_f32_16x16x32_bf16 v[176:179], a[44:47], v[84:87], v[176:179]
    ds_read_b64_tr_b16 a[24:25], v19 offset:8192
    s_add_u32 s68, s12, 1572992
    v_mfma_f32_16x16x32_bf16 v[176:179], a[40:43], v[76:79], v[176:179]
    ds_read_b64_tr_b16 a[26:27], v19 offset:10240
    s_lshl_b32 s75, s71, 7
    v_mfma_f32_16x16x32_bf16 v[172:175], a[36:39], v[84:87], v[172:175]
    ds_read_b64_tr_b16 a[28:29], v19 offset:12288
    s_lshl_b32 s71, s71, 16
    v_mfma_f32_16x16x32_bf16 v[172:175], a[32:35], v[76:79], v[172:175]
    ds_read_b64_tr_b16 a[30:31], v19 offset:14336
    s_waitcnt lgkmcnt(8)
    v_mfma_f32_16x16x32_bf16 v[156:159], a[0:3], v[92:95], v[156:159]
    ds_read_b64_tr_b16 a[32:33], v16 offset:16384
    buffer_load_dwordx4 v32, s[36:39], s68 offen offset:0 sc1 lds
    v_mfma_f32_16x16x32_bf16 v[156:159], a[4:7], v[100:103], v[156:159]
    ds_read_b64_tr_b16 a[34:35], v16 offset:18432
    s_add_u32 s82, s88, s71
    v_mfma_f32_16x16x32_bf16 v[160:163], a[8:11], v[92:95], v[160:163]
    ds_read_b64_tr_b16 a[36:37], v16 offset:20480
    s_add_u32 s88, s88, s96
    v_mfma_f32_16x16x32_bf16 v[160:163], a[12:15], v[100:103], v[160:163]
    ds_read_b64_tr_b16 a[38:39], v16 offset:22528
    buffer_load_dwordx4 v33, s[36:39], s68 offen offset:1024 sc1 lds
    v_mfma_f32_16x16x32_bf16 v[168:171], a[12:15], v[104:107], v[168:171]
    ds_read_b64_tr_b16 a[40:41], v17 offset:16384
    s_add_u32 s71, s95, 4
    v_mfma_f32_16x16x32_bf16 v[168:171], a[8:11], v[96:99], v[168:171]
    ds_read_b64_tr_b16 a[42:43], v17 offset:18432
    s_sub_u32 s3, s71, 7
    v_mfma_f32_16x16x32_bf16 v[164:167], a[4:7], v[104:107], v[164:167]
    ds_read_b64_tr_b16 a[44:45], v17 offset:20480
    buffer_load_dwordx4 v34, s[36:39], s68 offen offset:2048 sc1 lds
    v_mfma_f32_16x16x32_bf16 v[164:167], a[0:3], v[96:99], v[164:167]
    ds_read_b64_tr_b16 a[46:47], v17 offset:22528
    s_waitcnt lgkmcnt(8)
    v_mfma_f32_16x16x32_bf16 v[180:183], a[16:19], v[96:99], v[180:183]
    ds_read_b64_tr_b16 a[0:1], v18 offset:16384
    s_min_u32 s71, s71, s3
    v_mfma_f32_16x16x32_bf16 v[180:183], a[20:23], v[104:107], v[180:183]
    ds_read_b64_tr_b16 a[2:3], v18 offset:18432
    buffer_load_dwordx4 v35, s[36:39], s68 offen offset:3072 sc1 lds
    v_mfma_f32_16x16x32_bf16 v[184:187], a[24:27], v[96:99], v[184:187]
    ds_read_b64_tr_b16 a[4:5], v18 offset:20480
    s_add_u32 m0, s67, 49152
    v_mfma_f32_16x16x32_bf16 v[184:187], a[28:31], v[104:107], v[184:187]
    ds_read_b64_tr_b16 a[6:7], v18 offset:22528
    s_lshl_b32 s76, s71, 7
    v_mfma_f32_16x16x32_bf16 v[176:179], a[28:31], v[100:103], v[176:179]
    ds_read_b64_tr_b16 a[8:9], v19 offset:16384
    s_add_u32 s68, s12, 2621568
    v_mfma_f32_16x16x32_bf16 v[176:179], a[24:27], v[92:95], v[176:179]
    ds_read_b64_tr_b16 a[10:11], v19 offset:18432
    s_lshl_b32 s71, s71, 16
    v_mfma_f32_16x16x32_bf16 v[172:175], a[20:23], v[100:103], v[172:175]
    ds_read_b64_tr_b16 a[12:13], v19 offset:20480
    s_add_u32 s83, s88, s71
    v_mfma_f32_16x16x32_bf16 v[172:175], a[16:19], v[92:95], v[172:175]
    ds_read_b64_tr_b16 a[14:15], v19 offset:22528
    s_waitcnt lgkmcnt(8)
    v_mfma_f32_16x16x32_bf16 v[156:159], a[32:35], v[108:111], v[156:159]
    ds_read_b64_tr_b16 a[16:17], v16 offset:24576
    buffer_load_dwordx4 v32, s[36:39], s68 offen offset:0 sc1 lds
    v_mfma_f32_16x16x32_bf16 v[156:159], a[36:39], v[116:119], v[156:159]
    ds_read_b64_tr_b16 a[18:19], v16 offset:26624
    s_add_u32 s88, s88, s96
    v_mfma_f32_16x16x32_bf16 v[160:163], a[40:43], v[108:111], v[160:163]
    ds_read_b64_tr_b16 a[20:21], v16 offset:28672
    s_add_u32 s71, s95, 5
    v_mfma_f32_16x16x32_bf16 v[160:163], a[44:47], v[116:119], v[160:163]
    ds_read_b64_tr_b16 a[22:23], v16 offset:30720
    buffer_load_dwordx4 v33, s[36:39], s68 offen offset:1024 sc1 lds
    v_mfma_f32_16x16x32_bf16 v[168:171], a[44:47], v[120:123], v[168:171]
    ds_read_b64_tr_b16 a[24:25], v17 offset:24576
    s_sub_u32 s3, s71, 7
    v_mfma_f32_16x16x32_bf16 v[168:171], a[40:43], v[112:115], v[168:171]
    ds_read_b64_tr_b16 a[26:27], v17 offset:26624
    s_min_u32 s71, s71, s3
    v_mfma_f32_16x16x32_bf16 v[164:167], a[36:39], v[120:123], v[164:167]
    ds_read_b64_tr_b16 a[28:29], v17 offset:28672
    buffer_load_dwordx4 v34, s[36:39], s68 offen offset:2048 sc1 lds
    v_mfma_f32_16x16x32_bf16 v[164:167], a[32:35], v[112:115], v[164:167]
    ds_read_b64_tr_b16 a[30:31], v17 offset:30720
    s_waitcnt lgkmcnt(8)
    v_mfma_f32_16x16x32_bf16 v[180:183], a[0:3], v[112:115], v[180:183]
    ds_read_b64_tr_b16 a[32:33], v18 offset:24576
    s_lshl_b32 s77, s71, 7
    v_mfma_f32_16x16x32_bf16 v[180:183], a[4:7], v[120:123], v[180:183]
    ds_read_b64_tr_b16 a[34:35], v18 offset:26624
    buffer_load_dwordx4 v35, s[36:39], s68 offen offset:3072 sc1 lds
    v_mfma_f32_16x16x32_bf16 v[184:187], a[8:11], v[112:115], v[184:187]
    ds_read_b64_tr_b16 a[36:37], v18 offset:28672
    s_add_u32 m0, s67, 65536
    v_mfma_f32_16x16x32_bf16 v[184:187], a[12:15], v[120:123], v[184:187]
    ds_read_b64_tr_b16 a[38:39], v18 offset:30720
    s_lshl_b32 s71, s71, 16
    v_mfma_f32_16x16x32_bf16 v[176:179], a[12:15], v[116:119], v[176:179]
    ds_read_b64_tr_b16 a[40:41], v19 offset:24576
    s_add_u32 s68, s12, 256
    v_mfma_f32_16x16x32_bf16 v[176:179], a[8:11], v[108:111], v[176:179]
    ds_read_b64_tr_b16 a[42:43], v19 offset:26624
    s_add_u32 s84, s88, s71
    v_mfma_f32_16x16x32_bf16 v[172:175], a[4:7], v[116:119], v[172:175]
    ds_read_b64_tr_b16 a[44:45], v19 offset:28672
    s_add_u32 s88, s88, s96
    v_mfma_f32_16x16x32_bf16 v[172:175], a[0:3], v[108:111], v[172:175]
    ds_read_b64_tr_b16 a[46:47], v19 offset:30720
    s_waitcnt vmcnt(8) lgkmcnt(8)
    v_mfma_f32_16x16x32_bf16 v[156:159], a[16:19], v[124:127], v[156:159]
    s_barrier
    ds_read_b64_tr_b16 a[0:1], v8 offset:0
    v_mfma_f32_16x16x32_bf16 v[156:159], a[20:23], v[132:135], v[156:159]
    ds_read_b64_tr_b16 a[2:3], v8 offset:2048
    buffer_load_dwordx4 v32, s[36:39], s68 offen offset:0 sc1 lds
    v_mfma_f32_16x16x32_bf16 v[160:163], a[24:27], v[124:127], v[160:163]
    ds_read_b64_tr_b16 a[4:5], v8 offset:4096
    s_add_u32 s71, s95, 6
    v_mfma_f32_16x16x32_bf16 v[160:163], a[28:31], v[132:135], v[160:163]
    ds_read_b64_tr_b16 a[6:7], v8 offset:6144
    buffer_load_dwordx4 v33, s[36:39], s68 offen offset:1024 sc1 lds
    v_mfma_f32_16x16x32_bf16 v[168:171], a[28:31], v[136:139], v[168:171]
    ds_read_b64_tr_b16 a[8:9], v9 offset:0
    s_sub_u32 s3, s71, 7
    v_mfma_f32_16x16x32_bf16 v[168:171], a[24:27], v[128:131], v[168:171]
    ds_read_b64_tr_b16 a[10:11], v9 offset:2048
    s_min_u32 s71, s71, s3
    v_mfma_f32_16x16x32_bf16 v[164:167], a[20:23], v[136:139], v[164:167]
    ds_read_b64_tr_b16 a[12:13], v9 offset:4096
    buffer_load_dwordx4 v34, s[36:39], s68 offen offset:2048 sc1 lds
    v_mfma_f32_16x16x32_bf16 v[164:167], a[16:19], v[128:131], v[164:167]
    ds_read_b64_tr_b16 a[14:15], v9 offset:6144
    s_waitcnt lgkmcnt(8)
    v_mfma_f32_16x16x32_bf16 v[180:183], a[32:35], v[128:131], v[180:183]
    ds_read_b64_tr_b16 a[16:17], v10 offset:0
    s_lshl_b32 s78, s71, 7
    v_mfma_f32_16x16x32_bf16 v[180:183], a[36:39], v[136:139], v[180:183]
    ds_read_b64_tr_b16 a[18:19], v10 offset:2048
    buffer_load_dwordx4 v35, s[36:39], s68 offen offset:3072 sc1 lds
    v_mfma_f32_16x16x32_bf16 v[184:187], a[40:43], v[128:131], v[184:187]
    ds_read_b64_tr_b16 a[20:21], v10 offset:4096
    s_add_u32 m0, s67, 81920
    v_mfma_f32_16x16x32_bf16 v[184:187], a[44:47], v[136:139], v[184:187]
    ds_read_b64_tr_b16 a[22:23], v10 offset:6144
    s_lshl_b32 s71, s71, 16
    v_mfma_f32_16x16x32_bf16 v[176:179], a[44:47], v[132:135], v[176:179]
    ds_read_b64_tr_b16 a[24:25], v11 offset:0
    s_add_u32 s68, s12, 1048832
    v_mfma_f32_16x16x32_bf16 v[176:179], a[40:43], v[124:127], v[176:179]
    ds_read_b64_tr_b16 a[26:27], v11 offset:2048
    s_add_u32 s85, s88, s71
    v_mfma_f32_16x16x32_bf16 v[172:175], a[36:39], v[132:135], v[172:175]
    ds_read_b64_tr_b16 a[28:29], v11 offset:4096
    s_add_u32 s88, s88, s96
    v_mfma_f32_16x16x32_bf16 v[172:175], a[32:35], v[124:127], v[172:175]
    ds_read_b64_tr_b16 a[30:31], v11 offset:6144
    s_waitcnt lgkmcnt(8)
    v_mfma_f32_16x16x32_bf16 v[156:159], a[0:3], v[140:143], v[156:159]
    ds_read_b64_tr_b16 a[32:33], v8 offset:8192
    buffer_load_dwordx4 v32, s[36:39], s68 offen offset:0 sc1 lds
    v_mfma_f32_16x16x32_bf16 v[156:159], a[4:7], v[148:151], v[156:159]
    ds_read_b64_tr_b16 a[34:35], v8 offset:10240
    v_mfma_f32_16x16x32_bf16 v[160:163], a[8:11], v[140:143], v[160:163]
    ds_read_b64_tr_b16 a[36:37], v8 offset:12288
    v_mfma_f32_16x16x32_bf16 v[160:163], a[12:15], v[148:151], v[160:163]
    ds_read_b64_tr_b16 a[38:39], v8 offset:14336
    buffer_load_dwordx4 v33, s[36:39], s68 offen offset:1024 sc1 lds
    v_mfma_f32_16x16x32_bf16 v[168:171], a[12:15], v[152:155], v[168:171]
    ds_read_b64_tr_b16 a[40:41], v9 offset:8192
    v_lshrrev_b32 v26, 2, v0
    v_mfma_f32_16x16x32_bf16 v[168:171], a[8:11], v[144:147], v[168:171]
    ds_read_b64_tr_b16 a[42:43], v9 offset:10240
    s_lshl_b32 s93, s64, 4
    v_mfma_f32_16x16x32_bf16 v[164:167], a[4:7], v[152:155], v[164:167]
    ds_read_b64_tr_b16 a[44:45], v9 offset:12288
    buffer_load_dwordx4 v34, s[36:39], s68 offen offset:2048 sc1 lds
    v_mfma_f32_16x16x32_bf16 v[164:167], a[0:3], v[144:147], v[164:167]
    ds_read_b64_tr_b16 a[46:47], v9 offset:14336
    s_waitcnt lgkmcnt(8)
    v_mfma_f32_16x16x32_bf16 v[180:183], a[16:19], v[144:147], v[180:183]
    ds_read_b64_tr_b16 a[0:1], v10 offset:8192
    v_add_u32 v26, s93, v26
    v_mfma_f32_16x16x32_bf16 v[180:183], a[20:23], v[152:155], v[180:183]
    ds_read_b64_tr_b16 a[2:3], v10 offset:10240
    buffer_load_dwordx4 v35, s[36:39], s68 offen offset:3072 sc1 lds
    v_mfma_f32_16x16x32_bf16 v[184:187], a[24:27], v[144:147], v[184:187]
    ds_read_b64_tr_b16 a[4:5], v10 offset:12288
    s_add_u32 m0, s67, 98304
    v_mfma_f32_16x16x32_bf16 v[184:187], a[28:31], v[152:155], v[184:187]
    ds_read_b64_tr_b16 a[6:7], v10 offset:14336
    v_mfma_f32_16x16x32_bf16 v[176:179], a[28:31], v[148:151], v[176:179]
    ds_read_b64_tr_b16 a[8:9], v11 offset:8192
    s_add_u32 s68, s12, 2097408
    v_mfma_f32_16x16x32_bf16 v[176:179], a[24:27], v[140:143], v[176:179]
    ds_read_b64_tr_b16 a[10:11], v11 offset:10240
    v_mfma_f32_16x16x32_bf16 v[172:175], a[20:23], v[148:151], v[172:175]
    ds_read_b64_tr_b16 a[12:13], v11 offset:12288
    v_mfma_f32_16x16x32_bf16 v[172:175], a[16:19], v[140:143], v[172:175]
    ds_read_b64_tr_b16 a[14:15], v11 offset:14336
    s_waitcnt lgkmcnt(8)
    v_mfma_f32_16x16x32_bf16 v[188:191], a[32:35], v[44:47], 0
    ds_read_b64_tr_b16 a[16:17], v8 offset:16384
    buffer_load_dwordx4 v32, s[36:39], s68 offen offset:0 sc1 lds
    v_mfma_f32_16x16x32_bf16 v[188:191], a[36:39], v[52:55], v[188:191]
    ds_read_b64_tr_b16 a[18:19], v8 offset:18432
    v_mfma_f32_16x16x32_bf16 v[192:195], a[40:43], v[44:47], 0
    ds_read_b64_tr_b16 a[20:21], v8 offset:20480
    v_mfma_f32_16x16x32_bf16 v[192:195], a[44:47], v[52:55], v[192:195]
    ds_read_b64_tr_b16 a[22:23], v8 offset:22528
    buffer_load_dwordx4 v33, s[36:39], s68 offen offset:1024 sc1 lds
    v_mfma_f32_16x16x32_bf16 v[200:203], a[44:47], v[56:59], 0
    ds_read_b64_tr_b16 a[24:25], v9 offset:16384
    v_cvt_pk_bf16_f32 v156, v156, v157
    v_mfma_f32_16x16x32_bf16 v[200:203], a[40:43], v[48:51], v[200:203]
    ds_read_b64_tr_b16 a[26:27], v9 offset:18432
    v_cvt_pk_bf16_f32 v157, v158, v159
    v_mfma_f32_16x16x32_bf16 v[196:199], a[36:39], v[56:59], 0
    ds_read_b64_tr_b16 a[28:29], v9 offset:20480
    buffer_load_dwordx4 v34, s[36:39], s68 offen offset:2048 sc1 lds
    v_mfma_f32_16x16x32_bf16 v[196:199], a[32:35], v[48:51], v[196:199]
    ds_read_b64_tr_b16 a[30:31], v9 offset:22528
    s_waitcnt lgkmcnt(8)
    v_mfma_f32_16x16x32_bf16 v[212:215], a[0:3], v[48:51], 0
    ds_read_b64_tr_b16 a[32:33], v10 offset:16384
    v_cvt_pk_bf16_f32 v158, v160, v161
    v_mfma_f32_16x16x32_bf16 v[212:215], a[4:7], v[56:59], v[212:215]
    ds_read_b64_tr_b16 a[34:35], v10 offset:18432
    buffer_load_dwordx4 v35, s[36:39], s68 offen offset:3072 sc1 lds
    v_mfma_f32_16x16x32_bf16 v[216:219], a[8:11], v[48:51], 0
    ds_read_b64_tr_b16 a[36:37], v10 offset:20480
    s_add_u32 m0, s67, 114688
    v_mfma_f32_16x16x32_bf16 v[216:219], a[12:15], v[56:59], v[216:219]
    ds_read_b64_tr_b16 a[38:39], v10 offset:22528
    v_cvt_pk_bf16_f32 v159, v162, v163
    v_mfma_f32_16x16x32_bf16 v[208:211], a[12:15], v[52:55], 0
    ds_read_b64_tr_b16 a[40:41], v11 offset:16384
    s_add_u32 s68, s13, 256
    v_mfma_f32_16x16x32_bf16 v[208:211], a[8:11], v[44:47], v[208:211]
    ds_read_b64_tr_b16 a[42:43], v11 offset:18432
    v_permlane32_swap_b32 v156, v158
    v_mfma_f32_16x16x32_bf16 v[204:207], a[4:7], v[52:55], 0
    ds_read_b64_tr_b16 a[44:45], v11 offset:20480
    v_permlane32_swap_b32 v157, v159
    v_mfma_f32_16x16x32_bf16 v[204:207], a[0:3], v[44:47], v[204:207]
    ds_read_b64_tr_b16 a[46:47], v11 offset:22528
    s_waitcnt lgkmcnt(8)
    v_mfma_f32_16x16x32_bf16 v[188:191], a[16:19], v[60:63], v[188:191]
    ds_read_b64_tr_b16 a[0:1], v8 offset:24576
    buffer_load_dwordx4 v32, s[36:39], s68 offen offset:0 sc1 lds
    v_mfma_f32_16x16x32_bf16 v[188:191], a[20:23], v[68:71], v[188:191]
    ds_read_b64_tr_b16 a[2:3], v8 offset:26624
    v_permlane16_swap_b32 v156, v158
    v_mfma_f32_16x16x32_bf16 v[192:195], a[24:27], v[60:63], v[192:195]
    ds_read_b64_tr_b16 a[4:5], v8 offset:28672
    v_permlane16_swap_b32 v157, v159
    v_mfma_f32_16x16x32_bf16 v[192:195], a[28:31], v[68:71], v[192:195]
    ds_read_b64_tr_b16 a[6:7], v8 offset:30720
    buffer_load_dwordx4 v33, s[36:39], s68 offen offset:1024 sc1 lds
    v_mfma_f32_16x16x32_bf16 v[200:203], a[28:31], v[72:75], v[200:203]
    ds_read_b64_tr_b16 a[8:9], v9 offset:24576
    v_accvgpr_write_b32 a64, v156
    v_mfma_f32_16x16x32_bf16 v[200:203], a[24:27], v[64:67], v[200:203]
    ds_read_b64_tr_b16 a[10:11], v9 offset:26624
    v_accvgpr_write_b32 a65, v157
    v_mfma_f32_16x16x32_bf16 v[196:199], a[20:23], v[72:75], v[196:199]
    ds_read_b64_tr_b16 a[12:13], v9 offset:28672
    buffer_load_dwordx4 v34, s[36:39], s68 offen offset:2048 sc1 lds
    v_mfma_f32_16x16x32_bf16 v[196:199], a[16:19], v[64:67], v[196:199]
    ds_read_b64_tr_b16 a[14:15], v9 offset:30720
    s_waitcnt lgkmcnt(8)
    v_mfma_f32_16x16x32_bf16 v[212:215], a[32:35], v[64:67], v[212:215]
    ds_read_b64_tr_b16 a[16:17], v10 offset:24576
    v_accvgpr_write_b32 a66, v158
    v_mfma_f32_16x16x32_bf16 v[212:215], a[36:39], v[72:75], v[212:215]
    ds_read_b64_tr_b16 a[18:19], v10 offset:26624
    buffer_load_dwordx4 v35, s[36:39], s68 offen offset:3072 sc1 lds
    v_mfma_f32_16x16x32_bf16 v[216:219], a[40:43], v[64:67], v[216:219]
    ds_read_b64_tr_b16 a[20:21], v10 offset:28672
    s_add_u32 m0, s67, 131072
    v_mfma_f32_16x16x32_bf16 v[216:219], a[44:47], v[72:75], v[216:219]
    ds_read_b64_tr_b16 a[22:23], v10 offset:30720
    v_accvgpr_write_b32 a67, v159
    v_mfma_f32_16x16x32_bf16 v[208:211], a[44:47], v[68:71], v[208:211]
    ds_read_b64_tr_b16 a[24:25], v11 offset:24576
    s_add_u32 s68, s12, 524672
    v_mfma_f32_16x16x32_bf16 v[208:211], a[40:43], v[60:63], v[208:211]
    ds_read_b64_tr_b16 a[26:27], v11 offset:26624
    v_cvt_pk_bf16_f32 v164, v164, v165
    v_mfma_f32_16x16x32_bf16 v[204:207], a[36:39], v[68:71], v[204:207]
    ds_read_b64_tr_b16 a[28:29], v11 offset:28672
    v_cvt_pk_bf16_f32 v165, v166, v167
    v_mfma_f32_16x16x32_bf16 v[204:207], a[32:35], v[60:63], v[204:207]
    ds_read_b64_tr_b16 a[30:31], v11 offset:30720
    s_waitcnt vmcnt(16) lgkmcnt(8)
    v_mfma_f32_16x16x32_bf16 v[188:191], a[0:3], v[76:79], v[188:191]
    s_barrier
    ds_read_b64_tr_b16 a[32:33], v8 offset:32768
    v_mfma_f32_16x16x32_bf16 v[188:191], a[4:7], v[84:87], v[188:191]
    ds_read_b64_tr_b16 a[34:35], v8 offset:34816
    buffer_load_dwordx4 v32, s[36:39], s68 offen offset:0 sc1 lds
    v_mfma_f32_16x16x32_bf16 v[192:195], a[8:11], v[76:79], v[192:195]
    ds_read_b64_tr_b16 a[36:37], v8 offset:36864
    v_cvt_pk_bf16_f32 v166, v168, v169
    v_mfma_f32_16x16x32_bf16 v[192:195], a[12:15], v[84:87], v[192:195]
    ds_read_b64_tr_b16 a[38:39], v8 offset:38912
    buffer_load_dwordx4 v33, s[36:39], s68 offen offset:1024 sc1 lds
    v_mfma_f32_16x16x32_bf16 v[200:203], a[12:15], v[88:91], v[200:203]
    ds_read_b64_tr_b16 a[40:41], v9 offset:32768
    v_cvt_pk_bf16_f32 v167, v170, v171
    v_mfma_f32_16x16x32_bf16 v[200:203], a[8:11], v[80:83], v[200:203]
    ds_read_b64_tr_b16 a[42:43], v9 offset:34816
    v_permlane32_swap_b32 v164, v166
    v_mfma_f32_16x16x32_bf16 v[196:199], a[4:7], v[88:91], v[196:199]
    ds_read_b64_tr_b16 a[44:45], v9 offset:36864
    buffer_load_dwordx4 v34, s[36:39], s68 offen offset:2048 sc1 lds
    v_mfma_f32_16x16x32_bf16 v[196:199], a[0:3], v[80:83], v[196:199]
    ds_read_b64_tr_b16 a[46:47], v9 offset:38912
    s_waitcnt lgkmcnt(8)
    v_mfma_f32_16x16x32_bf16 v[212:215], a[16:19], v[80:83], v[212:215]
    ds_read_b64_tr_b16 a[0:1], v10 offset:32768
    v_permlane32_swap_b32 v165, v167
    v_mfma_f32_16x16x32_bf16 v[212:215], a[20:23], v[88:91], v[212:215]
    ds_read_b64_tr_b16 a[2:3], v10 offset:34816
    buffer_load_dwordx4 v35, s[36:39], s68 offen offset:3072 sc1 lds
    v_mfma_f32_16x16x32_bf16 v[216:219], a[24:27], v[80:83], v[216:219]
    ds_read_b64_tr_b16 a[4:5], v10 offset:36864
    s_add_u32 m0, s67, 147456
    v_mfma_f32_16x16x32_bf16 v[216:219], a[28:31], v[88:91], v[216:219]
    ds_read_b64_tr_b16 a[6:7], v10 offset:38912
    v_permlane16_swap_b32 v164, v166
    v_mfma_f32_16x16x32_bf16 v[208:211], a[28:31], v[84:87], v[208:211]
    ds_read_b64_tr_b16 a[8:9], v11 offset:32768
    v_permlane16_swap_b32 v165, v167
    v_mfma_f32_16x16x32_bf16 v[208:211], a[24:27], v[76:79], v[208:211]
    ds_read_b64_tr_b16 a[10:11], v11 offset:34816
    v_accvgpr_write_b32 a68, v164
    v_mfma_f32_16x16x32_bf16 v[204:207], a[20:23], v[84:87], v[204:207]
    ds_read_b64_tr_b16 a[12:13], v11 offset:36864
    s_add_u32 s68, s12, 1573248
    v_mfma_f32_16x16x32_bf16 v[204:207], a[16:19], v[76:79], v[204:207]
    ds_read_b64_tr_b16 a[14:15], v11 offset:38912
    s_waitcnt lgkmcnt(8)
    v_mfma_f32_16x16x32_bf16 v[188:191], a[32:35], v[92:95], v[188:191]
    ds_read_b64_tr_b16 a[16:17], v8 offset:40960
    v_accvgpr_write_b32 a69, v165
    v_mfma_f32_16x16x32_bf16 v[188:191], a[36:39], v[100:103], v[188:191]
    ds_read_b64_tr_b16 a[18:19], v8 offset:43008
    v_accvgpr_write_b32 a70, v166
    v_mfma_f32_16x16x32_bf16 v[192:195], a[40:43], v[92:95], v[192:195]
    ds_read_b64_tr_b16 a[20:21], v8 offset:45056
    v_accvgpr_write_b32 a71, v167
    v_mfma_f32_16x16x32_bf16 v[192:195], a[44:47], v[100:103], v[192:195]
    ds_read_b64_tr_b16 a[22:23], v8 offset:47104
    buffer_load_dwordx4 v32, s[36:39], s68 offen offset:0 sc1 lds
    v_mfma_f32_16x16x32_bf16 v[200:203], a[44:47], v[104:107], v[200:203]
    ds_read_b64_tr_b16 a[24:25], v9 offset:40960
    v_cvt_pk_bf16_f32 v172, v172, v173
    v_mfma_f32_16x16x32_bf16 v[200:203], a[40:43], v[96:99], v[200:203]
    ds_read_b64_tr_b16 a[26:27], v9 offset:43008
    v_cvt_pk_bf16_f32 v173, v174, v175
    v_mfma_f32_16x16x32_bf16 v[196:199], a[36:39], v[104:107], v[196:199]
    ds_read_b64_tr_b16 a[28:29], v9 offset:45056
    v_cvt_pk_bf16_f32 v174, v176, v177
    v_mfma_f32_16x16x32_bf16 v[196:199], a[32:35], v[96:99], v[196:199]
    ds_read_b64_tr_b16 a[30:31], v9 offset:47104
    s_waitcnt lgkmcnt(8)
    v_mfma_f32_16x16x32_bf16 v[212:215], a[0:3], v[96:99], v[212:215]
    ds_read_b64_tr_b16 a[32:33], v10 offset:40960
    buffer_load_dwordx4 v33, s[36:39], s68 offen offset:1024 sc1 lds
    v_mfma_f32_16x16x32_bf16 v[212:215], a[4:7], v[104:107], v[212:215]
    ds_read_b64_tr_b16 a[34:35], v10 offset:43008
    v_cvt_pk_bf16_f32 v175, v178, v179
    v_mfma_f32_16x16x32_bf16 v[216:219], a[8:11], v[96:99], v[216:219]
    ds_read_b64_tr_b16 a[36:37], v10 offset:45056
    s_mul_i32 s93, s25, 128
    v_mfma_f32_16x16x32_bf16 v[216:219], a[12:15], v[104:107], v[216:219]
    ds_read_b64_tr_b16 a[38:39], v10 offset:47104
    v_add_u32 v27, s93, v26
    v_mfma_f32_16x16x32_bf16 v[208:211], a[12:15], v[100:103], v[208:211]
    ds_read_b64_tr_b16 a[40:41], v11 offset:40960
    v_mul_u32_u24 v27, 128, v27
    v_mfma_f32_16x16x32_bf16 v[208:211], a[8:11], v[92:95], v[208:211]
    ds_read_b64_tr_b16 a[42:43], v11 offset:43008
    buffer_load_dwordx4 v34, s[36:39], s68 offen offset:2048 sc1 lds
    v_mfma_f32_16x16x32_bf16 v[204:207], a[4:7], v[100:103], v[204:207]
    ds_read_b64_tr_b16 a[44:45], v11 offset:45056
    s_mov_b32 s93, 0
    v_mfma_f32_16x16x32_bf16 v[204:207], a[0:3], v[92:95], v[204:207]
    ds_read_b64_tr_b16 a[46:47], v11 offset:47104
    s_waitcnt lgkmcnt(8)
    v_mfma_f32_16x16x32_bf16 v[188:191], a[16:19], v[108:111], v[188:191]
    ds_read_b64_tr_b16 a[0:1], v8 offset:49152
    buffer_load_dword a58, v27, s[40:43], s93 offen
    v_mfma_f32_16x16x32_bf16 v[188:191], a[20:23], v[116:119], v[188:191]
    ds_read_b64_tr_b16 a[2:3], v8 offset:51200
    v_permlane32_swap_b32 v172, v174
    v_mfma_f32_16x16x32_bf16 v[192:195], a[24:27], v[108:111], v[192:195]
    ds_read_b64_tr_b16 a[4:5], v8 offset:53248
    buffer_load_dwordx4 v35, s[36:39], s68 offen offset:3072 sc1 lds
    v_mfma_f32_16x16x32_bf16 v[192:195], a[28:31], v[116:119], v[192:195]
    ds_read_b64_tr_b16 a[6:7], v8 offset:55296
    s_add_u32 m0, s67, 0
    v_mfma_f32_16x16x32_bf16 v[200:203], a[28:31], v[120:123], v[200:203]
    ds_read_b64_tr_b16 a[8:9], v9 offset:49152
    v_permlane32_swap_b32 v173, v175
    v_mfma_f32_16x16x32_bf16 v[200:203], a[24:27], v[112:115], v[200:203]
    ds_read_b64_tr_b16 a[10:11], v9 offset:51200
    s_add_u32 s68, s12, 2621824
    v_mfma_f32_16x16x32_bf16 v[196:199], a[20:23], v[120:123], v[196:199]
    ds_read_b64_tr_b16 a[12:13], v9 offset:53248
    v_permlane16_swap_b32 v172, v174
    v_permlane16_swap_b32 v173, v175
    v_mfma_f32_16x16x32_bf16 v[196:199], a[16:19], v[112:115], v[196:199]
    ds_read_b64_tr_b16 a[14:15], v9 offset:55296
    s_waitcnt lgkmcnt(8)
    v_mfma_f32_16x16x32_bf16 v[212:215], a[32:35], v[112:115], v[212:215]
    ds_read_b64_tr_b16 a[16:17], v10 offset:49152
    buffer_load_dwordx4 v32, s[36:39], s68 offen offset:0 sc1 lds
    v_mfma_f32_16x16x32_bf16 v[212:215], a[36:39], v[120:123], v[212:215]
    ds_read_b64_tr_b16 a[18:19], v10 offset:51200
    v_accvgpr_write_b32 a72, v172
    v_mfma_f32_16x16x32_bf16 v[216:219], a[40:43], v[112:115], v[216:219]
    ds_read_b64_tr_b16 a[20:21], v10 offset:53248
    v_accvgpr_write_b32 a73, v173
    v_mfma_f32_16x16x32_bf16 v[216:219], a[44:47], v[120:123], v[216:219]
    ds_read_b64_tr_b16 a[22:23], v10 offset:55296
    v_accvgpr_write_b32 a74, v174
    v_mfma_f32_16x16x32_bf16 v[208:211], a[44:47], v[116:119], v[208:211]
    ds_read_b64_tr_b16 a[24:25], v11 offset:49152
    buffer_load_dwordx4 v33, s[36:39], s68 offen offset:1024 sc1 lds
    v_mfma_f32_16x16x32_bf16 v[208:211], a[40:43], v[108:111], v[208:211]
    ds_read_b64_tr_b16 a[26:27], v11 offset:51200
    v_accvgpr_write_b32 a75, v175
    v_mfma_f32_16x16x32_bf16 v[204:207], a[36:39], v[116:119], v[204:207]
    ds_read_b64_tr_b16 a[28:29], v11 offset:53248
    v_cvt_pk_bf16_f32 v180, v180, v181
    v_mfma_f32_16x16x32_bf16 v[204:207], a[32:35], v[108:111], v[204:207]
    ds_read_b64_tr_b16 a[30:31], v11 offset:55296
    s_waitcnt lgkmcnt(8)
    v_mfma_f32_16x16x32_bf16 v[188:191], a[0:3], v[124:127], v[188:191]
    ds_read_b64_tr_b16 a[32:33], v8 offset:57344
    buffer_load_dwordx4 v34, s[36:39], s68 offen offset:2048 sc1 lds
    v_mfma_f32_16x16x32_bf16 v[188:191], a[4:7], v[132:135], v[188:191]
    ds_read_b64_tr_b16 a[34:35], v8 offset:59392
    v_cvt_pk_bf16_f32 v181, v182, v183
    v_mfma_f32_16x16x32_bf16 v[192:195], a[8:11], v[124:127], v[192:195]
    ds_read_b64_tr_b16 a[36:37], v8 offset:61440
    buffer_load_dwordx4 v35, s[36:39], s68 offen offset:3072 sc1 lds
    v_mfma_f32_16x16x32_bf16 v[192:195], a[12:15], v[132:135], v[192:195]
    ds_read_b64_tr_b16 a[38:39], v8 offset:63488
    v_cvt_pk_bf16_f32 v182, v184, v185
    v_mfma_f32_16x16x32_bf16 v[200:203], a[12:15], v[136:139], v[200:203]
    ds_read_b64_tr_b16 a[40:41], v9 offset:57344
    v_cvt_pk_bf16_f32 v183, v186, v187
    v_mfma_f32_16x16x32_bf16 v[200:203], a[8:11], v[128:131], v[200:203]
    ds_read_b64_tr_b16 a[42:43], v9 offset:59392
    v_permlane32_swap_b32 v180, v182
    v_mfma_f32_16x16x32_bf16 v[196:199], a[4:7], v[136:139], v[196:199]
    ds_read_b64_tr_b16 a[44:45], v9 offset:61440
    v_permlane32_swap_b32 v181, v183
    v_mfma_f32_16x16x32_bf16 v[196:199], a[0:3], v[128:131], v[196:199]
    ds_read_b64_tr_b16 a[46:47], v9 offset:63488
    s_waitcnt lgkmcnt(8)
    v_mfma_f32_16x16x32_bf16 v[212:215], a[16:19], v[128:131], v[212:215]
    ds_read_b64_tr_b16 a[0:1], v10 offset:57344
    v_permlane16_swap_b32 v180, v182
    v_mfma_f32_16x16x32_bf16 v[212:215], a[20:23], v[136:139], v[212:215]
    ds_read_b64_tr_b16 a[2:3], v10 offset:59392
    v_permlane16_swap_b32 v181, v183
    v_mfma_f32_16x16x32_bf16 v[216:219], a[24:27], v[128:131], v[216:219]
    ds_read_b64_tr_b16 a[4:5], v10 offset:61440
    v_accvgpr_write_b32 a76, v180
    v_mfma_f32_16x16x32_bf16 v[216:219], a[28:31], v[136:139], v[216:219]
    ds_read_b64_tr_b16 a[6:7], v10 offset:63488
    v_accvgpr_write_b32 a77, v181
    v_mfma_f32_16x16x32_bf16 v[208:211], a[28:31], v[132:135], v[208:211]
    ds_read_b64_tr_b16 a[8:9], v11 offset:57344
    v_accvgpr_write_b32 a78, v182
L_pg1:
    s_cbranch_execz L_pg5
    v_mfma_f32_16x16x32_bf16 v[208:211], a[24:27], v[124:127], v[208:211]
    ds_read_b64_tr_b16 a[10:11], v11 offset:59392
    v_accvgpr_write_b32 a79, v183
    v_mfma_f32_16x16x32_bf16 v[204:207], a[20:23], v[132:135], v[204:207]
    ds_read_b64_tr_b16 a[12:13], v11 offset:61440
    v_mfma_f32_16x16x32_bf16 v[204:207], a[16:19], v[124:127], v[204:207]
    ds_read_b64_tr_b16 a[14:15], v11 offset:63488
    s_waitcnt vmcnt(21) lgkmcnt(8)
    v_mfma_f32_16x16x32_bf16 v[188:191], a[32:35], v[140:143], v[188:191]
    s_barrier
    ds_read_b64_tr_b16 a[16:17], v12 offset:0
    v_mfma_f32_16x16x32_bf16 v[188:191], a[36:39], v[148:151], v[188:191]
    ds_read_b64_tr_b16 a[18:19], v12 offset:2048
    s_add_u32 m0, s67, 16384
    v_mfma_f32_16x16x32_bf16 v[192:195], a[40:43], v[140:143], v[192:195]
    ds_read_b64_tr_b16 a[20:21], v12 offset:4096
    v_mfma_f32_16x16x32_bf16 v[192:195], a[44:47], v[148:151], v[192:195]
    ds_read_b64_tr_b16 a[22:23], v12 offset:6144
    v_mfma_f32_16x16x32_bf16 v[200:203], a[44:47], v[152:155], v[200:203]
    ds_read_b64_tr_b16 a[24:25], v13 offset:0
    v_mfma_f32_16x16x32_bf16 v[200:203], a[40:43], v[144:147], v[200:203]
    ds_read_b64_tr_b16 a[26:27], v13 offset:2048
    v_mfma_f32_16x16x32_bf16 v[196:199], a[36:39], v[152:155], v[196:199]
    ds_read_b64_tr_b16 a[28:29], v13 offset:4096
    s_add_u32 s68, s14, 0
    v_mfma_f32_16x16x32_bf16 v[196:199], a[32:35], v[144:147], v[196:199]
    ds_read_b64_tr_b16 a[30:31], v13 offset:6144
    s_waitcnt lgkmcnt(8)
    v_mfma_f32_16x16x32_bf16 v[212:215], a[0:3], v[144:147], v[212:215]
    ds_read_b64_tr_b16 a[32:33], v14 offset:0
    v_mfma_f32_16x16x32_bf16 v[212:215], a[4:7], v[152:155], v[212:215]
    ds_read_b64_tr_b16 a[34:35], v14 offset:2048
    v_mfma_f32_16x16x32_bf16 v[216:219], a[8:11], v[144:147], v[216:219]
    ds_read_b64_tr_b16 a[36:37], v14 offset:4096
    v_mfma_f32_16x16x32_bf16 v[216:219], a[12:15], v[152:155], v[216:219]
    ds_read_b64_tr_b16 a[38:39], v14 offset:6144
    buffer_load_dwordx4 v220, s[32:35], s68 offen offset:0 sc1 lds
    v_mfma_f32_16x16x32_bf16 v[208:211], a[12:15], v[148:151], v[208:211]
    ds_read_b64_tr_b16 a[40:41], v15 offset:0
    v_mfma_f32_16x16x32_bf16 v[208:211], a[8:11], v[140:143], v[208:211]
    ds_read_b64_tr_b16 a[42:43], v15 offset:2048
    v_mfma_f32_16x16x32_bf16 v[204:207], a[4:7], v[148:151], v[204:207]
    ds_read_b64_tr_b16 a[44:45], v15 offset:4096
    v_mfma_f32_16x16x32_bf16 v[204:207], a[0:3], v[140:143], v[204:207]
    ds_read_b64_tr_b16 a[46:47], v15 offset:6144
    s_waitcnt lgkmcnt(8)
    v_mfma_f32_16x16x32_bf16 v[156:159], a[16:19], v[44:47], 0
    ds_read_b64_tr_b16 a[0:1], v12 offset:8192
    buffer_load_dwordx4 v221, s[32:35], s68 offen offset:1024 sc1 lds
    v_mfma_f32_16x16x32_bf16 v[156:159], a[20:23], v[52:55], v[156:159]
    ds_read_b64_tr_b16 a[2:3], v12 offset:10240
    v_mfma_f32_16x16x32_bf16 v[160:163], a[24:27], v[44:47], 0
    ds_read_b64_tr_b16 a[4:5], v12 offset:12288
    v_mfma_f32_16x16x32_bf16 v[160:163], a[28:31], v[52:55], v[160:163]
    ds_read_b64_tr_b16 a[6:7], v12 offset:14336
    v_mfma_f32_16x16x32_bf16 v[168:171], a[28:31], v[56:59], 0
    ds_read_b64_tr_b16 a[8:9], v13 offset:8192
    v_cvt_pk_bf16_f32 v188, v188, v189
    v_mfma_f32_16x16x32_bf16 v[168:171], a[24:27], v[48:51], v[168:171]
    ds_read_b64_tr_b16 a[10:11], v13 offset:10240
    buffer_load_dwordx4 v222, s[32:35], s68 offen offset:2048 sc1 lds
    v_mfma_f32_16x16x32_bf16 v[164:167], a[20:23], v[56:59], 0
    ds_read_b64_tr_b16 a[12:13], v13 offset:12288
    v_cvt_pk_bf16_f32 v189, v190, v191
    v_mfma_f32_16x16x32_bf16 v[164:167], a[16:19], v[48:51], v[164:167]
    ds_read_b64_tr_b16 a[14:15], v13 offset:14336
    s_waitcnt lgkmcnt(8)
    v_mfma_f32_16x16x32_bf16 v[180:183], a[32:35], v[48:51], 0
    ds_read_b64_tr_b16 a[16:17], v14 offset:8192
    v_cvt_pk_bf16_f32 v190, v192, v193
    v_mfma_f32_16x16x32_bf16 v[180:183], a[36:39], v[56:59], v[180:183]
    ds_read_b64_tr_b16 a[18:19], v14 offset:10240
    v_cvt_pk_bf16_f32 v191, v194, v195
    v_mfma_f32_16x16x32_bf16 v[184:187], a[40:43], v[48:51], 0
    ds_read_b64_tr_b16 a[20:21], v14 offset:12288
    buffer_load_dwordx4 v223, s[32:35], s68 offen offset:3072 sc1 lds
    v_mfma_f32_16x16x32_bf16 v[184:187], a[44:47], v[56:59], v[184:187]
    ds_read_b64_tr_b16 a[22:23], v14 offset:14336
    s_add_u32 m0, s67, 32768
    v_mfma_f32_16x16x32_bf16 v[176:179], a[44:47], v[52:55], 0
    ds_read_b64_tr_b16 a[24:25], v15 offset:8192
    v_permlane32_swap_b32 v188, v190
    v_mfma_f32_16x16x32_bf16 v[176:179], a[40:43], v[44:47], v[176:179]
    ds_read_b64_tr_b16 a[26:27], v15 offset:10240
    s_add_u32 s68, s14, 458752
    v_mfma_f32_16x16x32_bf16 v[172:175], a[36:39], v[52:55], 0
    ds_read_b64_tr_b16 a[28:29], v15 offset:12288
    v_permlane32_swap_b32 v189, v191
    v_permlane16_swap_b32 v188, v190
    v_mfma_f32_16x16x32_bf16 v[172:175], a[32:35], v[44:47], v[172:175]
    ds_read_b64_tr_b16 a[30:31], v15 offset:14336
    s_waitcnt lgkmcnt(8)
    v_mfma_f32_16x16x32_bf16 v[156:159], a[0:3], v[60:63], v[156:159]
    ds_read_b64_tr_b16 a[32:33], v12 offset:16384
    buffer_load_dwordx4 v220, s[32:35], s68 offen offset:0 sc1 lds
    v_mfma_f32_16x16x32_bf16 v[156:159], a[4:7], v[68:71], v[156:159]
    ds_read_b64_tr_b16 a[34:35], v12 offset:18432
    s_mov_b32 s93, 8192
    v_mfma_f32_16x16x32_bf16 v[160:163], a[8:11], v[60:63], v[160:163]
    ds_read_b64_tr_b16 a[36:37], v12 offset:20480
    buffer_load_dword a59, v27, s[40:43], s93 offen
    v_mfma_f32_16x16x32_bf16 v[160:163], a[12:15], v[68:71], v[160:163]
    ds_read_b64_tr_b16 a[38:39], v12 offset:22528
    v_permlane16_swap_b32 v189, v191
    v_mfma_f32_16x16x32_bf16 v[168:171], a[12:15], v[72:75], v[168:171]
    ds_read_b64_tr_b16 a[40:41], v13 offset:16384
    buffer_load_dwordx4 v221, s[32:35], s68 offen offset:1024 sc1 lds
    v_mfma_f32_16x16x32_bf16 v[168:171], a[8:11], v[64:67], v[168:171]
    ds_read_b64_tr_b16 a[42:43], v13 offset:18432
    v_accvgpr_write_b32 a80, v188
    v_mfma_f32_16x16x32_bf16 v[164:167], a[4:7], v[72:75], v[164:167]
    ds_read_b64_tr_b16 a[44:45], v13 offset:20480
    v_accvgpr_write_b32 a81, v189
    v_mfma_f32_16x16x32_bf16 v[164:167], a[0:3], v[64:67], v[164:167]
    ds_read_b64_tr_b16 a[46:47], v13 offset:22528
    s_waitcnt lgkmcnt(8)
    v_mfma_f32_16x16x32_bf16 v[180:183], a[16:19], v[64:67], v[180:183]
    ds_read_b64_tr_b16 a[0:1], v14 offset:16384
    buffer_load_dwordx4 v222, s[32:35], s68 offen offset:2048 sc1 lds
    v_mfma_f32_16x16x32_bf16 v[180:183], a[20:23], v[72:75], v[180:183]
    ds_read_b64_tr_b16 a[2:3], v14 offset:18432
    v_accvgpr_write_b32 a82, v190
    v_mfma_f32_16x16x32_bf16 v[184:187], a[24:27], v[64:67], v[184:187]
    ds_read_b64_tr_b16 a[4:5], v14 offset:20480
    buffer_load_dwordx4 v223, s[32:35], s68 offen offset:3072 sc1 lds
    v_mfma_f32_16x16x32_bf16 v[184:187], a[28:31], v[72:75], v[184:187]
    ds_read_b64_tr_b16 a[6:7], v14 offset:22528
    v_accvgpr_write_b32 a83, v191
    v_mfma_f32_16x16x32_bf16 v[176:179], a[28:31], v[68:71], v[176:179]
    ds_read_b64_tr_b16 a[8:9], v15 offset:16384
    v_cvt_pk_bf16_f32 v196, v196, v197
    v_mfma_f32_16x16x32_bf16 v[176:179], a[24:27], v[60:63], v[176:179]
    ds_read_b64_tr_b16 a[10:11], v15 offset:18432
    v_cvt_pk_bf16_f32 v197, v198, v199
    v_mfma_f32_16x16x32_bf16 v[172:175], a[20:23], v[68:71], v[172:175]
    ds_read_b64_tr_b16 a[12:13], v15 offset:20480
    v_cvt_pk_bf16_f32 v198, v200, v201
    v_mfma_f32_16x16x32_bf16 v[172:175], a[16:19], v[60:63], v[172:175]
    ds_read_b64_tr_b16 a[14:15], v15 offset:22528
    s_waitcnt lgkmcnt(8)
    v_mfma_f32_16x16x32_bf16 v[156:159], a[32:35], v[76:79], v[156:159]
    ds_read_b64_tr_b16 a[16:17], v12 offset:24576
    v_cvt_pk_bf16_f32 v199, v202, v203
    v_mfma_f32_16x16x32_bf16 v[156:159], a[36:39], v[84:87], v[156:159]
    ds_read_b64_tr_b16 a[18:19], v12 offset:26624
    v_permlane32_swap_b32 v196, v198
    v_mfma_f32_16x16x32_bf16 v[160:163], a[40:43], v[76:79], v[160:163]
    ds_read_b64_tr_b16 a[20:21], v12 offset:28672
    v_permlane32_swap_b32 v197, v199
    v_mfma_f32_16x16x32_bf16 v[160:163], a[44:47], v[84:87], v[160:163]
    ds_read_b64_tr_b16 a[22:23], v12 offset:30720
    v_permlane16_swap_b32 v196, v198
    v_mfma_f32_16x16x32_bf16 v[168:171], a[44:47], v[88:91], v[168:171]
    ds_read_b64_tr_b16 a[24:25], v13 offset:24576
    v_permlane16_swap_b32 v197, v199
    v_mfma_f32_16x16x32_bf16 v[168:171], a[40:43], v[80:83], v[168:171]
    ds_read_b64_tr_b16 a[26:27], v13 offset:26624
    v_accvgpr_write_b32 a84, v196
    v_mfma_f32_16x16x32_bf16 v[164:167], a[36:39], v[88:91], v[164:167]
    ds_read_b64_tr_b16 a[28:29], v13 offset:28672
    v_accvgpr_write_b32 a85, v197
    v_mfma_f32_16x16x32_bf16 v[164:167], a[32:35], v[80:83], v[164:167]
    ds_read_b64_tr_b16 a[30:31], v13 offset:30720
    s_waitcnt lgkmcnt(8)
    v_mfma_f32_16x16x32_bf16 v[180:183], a[0:3], v[80:83], v[180:183]
    ds_read_b64_tr_b16 a[32:33], v14 offset:24576
    v_accvgpr_write_b32 a86, v198
    v_mfma_f32_16x16x32_bf16 v[180:183], a[4:7], v[88:91], v[180:183]
    ds_read_b64_tr_b16 a[34:35], v14 offset:26624
    v_accvgpr_write_b32 a87, v199
    v_mfma_f32_16x16x32_bf16 v[184:187], a[8:11], v[80:83], v[184:187]
    ds_read_b64_tr_b16 a[36:37], v14 offset:28672
    v_cvt_pk_bf16_f32 v204, v204, v205
    v_mfma_f32_16x16x32_bf16 v[184:187], a[12:15], v[88:91], v[184:187]
    ds_read_b64_tr_b16 a[38:39], v14 offset:30720
    v_cvt_pk_bf16_f32 v205, v206, v207
    v_mfma_f32_16x16x32_bf16 v[176:179], a[12:15], v[84:87], v[176:179]
    ds_read_b64_tr_b16 a[40:41], v15 offset:24576
    v_cvt_pk_bf16_f32 v206, v208, v209
    v_mfma_f32_16x16x32_bf16 v[176:179], a[8:11], v[76:79], v[176:179]
    ds_read_b64_tr_b16 a[42:43], v15 offset:26624
    v_cvt_pk_bf16_f32 v207, v210, v211
    v_mfma_f32_16x16x32_bf16 v[172:175], a[4:7], v[84:87], v[172:175]
    ds_read_b64_tr_b16 a[44:45], v15 offset:28672
    v_permlane32_swap_b32 v204, v206
    v_mfma_f32_16x16x32_bf16 v[172:175], a[0:3], v[76:79], v[172:175]
    ds_read_b64_tr_b16 a[46:47], v15 offset:30720
    s_waitcnt vmcnt(22) lgkmcnt(8)
    v_mfma_f32_16x16x32_bf16 v[156:159], a[16:19], v[92:95], v[156:159]
    s_barrier
    ds_read_b64_tr_b16 a[0:1], v12 offset:32768
    v_mfma_f32_16x16x32_bf16 v[156:159], a[20:23], v[100:103], v[156:159]
    ds_read_b64_tr_b16 a[2:3], v12 offset:34816
    s_add_u32 m0, s67, 49152
    v_mfma_f32_16x16x32_bf16 v[160:163], a[24:27], v[92:95], v[160:163]
    ds_read_b64_tr_b16 a[4:5], v12 offset:36864
    v_permlane32_swap_b32 v205, v207
    v_mfma_f32_16x16x32_bf16 v[160:163], a[28:31], v[100:103], v[160:163]
    ds_read_b64_tr_b16 a[6:7], v12 offset:38912
    v_permlane16_swap_b32 v204, v206
    v_mfma_f32_16x16x32_bf16 v[168:171], a[28:31], v[104:107], v[168:171]
    ds_read_b64_tr_b16 a[8:9], v13 offset:32768
    v_permlane16_swap_b32 v205, v207
    v_mfma_f32_16x16x32_bf16 v[168:171], a[24:27], v[96:99], v[168:171]
    ds_read_b64_tr_b16 a[10:11], v13 offset:34816
    v_accvgpr_write_b32 a88, v204
    v_mfma_f32_16x16x32_bf16 v[164:167], a[20:23], v[104:107], v[164:167]
    ds_read_b64_tr_b16 a[12:13], v13 offset:36864
    s_add_u32 s68, s14, 917504
    v_mfma_f32_16x16x32_bf16 v[164:167], a[16:19], v[96:99], v[164:167]
    ds_read_b64_tr_b16 a[14:15], v13 offset:38912
    s_waitcnt lgkmcnt(8)
    v_mfma_f32_16x16x32_bf16 v[180:183], a[32:35], v[96:99], v[180:183]
    ds_read_b64_tr_b16 a[16:17], v14 offset:32768
    v_accvgpr_write_b32 a89, v205
    v_mfma_f32_16x16x32_bf16 v[180:183], a[36:39], v[104:107], v[180:183]
    ds_read_b64_tr_b16 a[18:19], v14 offset:34816
    v_accvgpr_write_b32 a90, v206
    v_mfma_f32_16x16x32_bf16 v[184:187], a[40:43], v[96:99], v[184:187]
    ds_read_b64_tr_b16 a[20:21], v14 offset:36864
    v_accvgpr_write_b32 a91, v207
    v_mfma_f32_16x16x32_bf16 v[184:187], a[44:47], v[104:107], v[184:187]
    ds_read_b64_tr_b16 a[22:23], v14 offset:38912
    buffer_load_dwordx4 v220, s[32:35], s68 offen offset:0 sc1 lds
    v_mfma_f32_16x16x32_bf16 v[176:179], a[44:47], v[100:103], v[176:179]
    ds_read_b64_tr_b16 a[24:25], v15 offset:32768
    v_cvt_pk_bf16_f32 v212, v212, v213
    v_mfma_f32_16x16x32_bf16 v[176:179], a[40:43], v[92:95], v[176:179]
    ds_read_b64_tr_b16 a[26:27], v15 offset:34816
    v_cvt_pk_bf16_f32 v213, v214, v215
    v_mfma_f32_16x16x32_bf16 v[172:175], a[36:39], v[100:103], v[172:175]
    ds_read_b64_tr_b16 a[28:29], v15 offset:36864
    v_cvt_pk_bf16_f32 v214, v216, v217
    v_mfma_f32_16x16x32_bf16 v[172:175], a[32:35], v[92:95], v[172:175]
    ds_read_b64_tr_b16 a[30:31], v15 offset:38912
    s_waitcnt lgkmcnt(8)
    v_mfma_f32_16x16x32_bf16 v[156:159], a[0:3], v[108:111], v[156:159]
    ds_read_b64_tr_b16 a[32:33], v12 offset:40960
    buffer_load_dwordx4 v221, s[32:35], s68 offen offset:1024 sc1 lds
    v_mfma_f32_16x16x32_bf16 v[156:159], a[4:7], v[116:119], v[156:159]
    ds_read_b64_tr_b16 a[34:35], v12 offset:43008
    v_cvt_pk_bf16_f32 v215, v218, v219
    v_mfma_f32_16x16x32_bf16 v[160:163], a[8:11], v[108:111], v[160:163]
    ds_read_b64_tr_b16 a[36:37], v12 offset:45056
    v_permlane32_swap_b32 v212, v214
    v_mfma_f32_16x16x32_bf16 v[160:163], a[12:15], v[116:119], v[160:163]
    ds_read_b64_tr_b16 a[38:39], v12 offset:47104
    v_permlane32_swap_b32 v213, v215
    v_mfma_f32_16x16x32_bf16 v[168:171], a[12:15], v[120:123], v[168:171]
    ds_read_b64_tr_b16 a[40:41], v13 offset:40960
    v_permlane16_swap_b32 v212, v214
    v_mfma_f32_16x16x32_bf16 v[168:171], a[8:11], v[112:115], v[168:171]
    ds_read_b64_tr_b16 a[42:43], v13 offset:43008
    buffer_load_dwordx4 v222, s[32:35], s68 offen offset:2048 sc1 lds
    v_mfma_f32_16x16x32_bf16 v[164:167], a[4:7], v[120:123], v[164:167]
    ds_read_b64_tr_b16 a[44:45], v13 offset:45056
    v_permlane16_swap_b32 v213, v215
    v_mfma_f32_16x16x32_bf16 v[164:167], a[0:3], v[112:115], v[164:167]
    ds_read_b64_tr_b16 a[46:47], v13 offset:47104
    s_waitcnt lgkmcnt(8)
    v_mfma_f32_16x16x32_bf16 v[180:183], a[16:19], v[112:115], v[180:183]
    ds_read_b64_tr_b16 a[0:1], v14 offset:40960
    v_accvgpr_write_b32 a92, v212
    v_mfma_f32_16x16x32_bf16 v[180:183], a[20:23], v[120:123], v[180:183]
    ds_read_b64_tr_b16 a[2:3], v14 offset:43008
    v_accvgpr_write_b32 a93, v213
    v_mfma_f32_16x16x32_bf16 v[184:187], a[24:27], v[112:115], v[184:187]
    ds_read_b64_tr_b16 a[4:5], v14 offset:45056
    buffer_load_dwordx4 v223, s[32:35], s68 offen offset:3072 sc1 lds
    v_mfma_f32_16x16x32_bf16 v[184:187], a[28:31], v[120:123], v[184:187]
    ds_read_b64_tr_b16 a[6:7], v14 offset:47104
    s_add_u32 m0, s67, 65536
    v_mfma_f32_16x16x32_bf16 v[176:179], a[28:31], v[116:119], v[176:179]
    ds_read_b64_tr_b16 a[8:9], v15 offset:40960
    v_accvgpr_write_b32 a94, v214
    v_mfma_f32_16x16x32_bf16 v[176:179], a[24:27], v[108:111], v[176:179]
    ds_read_b64_tr_b16 a[10:11], v15 offset:43008
    s_add_u32 s68, s15, 0
    v_mfma_f32_16x16x32_bf16 v[172:175], a[20:23], v[116:119], v[172:175]
    ds_read_b64_tr_b16 a[12:13], v15 offset:45056
    v_accvgpr_write_b32 a95, v215
    v_mfma_f32_16x16x32_bf16 v[172:175], a[16:19], v[108:111], v[172:175]
    ds_read_b64_tr_b16 a[14:15], v15 offset:47104
    s_waitcnt lgkmcnt(8)
    v_mfma_f32_16x16x32_bf16 v[156:159], a[32:35], v[124:127], v[156:159]
    ds_read_b64_tr_b16 a[16:17], v12 offset:49152
    buffer_load_dwordx4 v220, s[32:35], s68 offen offset:0 sc1 lds
    v_mfma_f32_16x16x32_bf16 v[156:159], a[36:39], v[132:135], v[156:159]
    ds_read_b64_tr_b16 a[18:19], v12 offset:51200
    v_mfma_f32_16x16x32_bf16 v[160:163], a[40:43], v[124:127], v[160:163]
    ds_read_b64_tr_b16 a[20:21], v12 offset:53248
    v_mfma_f32_16x16x32_bf16 v[160:163], a[44:47], v[132:135], v[160:163]
    ds_read_b64_tr_b16 a[22:23], v12 offset:55296
    v_mfma_f32_16x16x32_bf16 v[168:171], a[44:47], v[136:139], v[168:171]
    ds_read_b64_tr_b16 a[24:25], v13 offset:49152
    buffer_load_dwordx4 v221, s[32:35], s68 offen offset:1024 sc1 lds
    v_mfma_f32_16x16x32_bf16 v[168:171], a[40:43], v[128:131], v[168:171]
    ds_read_b64_tr_b16 a[26:27], v13 offset:51200
    s_mul_i32 s93, s25, 128
    v_mfma_f32_16x16x32_bf16 v[164:167], a[36:39], v[136:139], v[164:167]
    ds_read_b64_tr_b16 a[28:29], v13 offset:53248
    v_add_u32 v27, s93, v26
    v_mfma_f32_16x16x32_bf16 v[164:167], a[32:35], v[128:131], v[164:167]
    ds_read_b64_tr_b16 a[30:31], v13 offset:55296
    s_waitcnt lgkmcnt(8)
    v_mfma_f32_16x16x32_bf16 v[180:183], a[0:3], v[128:131], v[180:183]
    ds_read_b64_tr_b16 a[32:33], v14 offset:49152
    buffer_load_dwordx4 v222, s[32:35], s68 offen offset:2048 sc1 lds
    v_mfma_f32_16x16x32_bf16 v[180:183], a[4:7], v[136:139], v[180:183]
    ds_read_b64_tr_b16 a[34:35], v14 offset:51200
    v_mul_u32_u24 v27, 128, v27
    v_mfma_f32_16x16x32_bf16 v[184:187], a[8:11], v[128:131], v[184:187]
    ds_read_b64_tr_b16 a[36:37], v14 offset:53248
    buffer_load_dwordx4 v223, s[32:35], s68 offen offset:3072 sc1 lds
    v_mfma_f32_16x16x32_bf16 v[184:187], a[12:15], v[136:139], v[184:187]
    ds_read_b64_tr_b16 a[38:39], v14 offset:55296
    s_mov_b32 s93, 0
    v_mfma_f32_16x16x32_bf16 v[176:179], a[12:15], v[132:135], v[176:179]
    ds_read_b64_tr_b16 a[40:41], v15 offset:49152
    buffer_load_dword a60, v27, s[44:47], s93 offen
    v_mfma_f32_16x16x32_bf16 v[176:179], a[8:11], v[124:127], v[176:179]
    ds_read_b64_tr_b16 a[42:43], v15 offset:51200
    v_mfma_f32_16x16x32_bf16 v[172:175], a[4:7], v[132:135], v[172:175]
    ds_read_b64_tr_b16 a[44:45], v15 offset:53248
    v_mfma_f32_16x16x32_bf16 v[172:175], a[0:3], v[124:127], v[172:175]
    ds_read_b64_tr_b16 a[46:47], v15 offset:55296
    s_waitcnt lgkmcnt(8)
    v_mfma_f32_16x16x32_bf16 v[156:159], a[16:19], v[140:143], v[156:159]
    ds_read_b64_tr_b16 a[0:1], v12 offset:57344
    v_mfma_f32_16x16x32_bf16 v[156:159], a[20:23], v[148:151], v[156:159]
    ds_read_b64_tr_b16 a[2:3], v12 offset:59392
    v_mfma_f32_16x16x32_bf16 v[160:163], a[24:27], v[140:143], v[160:163]
    ds_read_b64_tr_b16 a[4:5], v12 offset:61440
    v_mfma_f32_16x16x32_bf16 v[160:163], a[28:31], v[148:151], v[160:163]
    ds_read_b64_tr_b16 a[6:7], v12 offset:63488
    v_mfma_f32_16x16x32_bf16 v[168:171], a[28:31], v[152:155], v[168:171]
    ds_read_b64_tr_b16 a[8:9], v13 offset:57344
    v_mfma_f32_16x16x32_bf16 v[168:171], a[24:27], v[144:147], v[168:171]
    ds_read_b64_tr_b16 a[10:11], v13 offset:59392
    v_mfma_f32_16x16x32_bf16 v[164:167], a[20:23], v[152:155], v[164:167]
    ds_read_b64_tr_b16 a[12:13], v13 offset:61440
    v_mfma_f32_16x16x32_bf16 v[164:167], a[16:19], v[144:147], v[164:167]
    ds_read_b64_tr_b16 a[14:15], v13 offset:63488
    s_waitcnt lgkmcnt(8)
    v_mfma_f32_16x16x32_bf16 v[180:183], a[32:35], v[144:147], v[180:183]
    ds_read_b64_tr_b16 a[16:17], v14 offset:57344
    v_mfma_f32_16x16x32_bf16 v[180:183], a[36:39], v[152:155], v[180:183]
    ds_read_b64_tr_b16 a[18:19], v14 offset:59392
    v_mfma_f32_16x16x32_bf16 v[184:187], a[40:43], v[144:147], v[184:187]
    ds_read_b64_tr_b16 a[20:21], v14 offset:61440
    v_mfma_f32_16x16x32_bf16 v[184:187], a[44:47], v[152:155], v[184:187]
    ds_read_b64_tr_b16 a[22:23], v14 offset:63488
    v_mfma_f32_16x16x32_bf16 v[176:179], a[44:47], v[148:151], v[176:179]
    ds_read_b64_tr_b16 a[24:25], v15 offset:57344
    v_mfma_f32_16x16x32_bf16 v[176:179], a[40:43], v[140:143], v[176:179]
    ds_read_b64_tr_b16 a[26:27], v15 offset:59392
    v_mfma_f32_16x16x32_bf16 v[172:175], a[36:39], v[148:151], v[172:175]
    ds_read_b64_tr_b16 a[28:29], v15 offset:61440
    v_mfma_f32_16x16x32_bf16 v[172:175], a[32:35], v[140:143], v[172:175]
    ds_read_b64_tr_b16 a[30:31], v15 offset:63488
    s_waitcnt vmcnt(22) lgkmcnt(8)
    v_mfma_f32_16x16x32_bf16 v[188:191], a[0:3], v[44:47], 0
    s_barrier
    ds_read_b64_tr_b16 a[32:33], v16 offset:0
    v_mfma_f32_16x16x32_bf16 v[188:191], a[4:7], v[52:55], v[188:191]
    ds_read_b64_tr_b16 a[34:35], v16 offset:2048
    s_add_u32 m0, s67, 81920
    v_mfma_f32_16x16x32_bf16 v[192:195], a[8:11], v[44:47], 0
    ds_read_b64_tr_b16 a[36:37], v16 offset:4096
    v_mfma_f32_16x16x32_bf16 v[192:195], a[12:15], v[52:55], v[192:195]
    ds_read_b64_tr_b16 a[38:39], v16 offset:6144
    v_mfma_f32_16x16x32_bf16 v[200:203], a[12:15], v[56:59], 0
    ds_read_b64_tr_b16 a[40:41], v17 offset:0
    v_cvt_pk_bf16_f32 v156, v156, v157
    v_mfma_f32_16x16x32_bf16 v[200:203], a[8:11], v[48:51], v[200:203]
    ds_read_b64_tr_b16 a[42:43], v17 offset:2048
    v_cvt_pk_bf16_f32 v157, v158, v159
    v_mfma_f32_16x16x32_bf16 v[196:199], a[4:7], v[56:59], 0
    ds_read_b64_tr_b16 a[44:45], v17 offset:4096
    s_add_u32 s68, s14, 229504
    v_mfma_f32_16x16x32_bf16 v[196:199], a[0:3], v[48:51], v[196:199]
    ds_read_b64_tr_b16 a[46:47], v17 offset:6144
    s_waitcnt lgkmcnt(8)
    v_mfma_f32_16x16x32_bf16 v[212:215], a[16:19], v[48:51], 0
    ds_read_b64_tr_b16 a[0:1], v18 offset:0
    v_cvt_pk_bf16_f32 v158, v160, v161
    v_mfma_f32_16x16x32_bf16 v[212:215], a[20:23], v[56:59], v[212:215]
    ds_read_b64_tr_b16 a[2:3], v18 offset:2048
    v_cvt_pk_bf16_f32 v159, v162, v163
    v_mfma_f32_16x16x32_bf16 v[216:219], a[24:27], v[48:51], 0
    ds_read_b64_tr_b16 a[4:5], v18 offset:4096
    v_permlane32_swap_b32 v156, v158
    v_mfma_f32_16x16x32_bf16 v[216:219], a[28:31], v[56:59], v[216:219]
    ds_read_b64_tr_b16 a[6:7], v18 offset:6144
    buffer_load_dwordx4 v220, s[32:35], s68 offen offset:0 sc1 lds
    v_mfma_f32_16x16x32_bf16 v[208:211], a[28:31], v[52:55], 0
    ds_read_b64_tr_b16 a[8:9], v19 offset:0
    v_permlane32_swap_b32 v157, v159
    v_mfma_f32_16x16x32_bf16 v[208:211], a[24:27], v[44:47], v[208:211]
    ds_read_b64_tr_b16 a[10:11], v19 offset:2048
    v_permlane16_swap_b32 v156, v158
    v_mfma_f32_16x16x32_bf16 v[204:207], a[20:23], v[52:55], 0
    ds_read_b64_tr_b16 a[12:13], v19 offset:4096
    v_permlane16_swap_b32 v157, v159
    v_mfma_f32_16x16x32_bf16 v[204:207], a[16:19], v[44:47], v[204:207]
    ds_read_b64_tr_b16 a[14:15], v19 offset:6144
    s_waitcnt lgkmcnt(8)
    v_mfma_f32_16x16x32_bf16 v[188:191], a[32:35], v[60:63], v[188:191]
    ds_read_b64_tr_b16 a[16:17], v16 offset:8192
    buffer_load_dwordx4 v221, s[32:35], s68 offen offset:1024 sc1 lds
    v_mfma_f32_16x16x32_bf16 v[188:191], a[36:39], v[68:71], v[188:191]
    ds_read_b64_tr_b16 a[18:19], v16 offset:10240
    v_accvgpr_write_b32 a96, v156
    v_mfma_f32_16x16x32_bf16 v[192:195], a[40:43], v[60:63], v[192:195]
    ds_read_b64_tr_b16 a[20:21], v16 offset:12288
    v_accvgpr_write_b32 a97, v157
    v_mfma_f32_16x16x32_bf16 v[192:195], a[44:47], v[68:71], v[192:195]
    ds_read_b64_tr_b16 a[22:23], v16 offset:14336
    v_accvgpr_write_b32 a98, v158
    v_mfma_f32_16x16x32_bf16 v[200:203], a[44:47], v[72:75], v[200:203]
    ds_read_b64_tr_b16 a[24:25], v17 offset:8192
    v_accvgpr_write_b32 a99, v159
    v_mfma_f32_16x16x32_bf16 v[200:203], a[40:43], v[64:67], v[200:203]
    ds_read_b64_tr_b16 a[26:27], v17 offset:10240
    buffer_load_dwordx4 v222, s[32:35], s68 offen offset:2048 sc1 lds
    v_mfma_f32_16x16x32_bf16 v[196:199], a[36:39], v[72:75], v[196:199]
    ds_read_b64_tr_b16 a[28:29], v17 offset:12288
    v_cvt_pk_bf16_f32 v164, v164, v165
    v_mfma_f32_16x16x32_bf16 v[196:199], a[32:35], v[64:67], v[196:199]
    ds_read_b64_tr_b16 a[30:31], v17 offset:14336
    s_waitcnt lgkmcnt(8)
    v_mfma_f32_16x16x32_bf16 v[212:215], a[0:3], v[64:67], v[212:215]
    ds_read_b64_tr_b16 a[32:33], v18 offset:8192
    v_cvt_pk_bf16_f32 v165, v166, v167
    v_mfma_f32_16x16x32_bf16 v[212:215], a[4:7], v[72:75], v[212:215]
    ds_read_b64_tr_b16 a[34:35], v18 offset:10240
    v_cvt_pk_bf16_f32 v166, v168, v169
    v_mfma_f32_16x16x32_bf16 v[216:219], a[8:11], v[64:67], v[216:219]
    ds_read_b64_tr_b16 a[36:37], v18 offset:12288
    buffer_load_dwordx4 v223, s[32:35], s68 offen offset:3072 sc1 lds
    v_mfma_f32_16x16x32_bf16 v[216:219], a[12:15], v[72:75], v[216:219]
    ds_read_b64_tr_b16 a[38:39], v18 offset:14336
    s_add_u32 m0, s67, 98304
    v_mfma_f32_16x16x32_bf16 v[208:211], a[12:15], v[68:71], v[208:211]
    ds_read_b64_tr_b16 a[40:41], v19 offset:8192
    v_cvt_pk_bf16_f32 v167, v170, v171
    v_mfma_f32_16x16x32_bf16 v[208:211], a[8:11], v[60:63], v[208:211]
    ds_read_b64_tr_b16 a[42:43], v19 offset:10240
    s_add_u32 s68, s14, 688256
    v_mfma_f32_16x16x32_bf16 v[204:207], a[4:7], v[68:71], v[204:207]
    ds_read_b64_tr_b16 a[44:45], v19 offset:12288
    v_permlane32_swap_b32 v164, v166
    v_mfma_f32_16x16x32_bf16 v[204:207], a[0:3], v[60:63], v[204:207]
    ds_read_b64_tr_b16 a[46:47], v19 offset:14336
    s_waitcnt lgkmcnt(8)
    v_mfma_f32_16x16x32_bf16 v[188:191], a[16:19], v[76:79], v[188:191]
    ds_read_b64_tr_b16 a[0:1], v16 offset:16384
    buffer_load_dwordx4 v220, s[32:35], s68 offen offset:0 sc1 lds
    v_mfma_f32_16x16x32_bf16 v[188:191], a[20:23], v[84:87], v[188:191]
    ds_read_b64_tr_b16 a[2:3], v16 offset:18432
    v_permlane32_swap_b32 v165, v167
    v_mfma_f32_16x16x32_bf16 v[192:195], a[24:27], v[76:79], v[192:195]
    ds_read_b64_tr_b16 a[4:5], v16 offset:20480
    v_permlane16_swap_b32 v164, v166
    v_mfma_f32_16x16x32_bf16 v[192:195], a[28:31], v[84:87], v[192:195]
    ds_read_b64_tr_b16 a[6:7], v16 offset:22528
    v_permlane16_swap_b32 v165, v167
    v_mfma_f32_16x16x32_bf16 v[200:203], a[28:31], v[88:91], v[200:203]
    ds_read_b64_tr_b16 a[8:9], v17 offset:16384
    buffer_load_dwordx4 v221, s[32:35], s68 offen offset:1024 sc1 lds
    v_mfma_f32_16x16x32_bf16 v[200:203], a[24:27], v[80:83], v[200:203]
    ds_read_b64_tr_b16 a[10:11], v17 offset:18432
    v_accvgpr_write_b32 a100, v164
    v_mfma_f32_16x16x32_bf16 v[196:199], a[20:23], v[88:91], v[196:199]
    ds_read_b64_tr_b16 a[12:13], v17 offset:20480
    v_accvgpr_write_b32 a101, v165
    v_mfma_f32_16x16x32_bf16 v[196:199], a[16:19], v[80:83], v[196:199]
    ds_read_b64_tr_b16 a[14:15], v17 offset:22528
    s_waitcnt lgkmcnt(8)
    v_mfma_f32_16x16x32_bf16 v[212:215], a[32:35], v[80:83], v[212:215]
    ds_read_b64_tr_b16 a[16:17], v18 offset:16384
    buffer_load_dwordx4 v222, s[32:35], s68 offen offset:2048 sc1 lds
    v_mfma_f32_16x16x32_bf16 v[212:215], a[36:39], v[88:91], v[212:215]
    ds_read_b64_tr_b16 a[18:19], v18 offset:18432
    v_accvgpr_write_b32 a102, v166
    v_mfma_f32_16x16x32_bf16 v[216:219], a[40:43], v[80:83], v[216:219]
    ds_read_b64_tr_b16 a[20:21], v18 offset:20480
    buffer_load_dwordx4 v223, s[32:35], s68 offen offset:3072 sc1 lds
    v_mfma_f32_16x16x32_bf16 v[216:219], a[44:47], v[88:91], v[216:219]
    ds_read_b64_tr_b16 a[22:23], v18 offset:22528
    s_mov_b32 s93, 8192
    v_mfma_f32_16x16x32_bf16 v[208:211], a[44:47], v[84:87], v[208:211]
    ds_read_b64_tr_b16 a[24:25], v19 offset:16384
    buffer_load_dword a61, v27, s[44:47], s93 offen
    v_mfma_f32_16x16x32_bf16 v[208:211], a[40:43], v[76:79], v[208:211]
    ds_read_b64_tr_b16 a[26:27], v19 offset:18432
    v_accvgpr_write_b32 a103, v167
    v_mfma_f32_16x16x32_bf16 v[204:207], a[36:39], v[84:87], v[204:207]
    ds_read_b64_tr_b16 a[28:29], v19 offset:20480
    v_cvt_pk_bf16_f32 v172, v172, v173
    v_mfma_f32_16x16x32_bf16 v[204:207], a[32:35], v[76:79], v[204:207]
    ds_read_b64_tr_b16 a[30:31], v19 offset:22528
    s_waitcnt lgkmcnt(8)
    v_mfma_f32_16x16x32_bf16 v[188:191], a[0:3], v[92:95], v[188:191]
    ds_read_b64_tr_b16 a[32:33], v16 offset:24576
    v_cvt_pk_bf16_f32 v173, v174, v175
    v_mfma_f32_16x16x32_bf16 v[188:191], a[4:7], v[100:103], v[188:191]
    ds_read_b64_tr_b16 a[34:35], v16 offset:26624
    v_cvt_pk_bf16_f32 v174, v176, v177
    v_mfma_f32_16x16x32_bf16 v[192:195], a[8:11], v[92:95], v[192:195]
    ds_read_b64_tr_b16 a[36:37], v16 offset:28672
    v_cvt_pk_bf16_f32 v175, v178, v179
    v_mfma_f32_16x16x32_bf16 v[192:195], a[12:15], v[100:103], v[192:195]
    ds_read_b64_tr_b16 a[38:39], v16 offset:30720
    v_permlane32_swap_b32 v172, v174
    v_mfma_f32_16x16x32_bf16 v[200:203], a[12:15], v[104:107], v[200:203]
    ds_read_b64_tr_b16 a[40:41], v17 offset:24576
    v_permlane32_swap_b32 v173, v175
    v_mfma_f32_16x16x32_bf16 v[200:203], a[8:11], v[96:99], v[200:203]
    ds_read_b64_tr_b16 a[42:43], v17 offset:26624
    v_permlane16_swap_b32 v172, v174
    v_mfma_f32_16x16x32_bf16 v[196:199], a[4:7], v[104:107], v[196:199]
    ds_read_b64_tr_b16 a[44:45], v17 offset:28672
    v_permlane16_swap_b32 v173, v175
    v_mfma_f32_16x16x32_bf16 v[196:199], a[0:3], v[96:99], v[196:199]
    ds_read_b64_tr_b16 a[46:47], v17 offset:30720
    s_waitcnt lgkmcnt(8)
    v_mfma_f32_16x16x32_bf16 v[212:215], a[16:19], v[96:99], v[212:215]
    ds_read_b64_tr_b16 a[0:1], v18 offset:24576
    v_accvgpr_write_b32 a104, v172
    v_mfma_f32_16x16x32_bf16 v[212:215], a[20:23], v[104:107], v[212:215]
    ds_read_b64_tr_b16 a[2:3], v18 offset:26624
    v_accvgpr_write_b32 a105, v173
    v_mfma_f32_16x16x32_bf16 v[216:219], a[24:27], v[96:99], v[216:219]
    ds_read_b64_tr_b16 a[4:5], v18 offset:28672
    v_accvgpr_write_b32 a106, v174
    v_mfma_f32_16x16x32_bf16 v[216:219], a[28:31], v[104:107], v[216:219]
    ds_read_b64_tr_b16 a[6:7], v18 offset:30720
    v_accvgpr_write_b32 a107, v175
    v_mfma_f32_16x16x32_bf16 v[208:211], a[28:31], v[100:103], v[208:211]
    ds_read_b64_tr_b16 a[8:9], v19 offset:24576
    v_cvt_pk_bf16_f32 v180, v180, v181
L_pg2:
    s_cbranch_execz L_pg6
    v_mfma_f32_16x16x32_bf16 v[208:211], a[24:27], v[92:95], v[208:211]
    ds_read_b64_tr_b16 a[10:11], v19 offset:26624
    v_cvt_pk_bf16_f32 v181, v182, v183
    v_mfma_f32_16x16x32_bf16 v[204:207], a[20:23], v[100:103], v[204:207]
    ds_read_b64_tr_b16 a[12:13], v19 offset:28672
    v_cvt_pk_bf16_f32 v182, v184, v185
    v_mfma_f32_16x16x32_bf16 v[204:207], a[16:19], v[92:95], v[204:207]
    ds_read_b64_tr_b16 a[14:15], v19 offset:30720
    s_waitcnt vmcnt(23) lgkmcnt(8)
    v_mfma_f32_16x16x32_bf16 v[188:191], a[32:35], v[108:111], v[188:191]
    s_barrier
    ds_read_b64_tr_b16 a[16:17], v8 offset:0
    v_mfma_f32_16x16x32_bf16 v[188:191], a[36:39], v[116:119], v[188:191]
    ds_read_b64_tr_b16 a[18:19], v8 offset:2048
    s_add_u32 m0, s67, 114688
    v_mfma_f32_16x16x32_bf16 v[192:195], a[40:43], v[108:111], v[192:195]
    ds_read_b64_tr_b16 a[20:21], v8 offset:4096
    v_cvt_pk_bf16_f32 v183, v186, v187
    v_mfma_f32_16x16x32_bf16 v[192:195], a[44:47], v[116:119], v[192:195]
    ds_read_b64_tr_b16 a[22:23], v8 offset:6144
    v_permlane32_swap_b32 v180, v182
    v_mfma_f32_16x16x32_bf16 v[200:203], a[44:47], v[120:123], v[200:203]
    ds_read_b64_tr_b16 a[24:25], v9 offset:0
    v_permlane32_swap_b32 v181, v183
    v_mfma_f32_16x16x32_bf16 v[200:203], a[40:43], v[112:115], v[200:203]
    ds_read_b64_tr_b16 a[26:27], v9 offset:2048
    v_permlane16_swap_b32 v180, v182
    v_mfma_f32_16x16x32_bf16 v[196:199], a[36:39], v[120:123], v[196:199]
    ds_read_b64_tr_b16 a[28:29], v9 offset:4096
    s_add_u32 s68, s14, 1147008
    v_mfma_f32_16x16x32_bf16 v[196:199], a[32:35], v[112:115], v[196:199]
    ds_read_b64_tr_b16 a[30:31], v9 offset:6144
    s_waitcnt lgkmcnt(8)
    v_mfma_f32_16x16x32_bf16 v[212:215], a[0:3], v[112:115], v[212:215]
    ds_read_b64_tr_b16 a[32:33], v10 offset:0
    v_permlane16_swap_b32 v181, v183
    v_mfma_f32_16x16x32_bf16 v[212:215], a[4:7], v[120:123], v[212:215]
    ds_read_b64_tr_b16 a[34:35], v10 offset:2048
    v_accvgpr_write_b32 a108, v180
    v_mfma_f32_16x16x32_bf16 v[216:219], a[8:11], v[112:115], v[216:219]
    ds_read_b64_tr_b16 a[36:37], v10 offset:4096
    v_accvgpr_write_b32 a109, v181
    v_mfma_f32_16x16x32_bf16 v[216:219], a[12:15], v[120:123], v[216:219]
    ds_read_b64_tr_b16 a[38:39], v10 offset:6144
    buffer_load_dwordx4 v220, s[32:35], s68 offen offset:0 sc1 lds
    v_mfma_f32_16x16x32_bf16 v[208:211], a[12:15], v[116:119], v[208:211]
    ds_read_b64_tr_b16 a[40:41], v11 offset:0
    v_accvgpr_write_b32 a110, v182
    v_mfma_f32_16x16x32_bf16 v[208:211], a[8:11], v[108:111], v[208:211]
    ds_read_b64_tr_b16 a[42:43], v11 offset:2048
    v_accvgpr_write_b32 a111, v183
    v_mfma_f32_16x16x32_bf16 v[204:207], a[4:7], v[116:119], v[204:207]
    ds_read_b64_tr_b16 a[44:45], v11 offset:4096
    v_mfma_f32_16x16x32_bf16 v[204:207], a[0:3], v[108:111], v[204:207]
    ds_read_b64_tr_b16 a[46:47], v11 offset:6144
    s_waitcnt lgkmcnt(8)
    v_mfma_f32_16x16x32_bf16 v[188:191], a[16:19], v[124:127], v[188:191]
    ds_read_b64_tr_b16 a[0:1], v8 offset:8192
    buffer_load_dwordx4 v221, s[32:35], s68 offen offset:1024 sc1 lds
    v_mfma_f32_16x16x32_bf16 v[188:191], a[20:23], v[132:135], v[188:191]
    ds_read_b64_tr_b16 a[2:3], v8 offset:10240
    v_mfma_f32_16x16x32_bf16 v[192:195], a[24:27], v[124:127], v[192:195]
    ds_read_b64_tr_b16 a[4:5], v8 offset:12288
    v_mfma_f32_16x16x32_bf16 v[192:195], a[28:31], v[132:135], v[192:195]
    ds_read_b64_tr_b16 a[6:7], v8 offset:14336
    v_mfma_f32_16x16x32_bf16 v[200:203], a[28:31], v[136:139], v[200:203]
    ds_read_b64_tr_b16 a[8:9], v9 offset:8192
    v_mfma_f32_16x16x32_bf16 v[200:203], a[24:27], v[128:131], v[200:203]
    ds_read_b64_tr_b16 a[10:11], v9 offset:10240
    buffer_load_dwordx4 v222, s[32:35], s68 offen offset:2048 sc1 lds
    v_mfma_f32_16x16x32_bf16 v[196:199], a[20:23], v[136:139], v[196:199]
    ds_read_b64_tr_b16 a[12:13], v9 offset:12288
    v_mfma_f32_16x16x32_bf16 v[196:199], a[16:19], v[128:131], v[196:199]
    ds_read_b64_tr_b16 a[14:15], v9 offset:14336
    s_waitcnt lgkmcnt(8)
    v_mfma_f32_16x16x32_bf16 v[212:215], a[32:35], v[128:131], v[212:215]
    ds_read_b64_tr_b16 a[16:17], v10 offset:8192
    v_mfma_f32_16x16x32_bf16 v[212:215], a[36:39], v[136:139], v[212:215]
    ds_read_b64_tr_b16 a[18:19], v10 offset:10240
    v_mfma_f32_16x16x32_bf16 v[216:219], a[40:43], v[128:131], v[216:219]
    ds_read_b64_tr_b16 a[20:21], v10 offset:12288
    buffer_load_dwordx4 v223, s[32:35], s68 offen offset:3072 sc1 lds
    v_mfma_f32_16x16x32_bf16 v[216:219], a[44:47], v[136:139], v[216:219]
    ds_read_b64_tr_b16 a[22:23], v10 offset:14336
    s_add_u32 m0, s67, 131072
    v_mfma_f32_16x16x32_bf16 v[208:211], a[44:47], v[132:135], v[208:211]
    ds_read_b64_tr_b16 a[24:25], v11 offset:8192
    v_mfma_f32_16x16x32_bf16 v[208:211], a[40:43], v[124:127], v[208:211]
    ds_read_b64_tr_b16 a[26:27], v11 offset:10240
    v_mfma_f32_16x16x32_bf16 v[204:207], a[36:39], v[132:135], v[204:207]
    ds_read_b64_tr_b16 a[28:29], v11 offset:12288
    buffer_load_dwordx4 v36, s[40:43], 0 offen offset:0 sc1 lds
    v_mfma_f32_16x16x32_bf16 v[204:207], a[32:35], v[124:127], v[204:207]
    ds_read_b64_tr_b16 a[30:31], v11 offset:14336
    s_waitcnt lgkmcnt(8)
    v_mfma_f32_16x16x32_bf16 v[188:191], a[0:3], v[140:143], v[188:191]
    ds_read_b64_tr_b16 a[32:33], v8 offset:16384
    v_mfma_f32_16x16x32_bf16 v[188:191], a[4:7], v[148:151], v[188:191]
    ds_read_b64_tr_b16 a[34:35], v8 offset:18432
    v_mfma_f32_16x16x32_bf16 v[192:195], a[8:11], v[140:143], v[192:195]
    ds_read_b64_tr_b16 a[36:37], v8 offset:20480
    buffer_load_dwordx4 v37, s[40:43], 0 offen offset:1024 sc1 lds
    v_mfma_f32_16x16x32_bf16 v[192:195], a[12:15], v[148:151], v[192:195]
    ds_read_b64_tr_b16 a[38:39], v8 offset:22528
    v_mfma_f32_16x16x32_bf16 v[200:203], a[12:15], v[152:155], v[200:203]
    ds_read_b64_tr_b16 a[40:41], v9 offset:16384
    v_mfma_f32_16x16x32_bf16 v[200:203], a[8:11], v[144:147], v[200:203]
    ds_read_b64_tr_b16 a[42:43], v9 offset:18432
    v_mfma_f32_16x16x32_bf16 v[196:199], a[4:7], v[152:155], v[196:199]
    ds_read_b64_tr_b16 a[44:45], v9 offset:20480
    buffer_load_dwordx4 v38, s[40:43], 0 offen offset:2048 sc1 lds
    v_mfma_f32_16x16x32_bf16 v[196:199], a[0:3], v[144:147], v[196:199]
    ds_read_b64_tr_b16 a[46:47], v9 offset:22528
    s_waitcnt lgkmcnt(8)
    v_mfma_f32_16x16x32_bf16 v[212:215], a[16:19], v[144:147], v[212:215]
    ds_read_b64_tr_b16 a[0:1], v10 offset:16384
    v_mfma_f32_16x16x32_bf16 v[212:215], a[20:23], v[152:155], v[212:215]
    ds_read_b64_tr_b16 a[2:3], v10 offset:18432
    v_mfma_f32_16x16x32_bf16 v[216:219], a[24:27], v[144:147], v[216:219]
    ds_read_b64_tr_b16 a[4:5], v10 offset:20480
    buffer_load_dwordx4 v39, s[40:43], 0 offen offset:3072 sc1 lds
    v_mfma_f32_16x16x32_bf16 v[216:219], a[28:31], v[152:155], v[216:219]
    ds_read_b64_tr_b16 a[6:7], v10 offset:22528
    v_mfma_f32_16x16x32_bf16 v[208:211], a[28:31], v[148:151], v[208:211]
    ds_read_b64_tr_b16 a[8:9], v11 offset:16384
    v_mfma_f32_16x16x32_bf16 v[208:211], a[24:27], v[140:143], v[208:211]
    ds_read_b64_tr_b16 a[10:11], v11 offset:18432
    v_mfma_f32_16x16x32_bf16 v[204:207], a[20:23], v[148:151], v[204:207]
    ds_read_b64_tr_b16 a[12:13], v11 offset:20480
    v_mfma_f32_16x16x32_bf16 v[204:207], a[16:19], v[140:143], v[204:207]
    ds_read_b64_tr_b16 a[14:15], v11 offset:22528
    s_waitcnt lgkmcnt(8)
    v_mfma_f32_16x16x32_bf16 v[156:159], a[32:35], v[44:47], 0
    ds_read_b64_tr_b16 a[16:17], v8 offset:24576
    s_add_u32 s71, s64, 0
    v_mfma_f32_16x16x32_bf16 v[156:159], a[36:39], v[52:55], v[156:159]
    ds_read_b64_tr_b16 a[18:19], v8 offset:26624
    s_bfe_u32 s3, s71, 0x10001
    v_mfma_f32_16x16x32_bf16 v[160:163], a[40:43], v[44:47], 0
    ds_read_b64_tr_b16 a[20:21], v8 offset:28672
    s_mul_i32 s3, s3, 114688
    v_mfma_f32_16x16x32_bf16 v[160:163], a[44:47], v[52:55], v[160:163]
    ds_read_b64_tr_b16 a[22:23], v8 offset:30720
    s_and_b32 s71, s71, 1
    v_mfma_f32_16x16x32_bf16 v[168:171], a[44:47], v[56:59], 0
    ds_read_b64_tr_b16 a[24:25], v9 offset:24576
    v_cvt_pk_bf16_f32 v188, v188, v189
    v_mfma_f32_16x16x32_bf16 v[168:171], a[40:43], v[48:51], v[168:171]
    ds_read_b64_tr_b16 a[26:27], v9 offset:26624
    v_cvt_pk_bf16_f32 v189, v190, v191
    v_mfma_f32_16x16x32_bf16 v[164:167], a[36:39], v[56:59], 0
    ds_read_b64_tr_b16 a[28:29], v9 offset:28672
    v_cvt_pk_bf16_f32 v190, v192, v193
    v_mfma_f32_16x16x32_bf16 v[164:167], a[32:35], v[48:51], v[164:167]
    ds_read_b64_tr_b16 a[30:31], v9 offset:30720
    s_waitcnt lgkmcnt(8)
    v_mfma_f32_16x16x32_bf16 v[180:183], a[0:3], v[48:51], 0
    ds_read_b64_tr_b16 a[32:33], v10 offset:24576
    v_cvt_pk_bf16_f32 v191, v194, v195
    v_mfma_f32_16x16x32_bf16 v[180:183], a[4:7], v[56:59], v[180:183]
    ds_read_b64_tr_b16 a[34:35], v10 offset:26624
    v_permlane32_swap_b32 v188, v190
    v_mfma_f32_16x16x32_bf16 v[184:187], a[8:11], v[48:51], 0
    ds_read_b64_tr_b16 a[36:37], v10 offset:28672
    v_permlane32_swap_b32 v189, v191
    v_mfma_f32_16x16x32_bf16 v[184:187], a[12:15], v[56:59], v[184:187]
    ds_read_b64_tr_b16 a[38:39], v10 offset:30720
    v_permlane16_swap_b32 v188, v190
    v_mfma_f32_16x16x32_bf16 v[176:179], a[12:15], v[52:55], 0
    ds_read_b64_tr_b16 a[40:41], v11 offset:24576
    v_permlane16_swap_b32 v189, v191
    v_mfma_f32_16x16x32_bf16 v[176:179], a[8:11], v[44:47], v[176:179]
    ds_read_b64_tr_b16 a[42:43], v11 offset:26624
    v_accvgpr_write_b32 a112, v188
    v_mfma_f32_16x16x32_bf16 v[172:175], a[4:7], v[52:55], 0
    ds_read_b64_tr_b16 a[44:45], v11 offset:28672
    v_accvgpr_write_b32 a113, v189
    v_mfma_f32_16x16x32_bf16 v[172:175], a[0:3], v[44:47], v[172:175]
    ds_read_b64_tr_b16 a[46:47], v11 offset:30720
    s_waitcnt vmcnt(22) lgkmcnt(8)
    v_mfma_f32_16x16x32_bf16 v[156:159], a[16:19], v[60:63], v[156:159]
    s_barrier
    ds_read_b64_tr_b16 a[0:1], v8 offset:32768
    v_mfma_f32_16x16x32_bf16 v[156:159], a[20:23], v[68:71], v[156:159]
    ds_read_b64_tr_b16 a[2:3], v8 offset:34816
    s_add_u32 m0, s67, 147456
    v_mfma_f32_16x16x32_bf16 v[160:163], a[24:27], v[60:63], v[160:163]
    ds_read_b64_tr_b16 a[4:5], v8 offset:36864
    v_accvgpr_write_b32 a114, v190
    v_mfma_f32_16x16x32_bf16 v[160:163], a[28:31], v[68:71], v[160:163]
    ds_read_b64_tr_b16 a[6:7], v8 offset:38912
    v_accvgpr_write_b32 a115, v191
    v_mfma_f32_16x16x32_bf16 v[168:171], a[28:31], v[72:75], v[168:171]
    ds_read_b64_tr_b16 a[8:9], v9 offset:32768
    v_cvt_pk_bf16_f32 v196, v196, v197
    v_mfma_f32_16x16x32_bf16 v[168:171], a[24:27], v[64:67], v[168:171]
    ds_read_b64_tr_b16 a[10:11], v9 offset:34816
    v_cvt_pk_bf16_f32 v197, v198, v199
    v_mfma_f32_16x16x32_bf16 v[164:167], a[20:23], v[72:75], v[164:167]
    ds_read_b64_tr_b16 a[12:13], v9 offset:36864
    s_mov_b32 s68, 16384
    v_mfma_f32_16x16x32_bf16 v[164:167], a[16:19], v[64:67], v[164:167]
    ds_read_b64_tr_b16 a[14:15], v9 offset:38912
    s_waitcnt lgkmcnt(8)
    v_mfma_f32_16x16x32_bf16 v[180:183], a[32:35], v[64:67], v[180:183]
    ds_read_b64_tr_b16 a[16:17], v10 offset:32768
    v_cvt_pk_bf16_f32 v198, v200, v201
    v_mfma_f32_16x16x32_bf16 v[180:183], a[36:39], v[72:75], v[180:183]
    ds_read_b64_tr_b16 a[18:19], v10 offset:34816
    v_cvt_pk_bf16_f32 v199, v202, v203
    v_mfma_f32_16x16x32_bf16 v[184:187], a[40:43], v[64:67], v[184:187]
    ds_read_b64_tr_b16 a[20:21], v10 offset:36864
    v_permlane32_swap_b32 v196, v198
    v_mfma_f32_16x16x32_bf16 v[184:187], a[44:47], v[72:75], v[184:187]
    ds_read_b64_tr_b16 a[22:23], v10 offset:38912
    buffer_load_dwordx4 v36, s[40:43], s68 offen offset:0 sc1 lds
    v_mfma_f32_16x16x32_bf16 v[176:179], a[44:47], v[68:71], v[176:179]
    ds_read_b64_tr_b16 a[24:25], v11 offset:32768
    v_permlane32_swap_b32 v197, v199
    v_mfma_f32_16x16x32_bf16 v[176:179], a[40:43], v[60:63], v[176:179]
    ds_read_b64_tr_b16 a[26:27], v11 offset:34816
    v_permlane16_swap_b32 v196, v198
    v_mfma_f32_16x16x32_bf16 v[172:175], a[36:39], v[68:71], v[172:175]
    ds_read_b64_tr_b16 a[28:29], v11 offset:36864
    v_permlane16_swap_b32 v197, v199
    v_mfma_f32_16x16x32_bf16 v[172:175], a[32:35], v[60:63], v[172:175]
    ds_read_b64_tr_b16 a[30:31], v11 offset:38912
    s_waitcnt lgkmcnt(8)
    v_mfma_f32_16x16x32_bf16 v[156:159], a[0:3], v[76:79], v[156:159]
    ds_read_b64_tr_b16 a[32:33], v8 offset:40960
    buffer_load_dwordx4 v37, s[40:43], s68 offen offset:1024 sc1 lds
    v_mfma_f32_16x16x32_bf16 v[156:159], a[4:7], v[84:87], v[156:159]
    ds_read_b64_tr_b16 a[34:35], v8 offset:43008
    v_accvgpr_write_b32 a116, v196
    v_mfma_f32_16x16x32_bf16 v[160:163], a[8:11], v[76:79], v[160:163]
    ds_read_b64_tr_b16 a[36:37], v8 offset:45056
    v_accvgpr_write_b32 a117, v197
    v_mfma_f32_16x16x32_bf16 v[160:163], a[12:15], v[84:87], v[160:163]
    ds_read_b64_tr_b16 a[38:39], v8 offset:47104
    v_accvgpr_write_b32 a118, v198
    v_mfma_f32_16x16x32_bf16 v[168:171], a[12:15], v[88:91], v[168:171]
    ds_read_b64_tr_b16 a[40:41], v9 offset:40960
    v_accvgpr_write_b32 a119, v199
    v_mfma_f32_16x16x32_bf16 v[168:171], a[8:11], v[80:83], v[168:171]
    ds_read_b64_tr_b16 a[42:43], v9 offset:43008
    buffer_load_dwordx4 v38, s[40:43], s68 offen offset:2048 sc1 lds
    v_mfma_f32_16x16x32_bf16 v[164:167], a[4:7], v[88:91], v[164:167]
    ds_read_b64_tr_b16 a[44:45], v9 offset:45056
    v_cvt_pk_bf16_f32 v204, v204, v205
    v_mfma_f32_16x16x32_bf16 v[164:167], a[0:3], v[80:83], v[164:167]
    ds_read_b64_tr_b16 a[46:47], v9 offset:47104
    s_waitcnt lgkmcnt(8)
    v_mfma_f32_16x16x32_bf16 v[180:183], a[16:19], v[80:83], v[180:183]
    ds_read_b64_tr_b16 a[0:1], v10 offset:40960
    v_cvt_pk_bf16_f32 v205, v206, v207
    v_mfma_f32_16x16x32_bf16 v[180:183], a[20:23], v[88:91], v[180:183]
    ds_read_b64_tr_b16 a[2:3], v10 offset:43008
    v_cvt_pk_bf16_f32 v206, v208, v209
    v_mfma_f32_16x16x32_bf16 v[184:187], a[24:27], v[80:83], v[184:187]
    ds_read_b64_tr_b16 a[4:5], v10 offset:45056
    buffer_load_dwordx4 v39, s[40:43], s68 offen offset:3072 sc1 lds
    v_mfma_f32_16x16x32_bf16 v[184:187], a[28:31], v[88:91], v[184:187]
    ds_read_b64_tr_b16 a[6:7], v10 offset:47104
    s_add_u32 m0, s67, 0
    v_mfma_f32_16x16x32_bf16 v[176:179], a[28:31], v[84:87], v[176:179]
    ds_read_b64_tr_b16 a[8:9], v11 offset:40960
    v_cvt_pk_bf16_f32 v207, v210, v211
    v_mfma_f32_16x16x32_bf16 v[176:179], a[24:27], v[76:79], v[176:179]
    ds_read_b64_tr_b16 a[10:11], v11 offset:43008
    v_permlane32_swap_b32 v204, v206
    v_mfma_f32_16x16x32_bf16 v[172:175], a[20:23], v[84:87], v[172:175]
    ds_read_b64_tr_b16 a[12:13], v11 offset:45056
    buffer_load_dwordx4 v40, s[44:47], 0 offen offset:0 sc1 lds
    v_mfma_f32_16x16x32_bf16 v[172:175], a[16:19], v[76:79], v[172:175]
    ds_read_b64_tr_b16 a[14:15], v11 offset:47104
    s_waitcnt lgkmcnt(8)
    v_mfma_f32_16x16x32_bf16 v[156:159], a[32:35], v[92:95], v[156:159]
    ds_read_b64_tr_b16 a[16:17], v8 offset:49152
    v_permlane32_swap_b32 v205, v207
    v_mfma_f32_16x16x32_bf16 v[156:159], a[36:39], v[100:103], v[156:159]
    ds_read_b64_tr_b16 a[18:19], v8 offset:51200
    v_permlane16_swap_b32 v204, v206
    v_mfma_f32_16x16x32_bf16 v[160:163], a[40:43], v[92:95], v[160:163]
    ds_read_b64_tr_b16 a[20:21], v8 offset:53248
    buffer_load_dwordx4 v41, s[44:47], 0 offen offset:1024 sc1 lds
    v_mfma_f32_16x16x32_bf16 v[160:163], a[44:47], v[100:103], v[160:163]
    ds_read_b64_tr_b16 a[22:23], v8 offset:55296
    v_permlane16_swap_b32 v205, v207
    v_mfma_f32_16x16x32_bf16 v[168:171], a[44:47], v[104:107], v[168:171]
    ds_read_b64_tr_b16 a[24:25], v9 offset:49152
    v_accvgpr_write_b32 a120, v204
    v_mfma_f32_16x16x32_bf16 v[168:171], a[40:43], v[96:99], v[168:171]
    ds_read_b64_tr_b16 a[26:27], v9 offset:51200
    v_accvgpr_write_b32 a121, v205
    v_mfma_f32_16x16x32_bf16 v[164:167], a[36:39], v[104:107], v[164:167]
    ds_read_b64_tr_b16 a[28:29], v9 offset:53248
    buffer_load_dwordx4 v42, s[44:47], 0 offen offset:2048 sc1 lds
    v_mfma_f32_16x16x32_bf16 v[164:167], a[32:35], v[96:99], v[164:167]
    ds_read_b64_tr_b16 a[30:31], v9 offset:55296
    s_waitcnt lgkmcnt(8)
    v_mfma_f32_16x16x32_bf16 v[180:183], a[0:3], v[96:99], v[180:183]
    ds_read_b64_tr_b16 a[32:33], v10 offset:49152
    v_accvgpr_write_b32 a122, v206
    v_mfma_f32_16x16x32_bf16 v[180:183], a[4:7], v[104:107], v[180:183]
    ds_read_b64_tr_b16 a[34:35], v10 offset:51200
    v_accvgpr_write_b32 a123, v207
    v_mfma_f32_16x16x32_bf16 v[184:187], a[8:11], v[96:99], v[184:187]
    ds_read_b64_tr_b16 a[36:37], v10 offset:53248
    buffer_load_dwordx4 v43, s[44:47], 0 offen offset:3072 sc1 lds
    v_mfma_f32_16x16x32_bf16 v[184:187], a[12:15], v[104:107], v[184:187]
    ds_read_b64_tr_b16 a[38:39], v10 offset:55296
    v_cvt_pk_bf16_f32 v212, v212, v213
    v_mfma_f32_16x16x32_bf16 v[176:179], a[12:15], v[100:103], v[176:179]
    ds_read_b64_tr_b16 a[40:41], v11 offset:49152
    v_cvt_pk_bf16_f32 v213, v214, v215
    v_mfma_f32_16x16x32_bf16 v[176:179], a[8:11], v[92:95], v[176:179]
    ds_read_b64_tr_b16 a[42:43], v11 offset:51200
    v_cvt_pk_bf16_f32 v214, v216, v217
    v_mfma_f32_16x16x32_bf16 v[172:175], a[4:7], v[100:103], v[172:175]
    ds_read_b64_tr_b16 a[44:45], v11 offset:53248
    v_cvt_pk_bf16_f32 v215, v218, v219
    v_mfma_f32_16x16x32_bf16 v[172:175], a[0:3], v[92:95], v[172:175]
    ds_read_b64_tr_b16 a[46:47], v11 offset:55296
    s_waitcnt lgkmcnt(8)
    v_mfma_f32_16x16x32_bf16 v[156:159], a[16:19], v[108:111], v[156:159]
    ds_read_b64_tr_b16 a[0:1], v8 offset:57344
    v_permlane32_swap_b32 v212, v214
    v_mfma_f32_16x16x32_bf16 v[156:159], a[20:23], v[116:119], v[156:159]
    ds_read_b64_tr_b16 a[2:3], v8 offset:59392
    v_permlane32_swap_b32 v213, v215
    v_mfma_f32_16x16x32_bf16 v[160:163], a[24:27], v[108:111], v[160:163]
    ds_read_b64_tr_b16 a[4:5], v8 offset:61440
    v_permlane16_swap_b32 v212, v214
    v_mfma_f32_16x16x32_bf16 v[160:163], a[28:31], v[116:119], v[160:163]
    ds_read_b64_tr_b16 a[6:7], v8 offset:63488
    v_permlane16_swap_b32 v213, v215
    v_mfma_f32_16x16x32_bf16 v[168:171], a[28:31], v[120:123], v[168:171]
    ds_read_b64_tr_b16 a[8:9], v9 offset:57344
    v_accvgpr_write_b32 a124, v212
    v_mfma_f32_16x16x32_bf16 v[168:171], a[24:27], v[112:115], v[168:171]
    ds_read_b64_tr_b16 a[10:11], v9 offset:59392
    v_accvgpr_write_b32 a125, v213
    v_mfma_f32_16x16x32_bf16 v[164:167], a[20:23], v[120:123], v[164:167]
    ds_read_b64_tr_b16 a[12:13], v9 offset:61440
    v_accvgpr_write_b32 a126, v214
    v_mfma_f32_16x16x32_bf16 v[164:167], a[16:19], v[112:115], v[164:167]
    ds_read_b64_tr_b16 a[14:15], v9 offset:63488
    s_waitcnt lgkmcnt(8)
    v_mfma_f32_16x16x32_bf16 v[180:183], a[32:35], v[112:115], v[180:183]
    ds_read_b64_tr_b16 a[16:17], v10 offset:57344
    v_accvgpr_write_b32 a127, v215
    v_mfma_f32_16x16x32_bf16 v[180:183], a[36:39], v[120:123], v[180:183]
    ds_read_b64_tr_b16 a[18:19], v10 offset:59392
    s_lshl_b32 s71, s71, 10
    v_mfma_f32_16x16x32_bf16 v[184:187], a[40:43], v[112:115], v[184:187]
    ds_read_b64_tr_b16 a[20:21], v10 offset:61440
    s_add_u32 s71, s71, s3
    v_mfma_f32_16x16x32_bf16 v[184:187], a[44:47], v[120:123], v[184:187]
    ds_read_b64_tr_b16 a[22:23], v10 offset:63488
    s_add_u32 s98, s87, s71
    v_mfma_f32_16x16x32_bf16 v[176:179], a[44:47], v[116:119], v[176:179]
    ds_read_b64_tr_b16 a[24:25], v11 offset:57344
    s_add_u32 s71, s64, 1
    v_mfma_f32_16x16x32_bf16 v[176:179], a[40:43], v[108:111], v[176:179]
    ds_read_b64_tr_b16 a[26:27], v11 offset:59392
    s_bfe_u32 s3, s71, 0x10001
    v_mfma_f32_16x16x32_bf16 v[172:175], a[36:39], v[116:119], v[172:175]
    ds_read_b64_tr_b16 a[28:29], v11 offset:61440
    s_mul_i32 s3, s3, 114688
    v_mfma_f32_16x16x32_bf16 v[172:175], a[32:35], v[108:111], v[172:175]
    ds_read_b64_tr_b16 a[30:31], v11 offset:63488
    s_waitcnt vmcnt(21) lgkmcnt(8)
    v_mfma_f32_16x16x32_bf16 v[156:159], a[0:3], v[124:127], v[156:159]
    s_barrier
    ds_read_b64_tr_b16 a[32:33], v12 offset:0
    v_mfma_f32_16x16x32_bf16 v[156:159], a[4:7], v[132:135], v[156:159]
    ds_read_b64_tr_b16 a[34:35], v12 offset:2048
    s_add_u32 m0, s67, 16384
    v_mfma_f32_16x16x32_bf16 v[160:163], a[8:11], v[124:127], v[160:163]
    ds_read_b64_tr_b16 a[36:37], v12 offset:4096
    s_and_b32 s71, s71, 1
    v_mfma_f32_16x16x32_bf16 v[160:163], a[12:15], v[132:135], v[160:163]
    ds_read_b64_tr_b16 a[38:39], v12 offset:6144
    s_lshl_b32 s71, s71, 10
    v_mfma_f32_16x16x32_bf16 v[168:171], a[12:15], v[136:139], v[168:171]
    ds_read_b64_tr_b16 a[40:41], v13 offset:0
    s_add_u32 s71, s71, s3
    v_mfma_f32_16x16x32_bf16 v[168:171], a[8:11], v[128:131], v[168:171]
    ds_read_b64_tr_b16 a[42:43], v13 offset:2048
    s_add_u32 s99, s87, s71
    v_mfma_f32_16x16x32_bf16 v[164:167], a[4:7], v[136:139], v[164:167]
    ds_read_b64_tr_b16 a[44:45], v13 offset:4096
    s_mov_b32 s68, 32768
    v_mfma_f32_16x16x32_bf16 v[164:167], a[0:3], v[128:131], v[164:167]
    ds_read_b64_tr_b16 a[46:47], v13 offset:6144
    s_waitcnt lgkmcnt(8)
    v_mfma_f32_16x16x32_bf16 v[180:183], a[16:19], v[128:131], v[180:183]
    ds_read_b64_tr_b16 a[0:1], v14 offset:0
    s_add_u32 s71, s64, 2
    v_mfma_f32_16x16x32_bf16 v[180:183], a[20:23], v[136:139], v[180:183]
    ds_read_b64_tr_b16 a[2:3], v14 offset:2048
    s_bfe_u32 s3, s71, 0x10001
    v_mfma_f32_16x16x32_bf16 v[184:187], a[24:27], v[128:131], v[184:187]
    ds_read_b64_tr_b16 a[4:5], v14 offset:4096
    s_mul_i32 s3, s3, 114688
    v_mfma_f32_16x16x32_bf16 v[184:187], a[28:31], v[136:139], v[184:187]
    ds_read_b64_tr_b16 a[6:7], v14 offset:6144
    buffer_load_dwordx4 v36, s[40:43], s68 offen offset:0 sc1 lds
    v_mfma_f32_16x16x32_bf16 v[176:179], a[28:31], v[132:135], v[176:179]
    ds_read_b64_tr_b16 a[8:9], v15 offset:0
    s_and_b32 s71, s71, 1
    v_mfma_f32_16x16x32_bf16 v[176:179], a[24:27], v[124:127], v[176:179]
    ds_read_b64_tr_b16 a[10:11], v15 offset:2048
    s_lshl_b32 s71, s71, 10
    v_mfma_f32_16x16x32_bf16 v[172:175], a[20:23], v[132:135], v[172:175]
    ds_read_b64_tr_b16 a[12:13], v15 offset:4096
    s_add_u32 s71, s71, s3
    v_mfma_f32_16x16x32_bf16 v[172:175], a[16:19], v[124:127], v[172:175]
    ds_read_b64_tr_b16 a[14:15], v15 offset:6144
    s_waitcnt lgkmcnt(8)
    v_mfma_f32_16x16x32_bf16 v[156:159], a[32:35], v[140:143], v[156:159]
    ds_read_b64_tr_b16 a[16:17], v12 offset:8192
    buffer_load_dwordx4 v37, s[40:43], s68 offen offset:1024 sc1 lds
    v_mfma_f32_16x16x32_bf16 v[156:159], a[36:39], v[148:151], v[156:159]
    ds_read_b64_tr_b16 a[18:19], v12 offset:10240
    s_add_u32 s100, s87, s71
    v_mfma_f32_16x16x32_bf16 v[160:163], a[40:43], v[140:143], v[160:163]
    ds_read_b64_tr_b16 a[20:21], v12 offset:12288
    s_add_u32 s71, s64, 3
    v_mfma_f32_16x16x32_bf16 v[160:163], a[44:47], v[148:151], v[160:163]
    ds_read_b64_tr_b16 a[22:23], v12 offset:14336
    s_bfe_u32 s3, s71, 0x10001
    v_mfma_f32_16x16x32_bf16 v[168:171], a[44:47], v[152:155], v[168:171]
    ds_read_b64_tr_b16 a[24:25], v13 offset:8192
    s_mul_i32 s3, s3, 114688
    v_mfma_f32_16x16x32_bf16 v[168:171], a[40:43], v[144:147], v[168:171]
    ds_read_b64_tr_b16 a[26:27], v13 offset:10240
    buffer_load_dwordx4 v38, s[40:43], s68 offen offset:2048 sc1 lds
    v_mfma_f32_16x16x32_bf16 v[164:167], a[36:39], v[152:155], v[164:167]
    ds_read_b64_tr_b16 a[28:29], v13 offset:12288
    s_and_b32 s71, s71, 1
    v_mfma_f32_16x16x32_bf16 v[164:167], a[32:35], v[144:147], v[164:167]
    ds_read_b64_tr_b16 a[30:31], v13 offset:14336
    s_waitcnt lgkmcnt(8)
    v_mfma_f32_16x16x32_bf16 v[180:183], a[0:3], v[144:147], v[180:183]
    ds_read_b64_tr_b16 a[32:33], v14 offset:8192
    s_lshl_b32 s71, s71, 10
    v_mfma_f32_16x16x32_bf16 v[180:183], a[4:7], v[152:155], v[180:183]
    ds_read_b64_tr_b16 a[34:35], v14 offset:10240
    s_add_u32 s71, s71, s3
    v_mfma_f32_16x16x32_bf16 v[184:187], a[8:11], v[144:147], v[184:187]
    ds_read_b64_tr_b16 a[36:37], v14 offset:12288
    buffer_load_dwordx4 v39, s[40:43], s68 offen offset:3072 sc1 lds
    v_mfma_f32_16x16x32_bf16 v[184:187], a[12:15], v[152:155], v[184:187]
    ds_read_b64_tr_b16 a[38:39], v14 offset:14336
    s_add_u32 m0, s67, 32768
    v_mfma_f32_16x16x32_bf16 v[176:179], a[12:15], v[148:151], v[176:179]
    ds_read_b64_tr_b16 a[40:41], v15 offset:8192
    s_add_u32 s101, s87, s71
    v_mfma_f32_16x16x32_bf16 v[176:179], a[8:11], v[140:143], v[176:179]
    ds_read_b64_tr_b16 a[42:43], v15 offset:10240
    s_mov_b32 s68, 16384
    v_mfma_f32_16x16x32_bf16 v[172:175], a[4:7], v[148:151], v[172:175]
    ds_read_b64_tr_b16 a[44:45], v15 offset:12288
    v_mfma_f32_16x16x32_bf16 v[172:175], a[0:3], v[140:143], v[172:175]
    ds_read_b64_tr_b16 a[46:47], v15 offset:14336
    s_waitcnt lgkmcnt(8)
    v_mfma_f32_16x16x32_bf16 v[188:191], a[16:19], v[44:47], 0
    ds_read_b64_tr_b16 a[0:1], v12 offset:16384
    buffer_load_dwordx4 v40, s[44:47], s68 offen offset:0 sc1 lds
    v_mfma_f32_16x16x32_bf16 v[188:191], a[20:23], v[52:55], v[188:191]
    ds_read_b64_tr_b16 a[2:3], v12 offset:18432
    v_mfma_f32_16x16x32_bf16 v[192:195], a[24:27], v[44:47], 0
    ds_read_b64_tr_b16 a[4:5], v12 offset:20480
    v_mfma_f32_16x16x32_bf16 v[192:195], a[28:31], v[52:55], v[192:195]
    ds_read_b64_tr_b16 a[6:7], v12 offset:22528
    v_mfma_f32_16x16x32_bf16 v[200:203], a[28:31], v[56:59], 0
    ds_read_b64_tr_b16 a[8:9], v13 offset:16384
    buffer_load_dwordx4 v41, s[44:47], s68 offen offset:1024 sc1 lds
    v_max_f32 v156, 0, v156
    v_mfma_f32_16x16x32_bf16 v[200:203], a[24:27], v[48:51], v[200:203]
    ds_read_b64_tr_b16 a[10:11], v13 offset:18432
    v_max_f32 v157, 0, v157
    v_mfma_f32_16x16x32_bf16 v[196:199], a[20:23], v[56:59], 0
    ds_read_b64_tr_b16 a[12:13], v13 offset:20480
    v_max_f32 v158, 0, v158
    v_mfma_f32_16x16x32_bf16 v[196:199], a[16:19], v[48:51], v[196:199]
    ds_read_b64_tr_b16 a[14:15], v13 offset:22528
    s_waitcnt lgkmcnt(8)
    v_mfma_f32_16x16x32_bf16 v[212:215], a[32:35], v[48:51], 0
    ds_read_b64_tr_b16 a[16:17], v14 offset:16384
    buffer_load_dwordx4 v42, s[44:47], s68 offen offset:2048 sc1 lds
    v_mfma_f32_16x16x32_bf16 v[212:215], a[36:39], v[56:59], v[212:215]
    ds_read_b64_tr_b16 a[18:19], v14 offset:18432
    v_max_f32 v159, 0, v159
    v_mfma_f32_16x16x32_bf16 v[216:219], a[40:43], v[48:51], 0
    ds_read_b64_tr_b16 a[20:21], v14 offset:20480
    buffer_load_dwordx4 v43, s[44:47], s68 offen offset:3072 sc1 lds
    v_mfma_f32_16x16x32_bf16 v[216:219], a[44:47], v[56:59], v[216:219]
    ds_read_b64_tr_b16 a[22:23], v14 offset:22528
    v_max_f32 v160, 0, v160
    v_mfma_f32_16x16x32_bf16 v[208:211], a[44:47], v[52:55], 0
    ds_read_b64_tr_b16 a[24:25], v15 offset:16384
    v_max_f32 v161, 0, v161
    v_mfma_f32_16x16x32_bf16 v[208:211], a[40:43], v[44:47], v[208:211]
    ds_read_b64_tr_b16 a[26:27], v15 offset:18432
    v_max_f32 v162, 0, v162
    v_mfma_f32_16x16x32_bf16 v[204:207], a[36:39], v[52:55], 0
    ds_read_b64_tr_b16 a[28:29], v15 offset:20480
    v_max_f32 v163, 0, v163
    v_mfma_f32_16x16x32_bf16 v[204:207], a[32:35], v[44:47], v[204:207]
    ds_read_b64_tr_b16 a[30:31], v15 offset:22528
    s_waitcnt lgkmcnt(8)
    v_mfma_f32_16x16x32_bf16 v[188:191], a[0:3], v[60:63], v[188:191]
    ds_read_b64_tr_b16 a[32:33], v12 offset:24576
    v_cvt_pk_bf16_f32 v156, v156, v157
    v_mfma_f32_16x16x32_bf16 v[188:191], a[4:7], v[68:71], v[188:191]
    ds_read_b64_tr_b16 a[34:35], v12 offset:26624
    v_cvt_pk_bf16_f32 v157, v158, v159
    v_mfma_f32_16x16x32_bf16 v[192:195], a[8:11], v[60:63], v[192:195]
    ds_read_b64_tr_b16 a[36:37], v12 offset:28672
    v_cvt_pk_bf16_f32 v158, v160, v161
    v_mfma_f32_16x16x32_bf16 v[192:195], a[12:15], v[68:71], v[192:195]
    ds_read_b64_tr_b16 a[38:39], v12 offset:30720
    v_cvt_pk_bf16_f32 v159, v162, v163
    v_mfma_f32_16x16x32_bf16 v[200:203], a[12:15], v[72:75], v[200:203]
    ds_read_b64_tr_b16 a[40:41], v13 offset:24576
    buffer_store_dwordx4 v[156:159], v2, s[56:59], s86 offen offset:0 sc1
    v_mfma_f32_16x16x32_bf16 v[200:203], a[8:11], v[64:67], v[200:203]
    ds_read_b64_tr_b16 a[42:43], v13 offset:26624
    v_max_f32 v164, 0, v164
    v_mfma_f32_16x16x32_bf16 v[196:199], a[4:7], v[72:75], v[196:199]
    ds_read_b64_tr_b16 a[44:45], v13 offset:28672
    v_max_f32 v165, 0, v165
    v_mfma_f32_16x16x32_bf16 v[196:199], a[0:3], v[64:67], v[196:199]
    ds_read_b64_tr_b16 a[46:47], v13 offset:30720
    s_waitcnt lgkmcnt(8)
    v_mfma_f32_16x16x32_bf16 v[212:215], a[16:19], v[64:67], v[212:215]
    ds_read_b64_tr_b16 a[0:1], v14 offset:24576
    v_max_f32 v166, 0, v166
    v_mfma_f32_16x16x32_bf16 v[212:215], a[20:23], v[72:75], v[212:215]
    ds_read_b64_tr_b16 a[2:3], v14 offset:26624
    v_max_f32 v167, 0, v167
    v_mfma_f32_16x16x32_bf16 v[216:219], a[24:27], v[64:67], v[216:219]
    ds_read_b64_tr_b16 a[4:5], v14 offset:28672
    v_max_f32 v168, 0, v168
    v_mfma_f32_16x16x32_bf16 v[216:219], a[28:31], v[72:75], v[216:219]
    ds_read_b64_tr_b16 a[6:7], v14 offset:30720
    v_max_f32 v169, 0, v169
    v_mfma_f32_16x16x32_bf16 v[208:211], a[28:31], v[68:71], v[208:211]
    ds_read_b64_tr_b16 a[8:9], v15 offset:24576
    v_max_f32 v170, 0, v170
L_pg3:
    s_cbranch_execz L_pg7
    v_mfma_f32_16x16x32_bf16 v[208:211], a[24:27], v[60:63], v[208:211]
    ds_read_b64_tr_b16 a[10:11], v15 offset:26624
    v_max_f32 v171, 0, v171
    v_mfma_f32_16x16x32_bf16 v[204:207], a[20:23], v[68:71], v[204:207]
    ds_read_b64_tr_b16 a[12:13], v15 offset:28672
    v_cvt_pk_bf16_f32 v164, v164, v165
    v_mfma_f32_16x16x32_bf16 v[204:207], a[16:19], v[60:63], v[204:207]
    ds_read_b64_tr_b16 a[14:15], v15 offset:30720
    s_waitcnt vmcnt(21) lgkmcnt(8)
    v_mfma_f32_16x16x32_bf16 v[188:191], a[32:35], v[76:79], v[188:191]
    s_barrier
    ds_read_b64_tr_b16 a[16:17], v12 offset:32768
    v_mfma_f32_16x16x32_bf16 v[188:191], a[36:39], v[84:87], v[188:191]
    ds_read_b64_tr_b16 a[18:19], v12 offset:34816
    s_add_u32 m0, s67, 49152
    v_mfma_f32_16x16x32_bf16 v[192:195], a[40:43], v[76:79], v[192:195]
    ds_read_b64_tr_b16 a[20:21], v12 offset:36864
    v_cvt_pk_bf16_f32 v165, v166, v167
    v_mfma_f32_16x16x32_bf16 v[192:195], a[44:47], v[84:87], v[192:195]
    ds_read_b64_tr_b16 a[22:23], v12 offset:38912
    v_cvt_pk_bf16_f32 v166, v168, v169
    v_mfma_f32_16x16x32_bf16 v[200:203], a[44:47], v[88:91], v[200:203]
    ds_read_b64_tr_b16 a[24:25], v13 offset:32768
    v_cvt_pk_bf16_f32 v167, v170, v171
    v_mfma_f32_16x16x32_bf16 v[200:203], a[40:43], v[80:83], v[200:203]
    ds_read_b64_tr_b16 a[26:27], v13 offset:34816
    buffer_store_dwordx4 v[164:167], v2, s[56:59], s86 offen offset:1024 sc1
    v_mfma_f32_16x16x32_bf16 v[196:199], a[36:39], v[88:91], v[196:199]
    ds_read_b64_tr_b16 a[28:29], v13 offset:36864
    s_mov_b32 s68, 49152
    v_mfma_f32_16x16x32_bf16 v[196:199], a[32:35], v[80:83], v[196:199]
    ds_read_b64_tr_b16 a[30:31], v13 offset:38912
    s_waitcnt lgkmcnt(8)
    v_mfma_f32_16x16x32_bf16 v[212:215], a[0:3], v[80:83], v[212:215]
    ds_read_b64_tr_b16 a[32:33], v14 offset:32768
    v_max_f32 v172, 0, v172
    v_mfma_f32_16x16x32_bf16 v[212:215], a[4:7], v[88:91], v[212:215]
    ds_read_b64_tr_b16 a[34:35], v14 offset:34816
    v_max_f32 v173, 0, v173
    v_mfma_f32_16x16x32_bf16 v[216:219], a[8:11], v[80:83], v[216:219]
    ds_read_b64_tr_b16 a[36:37], v14 offset:36864
    v_max_f32 v174, 0, v174
    v_mfma_f32_16x16x32_bf16 v[216:219], a[12:15], v[88:91], v[216:219]
    ds_read_b64_tr_b16 a[38:39], v14 offset:38912
    buffer_load_dwordx4 v36, s[40:43], s68 offen offset:0 sc1 lds
    v_mfma_f32_16x16x32_bf16 v[208:211], a[12:15], v[84:87], v[208:211]
    ds_read_b64_tr_b16 a[40:41], v15 offset:32768
    v_max_f32 v175, 0, v175
    v_mfma_f32_16x16x32_bf16 v[208:211], a[8:11], v[76:79], v[208:211]
    ds_read_b64_tr_b16 a[42:43], v15 offset:34816
    v_max_f32 v176, 0, v176
    v_mfma_f32_16x16x32_bf16 v[204:207], a[4:7], v[84:87], v[204:207]
    ds_read_b64_tr_b16 a[44:45], v15 offset:36864
    v_max_f32 v177, 0, v177
    v_mfma_f32_16x16x32_bf16 v[204:207], a[0:3], v[76:79], v[204:207]
    ds_read_b64_tr_b16 a[46:47], v15 offset:38912
    s_waitcnt lgkmcnt(8)
    v_mfma_f32_16x16x32_bf16 v[188:191], a[16:19], v[92:95], v[188:191]
    ds_read_b64_tr_b16 a[0:1], v12 offset:40960
    buffer_load_dwordx4 v37, s[40:43], s68 offen offset:1024 sc1 lds
    v_mfma_f32_16x16x32_bf16 v[188:191], a[20:23], v[100:103], v[188:191]
    ds_read_b64_tr_b16 a[2:3], v12 offset:43008
    v_max_f32 v178, 0, v178
    v_mfma_f32_16x16x32_bf16 v[192:195], a[24:27], v[92:95], v[192:195]
    ds_read_b64_tr_b16 a[4:5], v12 offset:45056
    v_max_f32 v179, 0, v179
    v_mfma_f32_16x16x32_bf16 v[192:195], a[28:31], v[100:103], v[192:195]
    ds_read_b64_tr_b16 a[6:7], v12 offset:47104
    v_cvt_pk_bf16_f32 v172, v172, v173
    v_mfma_f32_16x16x32_bf16 v[200:203], a[28:31], v[104:107], v[200:203]
    ds_read_b64_tr_b16 a[8:9], v13 offset:40960
    v_cvt_pk_bf16_f32 v173, v174, v175
    v_mfma_f32_16x16x32_bf16 v[200:203], a[24:27], v[96:99], v[200:203]
    ds_read_b64_tr_b16 a[10:11], v13 offset:43008
    buffer_load_dwordx4 v38, s[40:43], s68 offen offset:2048 sc1 lds
    v_mfma_f32_16x16x32_bf16 v[196:199], a[20:23], v[104:107], v[196:199]
    ds_read_b64_tr_b16 a[12:13], v13 offset:45056
    v_cvt_pk_bf16_f32 v174, v176, v177
    v_mfma_f32_16x16x32_bf16 v[196:199], a[16:19], v[96:99], v[196:199]
    ds_read_b64_tr_b16 a[14:15], v13 offset:47104
    s_waitcnt lgkmcnt(8)
    v_mfma_f32_16x16x32_bf16 v[212:215], a[32:35], v[96:99], v[212:215]
    ds_read_b64_tr_b16 a[16:17], v14 offset:40960
    v_cvt_pk_bf16_f32 v175, v178, v179
    v_mfma_f32_16x16x32_bf16 v[212:215], a[36:39], v[104:107], v[212:215]
    ds_read_b64_tr_b16 a[18:19], v14 offset:43008
    buffer_store_dwordx4 v[172:175], v2, s[56:59], s86 offen offset:2048 sc1
    v_mfma_f32_16x16x32_bf16 v[216:219], a[40:43], v[96:99], v[216:219]
    ds_read_b64_tr_b16 a[20:21], v14 offset:45056
    buffer_load_dwordx4 v39, s[40:43], s68 offen offset:3072 sc1 lds
    v_mfma_f32_16x16x32_bf16 v[216:219], a[44:47], v[104:107], v[216:219]
    ds_read_b64_tr_b16 a[22:23], v14 offset:47104
    s_add_u32 m0, s67, 65536
    v_mfma_f32_16x16x32_bf16 v[208:211], a[44:47], v[100:103], v[208:211]
    ds_read_b64_tr_b16 a[24:25], v15 offset:40960
    v_max_f32 v180, 0, v180
    v_mfma_f32_16x16x32_bf16 v[208:211], a[40:43], v[92:95], v[208:211]
    ds_read_b64_tr_b16 a[26:27], v15 offset:43008
    s_mov_b32 s68, 32768
    v_mfma_f32_16x16x32_bf16 v[204:207], a[36:39], v[100:103], v[204:207]
    ds_read_b64_tr_b16 a[28:29], v15 offset:45056
    v_max_f32 v181, 0, v181
    v_mfma_f32_16x16x32_bf16 v[204:207], a[32:35], v[92:95], v[204:207]
    ds_read_b64_tr_b16 a[30:31], v15 offset:47104
    s_waitcnt lgkmcnt(8)
    v_mfma_f32_16x16x32_bf16 v[188:191], a[0:3], v[108:111], v[188:191]
    ds_read_b64_tr_b16 a[32:33], v12 offset:49152
    buffer_load_dwordx4 v40, s[44:47], s68 offen offset:0 sc1 lds
    v_mfma_f32_16x16x32_bf16 v[188:191], a[4:7], v[116:119], v[188:191]
    ds_read_b64_tr_b16 a[34:35], v12 offset:51200
    v_max_f32 v182, 0, v182
    v_mfma_f32_16x16x32_bf16 v[192:195], a[8:11], v[108:111], v[192:195]
    ds_read_b64_tr_b16 a[36:37], v12 offset:53248
    v_max_f32 v183, 0, v183
    v_mfma_f32_16x16x32_bf16 v[192:195], a[12:15], v[116:119], v[192:195]
    ds_read_b64_tr_b16 a[38:39], v12 offset:55296
    v_max_f32 v184, 0, v184
    v_mfma_f32_16x16x32_bf16 v[200:203], a[12:15], v[120:123], v[200:203]
    ds_read_b64_tr_b16 a[40:41], v12 offset:57344
    buffer_load_dwordx4 v41, s[44:47], s68 offen offset:1024 sc1 lds
    v_mfma_f32_16x16x32_bf16 v[200:203], a[8:11], v[112:115], v[200:203]
    ds_read_b64_tr_b16 a[42:43], v12 offset:59392
    v_max_f32 v185, 0, v185
    v_mfma_f32_16x16x32_bf16 v[196:199], a[4:7], v[120:123], v[196:199]
    ds_read_b64_tr_b16 a[44:45], v12 offset:61440
    v_max_f32 v186, 0, v186
    v_mfma_f32_16x16x32_bf16 v[196:199], a[0:3], v[112:115], v[196:199]
    ds_read_b64_tr_b16 a[46:47], v12 offset:63488
    s_waitcnt lgkmcnt(8)
    v_mfma_f32_16x16x32_bf16 v[212:215], a[16:19], v[112:115], v[212:215]
    ds_read_b64_tr_b16 a[0:1], v13 offset:49152
    buffer_load_dwordx4 v42, s[44:47], s68 offen offset:2048 sc1 lds
    v_mfma_f32_16x16x32_bf16 v[212:215], a[20:23], v[120:123], v[212:215]
    ds_read_b64_tr_b16 a[2:3], v13 offset:51200
    v_max_f32 v187, 0, v187
    v_mfma_f32_16x16x32_bf16 v[216:219], a[24:27], v[112:115], v[216:219]
    ds_read_b64_tr_b16 a[4:5], v13 offset:53248
    buffer_load_dwordx4 v43, s[44:47], s68 offen offset:3072 sc1 lds
    v_mfma_f32_16x16x32_bf16 v[216:219], a[28:31], v[120:123], v[216:219]
    ds_read_b64_tr_b16 a[6:7], v13 offset:55296
    v_cvt_pk_bf16_f32 v180, v180, v181
    v_mfma_f32_16x16x32_bf16 v[208:211], a[28:31], v[116:119], v[208:211]
    ds_read_b64_tr_b16 a[8:9], v13 offset:57344
    v_cvt_pk_bf16_f32 v181, v182, v183
    v_mfma_f32_16x16x32_bf16 v[208:211], a[24:27], v[108:111], v[208:211]
    ds_read_b64_tr_b16 a[10:11], v13 offset:59392
    v_cvt_pk_bf16_f32 v182, v184, v185
    v_mfma_f32_16x16x32_bf16 v[204:207], a[20:23], v[116:119], v[204:207]
    ds_read_b64_tr_b16 a[12:13], v13 offset:61440
    v_cvt_pk_bf16_f32 v183, v186, v187
    v_mfma_f32_16x16x32_bf16 v[204:207], a[16:19], v[108:111], v[204:207]
    ds_read_b64_tr_b16 a[14:15], v13 offset:63488
    s_waitcnt lgkmcnt(8)
    v_mfma_f32_16x16x32_bf16 v[188:191], a[32:35], v[124:127], v[188:191]
    ds_read_b64_tr_b16 a[16:17], v14 offset:49152
    buffer_store_dwordx4 v[180:183], v2, s[56:59], s86 offen offset:3072 sc1
    v_mfma_f32_16x16x32_bf16 v[188:191], a[36:39], v[132:135], v[188:191]
    ds_read_b64_tr_b16 a[18:19], v14 offset:51200
    s_add_u32 s86, s86, 4096
    v_mfma_f32_16x16x32_bf16 v[188:191], a[40:43], v[140:143], v[188:191]
    ds_read_b64_tr_b16 a[20:21], v14 offset:53248
    v_mfma_f32_16x16x32_bf16 v[188:191], a[44:47], v[148:151], v[188:191]
    ds_read_b64_tr_b16 a[22:23], v14 offset:55296
    v_mfma_f32_16x16x32_bf16 v[196:199], a[44:47], v[152:155], v[196:199]
    ds_read_b64_tr_b16 a[24:25], v14 offset:57344
    v_mfma_f32_16x16x32_bf16 v[196:199], a[40:43], v[144:147], v[196:199]
    ds_read_b64_tr_b16 a[26:27], v14 offset:59392
    v_mfma_f32_16x16x32_bf16 v[196:199], a[36:39], v[136:139], v[196:199]
    ds_read_b64_tr_b16 a[28:29], v14 offset:61440
    v_mfma_f32_16x16x32_bf16 v[196:199], a[32:35], v[128:131], v[196:199]
    ds_read_b64_tr_b16 a[30:31], v14 offset:63488
    s_waitcnt lgkmcnt(8)
    v_mfma_f32_16x16x32_bf16 v[200:203], a[0:3], v[128:131], v[200:203]
    ds_read_b64_tr_b16 a[32:33], v15 offset:49152
    v_mfma_f32_16x16x32_bf16 v[200:203], a[4:7], v[136:139], v[200:203]
    ds_read_b64_tr_b16 a[34:35], v15 offset:51200
    v_mfma_f32_16x16x32_bf16 v[200:203], a[8:11], v[144:147], v[200:203]
    ds_read_b64_tr_b16 a[36:37], v15 offset:53248
    v_mfma_f32_16x16x32_bf16 v[200:203], a[12:15], v[152:155], v[200:203]
    ds_read_b64_tr_b16 a[38:39], v15 offset:55296
    v_mfma_f32_16x16x32_bf16 v[192:195], a[12:15], v[148:151], v[192:195]
    ds_read_b64_tr_b16 a[40:41], v15 offset:57344
    v_mfma_f32_16x16x32_bf16 v[192:195], a[8:11], v[140:143], v[192:195]
    ds_read_b64_tr_b16 a[42:43], v15 offset:59392
    v_mfma_f32_16x16x32_bf16 v[192:195], a[4:7], v[132:135], v[192:195]
    ds_read_b64_tr_b16 a[44:45], v15 offset:61440
    v_mfma_f32_16x16x32_bf16 v[192:195], a[0:3], v[124:127], v[192:195]
    ds_read_b64_tr_b16 a[46:47], v15 offset:63488
    s_waitcnt vmcnt(24) lgkmcnt(8)
    v_mfma_f32_16x16x32_bf16 v[204:207], a[16:19], v[124:127], v[204:207]
    s_barrier
    ds_read_b128 a[0:3], v24 offset:0
    v_mfma_f32_16x16x32_bf16 v[204:207], a[20:23], v[132:135], v[204:207]
    s_add_u32 m0, s67, 81920
    v_mfma_f32_16x16x32_bf16 v[204:207], a[24:27], v[140:143], v[204:207]
    ds_read_b128 a[4:7], v25 offset:0
    v_mfma_f32_16x16x32_bf16 v[204:207], a[28:31], v[148:151], v[204:207]
    v_max_f32 v188, 0, v188
    v_max_f32 v189, 0, v189
    v_max_f32 v190, 0, v190
    v_mfma_f32_16x16x32_bf16 v[212:215], a[28:31], v[152:155], v[212:215]
    ds_read_b128 a[8:11], v24 offset:4096
    v_max_f32 v191, 0, v191
    v_mfma_f32_16x16x32_bf16 v[212:215], a[24:27], v[144:147], v[212:215]
    v_max_f32 v192, 0, v192
    v_max_f32 v193, 0, v193
    v_max_f32 v194, 0, v194
    v_max_f32 v195, 0, v195
    v_mfma_f32_16x16x32_bf16 v[212:215], a[20:23], v[136:139], v[212:215]
    ds_read_b128 a[12:15], v25 offset:4096
    s_mov_b32 s68, 65536
    v_mfma_f32_16x16x32_bf16 v[212:215], a[16:19], v[128:131], v[212:215]
    s_waitcnt lgkmcnt(4)
    v_cvt_pk_bf16_f32 v188, v188, v189
    v_cvt_pk_bf16_f32 v189, v190, v191
    v_mfma_f32_16x16x32_bf16 v[216:219], a[32:35], v[128:131], v[216:219]
    ds_read_b128 a[16:19], v24 offset:8192
    v_cvt_pk_bf16_f32 v190, v192, v193
    v_mfma_f32_16x16x32_bf16 v[216:219], a[36:39], v[136:139], v[216:219]
    v_cvt_pk_bf16_f32 v191, v194, v195
    buffer_store_dwordx4 v[188:191], v2, s[56:59], s86 offen offset:0 sc1
    v_mfma_f32_16x16x32_bf16 v[216:219], a[40:43], v[144:147], v[216:219]
    ds_read_b128 a[20:23], v25 offset:8192
    v_max_f32 v196, 0, v196
    v_mfma_f32_16x16x32_bf16 v[216:219], a[44:47], v[152:155], v[216:219]
    buffer_load_dwordx4 v36, s[40:43], s68 offen offset:0 sc1 lds
    v_max_f32 v197, 0, v197
    v_max_f32 v198, 0, v198
    v_mfma_f32_16x16x32_bf16 v[208:211], a[44:47], v[148:151], v[208:211]
    ds_read_b128 a[24:27], v24 offset:12288
    v_max_f32 v199, 0, v199
    v_mfma_f32_16x16x32_bf16 v[208:211], a[40:43], v[140:143], v[208:211]
    v_max_f32 v200, 0, v200
    v_max_f32 v201, 0, v201
    v_mfma_f32_16x16x32_bf16 v[208:211], a[36:39], v[132:135], v[208:211]
    ds_read_b128 a[28:31], v25 offset:12288
    v_max_f32 v202, 0, v202
    v_max_f32 v203, 0, v203
    v_mfma_f32_16x16x32_bf16 v[208:211], a[32:35], v[124:127], v[208:211]
    s_waitcnt lgkmcnt(4)
    v_cvt_pk_bf16_f32 v196, v196, v197
    v_cvt_pk_bf16_f32 v197, v198, v199
    v_mfma_f32_16x16x32_bf16 v[44:47], a[0:3], a[64:67], 0
    ds_read_b128 a[32:35], v24 offset:2048
    v_cvt_pk_bf16_f32 v198, v200, v201
    v_mfma_f32_16x16x32_bf16 v[44:47], a[4:7], a[72:75], v[44:47]
    buffer_load_dwordx4 v37, s[40:43], s68 offen offset:1024 sc1 lds
    v_cvt_pk_bf16_f32 v199, v202, v203
    v_mfma_f32_16x16x32_bf16 v[44:47], a[8:11], a[80:83], v[44:47]
    ds_read_b128 a[36:39], v25 offset:2048
    buffer_store_dwordx4 v[196:199], v2, s[56:59], s86 offen offset:1024 sc1
    v_mfma_f32_16x16x32_bf16 v[44:47], a[12:15], a[88:91], v[44:47]
    v_max_f32 v204, 0, v204
    v_max_f32 v205, 0, v205
    v_max_f32 v206, 0, v206
    v_mfma_f32_16x16x32_bf16 v[52:55], a[12:15], a[92:95], 0
    ds_read_b128 a[40:43], v24 offset:6144
    v_max_f32 v207, 0, v207
    v_mfma_f32_16x16x32_bf16 v[52:55], a[8:11], a[84:87], v[52:55]
    buffer_load_dwordx4 v38, s[40:43], s68 offen offset:2048 sc1 lds
    v_max_f32 v208, 0, v208
    v_max_f32 v209, 0, v209
    v_mfma_f32_16x16x32_bf16 v[52:55], a[4:7], a[76:79], v[52:55]
    ds_read_b128 a[44:47], v25 offset:6144
    v_max_f32 v210, 0, v210
    v_max_f32 v211, 0, v211
    v_mfma_f32_16x16x32_bf16 v[52:55], a[0:3], a[68:71], v[52:55]
    s_waitcnt lgkmcnt(4)
    v_cvt_pk_bf16_f32 v204, v204, v205
    v_cvt_pk_bf16_f32 v205, v206, v207
    v_mfma_f32_16x16x32_bf16 v[52:55], a[16:19], a[100:103], v[52:55]
    ds_read_b128 a[0:3], v24 offset:10240
    v_cvt_pk_bf16_f32 v206, v208, v209
    v_mfma_f32_16x16x32_bf16 v[52:55], a[20:23], a[108:111], v[52:55]
    v_cvt_pk_bf16_f32 v207, v210, v211
    buffer_store_dwordx4 v[204:207], v2, s[56:59], s86 offen offset:2048 sc1
    v_mfma_f32_16x16x32_bf16 v[52:55], a[24:27], a[116:119], v[52:55]
    ds_read_b128 a[4:7], v25 offset:10240
    v_max_f32 v212, 0, v212
    v_max_f32 v213, 0, v213
    v_max_f32 v214, 0, v214
    v_mfma_f32_16x16x32_bf16 v[52:55], a[28:31], a[124:127], v[52:55]
    buffer_load_dwordx4 v39, s[40:43], s68 offen offset:3072 sc1 lds
    s_add_u32 m0, s67, 98304
    v_mfma_f32_16x16x32_bf16 v[44:47], a[28:31], a[120:123], v[44:47]
    ds_read_b128 a[8:11], v24 offset:14336
    v_max_f32 v215, 0, v215
    v_mfma_f32_16x16x32_bf16 v[44:47], a[24:27], a[112:115], v[44:47]
    v_max_f32 v216, 0, v216
    v_max_f32 v217, 0, v217
    v_max_f32 v218, 0, v218
    v_max_f32 v219, 0, v219
    v_mfma_f32_16x16x32_bf16 v[44:47], a[20:23], a[104:107], v[44:47]
    ds_read_b128 a[12:15], v25 offset:14336
    s_mov_b32 s68, 49152
    v_mfma_f32_16x16x32_bf16 v[44:47], a[16:19], a[96:99], v[44:47]
    s_waitcnt lgkmcnt(4)
    v_cvt_pk_bf16_f32 v212, v212, v213
    v_cvt_pk_bf16_f32 v213, v214, v215
    v_mfma_f32_16x16x32_bf16 v[48:51], a[32:35], a[64:67], 0
    ds_read_b128 a[16:19], v24 offset:16384
    v_cvt_pk_bf16_f32 v214, v216, v217
    v_mfma_f32_16x16x32_bf16 v[48:51], a[36:39], a[72:75], v[48:51]
    buffer_load_dwordx4 v40, s[44:47], s68 offen offset:0 sc1 lds
    v_cvt_pk_bf16_f32 v215, v218, v219
    v_mfma_f32_16x16x32_bf16 v[48:51], a[40:43], a[80:83], v[48:51]
    ds_read_b128 a[20:23], v25 offset:16384
    buffer_store_dwordx4 v[212:215], v2, s[56:59], s86 offen offset:3072 sc1
    v_mfma_f32_16x16x32_bf16 v[48:51], a[44:47], a[88:91], v[48:51]
    v_max3_f32 v106, v44, v45, v46
    v_max3_f32 v108, v52, v53, v54
    v_max_f32 v106, v106, v47
    v_max_f32 v108, v108, v55
    v_mfma_f32_16x16x32_bf16 v[56:59], a[44:47], a[92:95], 0
    ds_read_b128 a[24:27], v24 offset:20480
    v_mov_b32 v107, v106
    v_mov_b32 v109, v108
    v_mfma_f32_16x16x32_bf16 v[56:59], a[40:43], a[84:87], v[56:59]
    buffer_load_dwordx4 v41, s[44:47], s68 offen offset:1024 sc1 lds
    v_permlane32_swap_b32 v106, v107
    v_permlane32_swap_b32 v108, v109
    v_mfma_f32_16x16x32_bf16 v[56:59], a[36:39], a[76:79], v[56:59]
    ds_read_b128 a[28:31], v25 offset:20480
    v_max_f32 v106, v106, v107
    v_max_f32 v108, v108, v109
    v_mfma_f32_16x16x32_bf16 v[56:59], a[32:35], a[68:71], v[56:59]
    s_waitcnt lgkmcnt(4)
    v_mov_b32 v107, v106
    v_mov_b32 v109, v108
    v_mfma_f32_16x16x32_bf16 v[56:59], a[0:3], a[100:103], v[56:59]
    ds_read_b128 a[32:35], v24 offset:24576
    v_permlane16_swap_b32 v106, v107
    v_permlane16_swap_b32 v108, v109
    v_max_f32 v106, v106, v107
    v_mfma_f32_16x16x32_bf16 v[56:59], a[4:7], a[108:111], v[56:59]
    buffer_load_dwordx4 v42, s[44:47], s68 offen offset:2048 sc1 lds
    v_max_f32 v108, v108, v109
    v_sub_f32 v92, 0, v106
    v_mfma_f32_16x16x32_bf16 v[56:59], a[8:11], a[116:119], v[56:59]
    ds_read_b128 a[36:39], v25 offset:24576
    v_sub_f32 v96, 0, v108
    v_sub_f32 v93, 0, v106
    v_mfma_f32_16x16x32_bf16 v[56:59], a[12:15], a[124:127], v[56:59]
    buffer_load_dwordx4 v43, s[44:47], s68 offen offset:3072 sc1 lds
    v_sub_f32 v97, 0, v108
    v_sub_f32 v94, 0, v106
    v_mfma_f32_16x16x32_bf16 v[48:51], a[12:15], a[120:123], v[48:51]
    ds_read_b128 a[40:43], v24 offset:28672
    v_sub_f32 v98, 0, v108
    v_sub_f32 v95, 0, v106
    v_mfma_f32_16x16x32_bf16 v[48:51], a[8:11], a[112:115], v[48:51]
    v_sub_f32 v99, 0, v108
    v_mov_b32 v100, 0
    v_mfma_f32_16x16x32_bf16 v[48:51], a[4:7], a[104:107], v[48:51]
    ds_read_b128 a[44:47], v25 offset:28672
    v_mov_b32 v101, 0
    v_mfma_f32_16x16x32_bf16 v[48:51], a[0:3], a[96:99], v[48:51]
    s_waitcnt lgkmcnt(4)
    v_mfma_f32_16x16x32_bf16 v[60:63], a[16:19], a[64:67], v[92:95]
    ds_read_b128 a[0:3], v24 offset:18432
    v_mfma_f32_16x16x32_bf16 v[60:63], a[20:23], a[72:75], v[60:63]
    v_mfma_f32_16x16x32_bf16 v[60:63], a[24:27], a[80:83], v[60:63]
    ds_read_b128 a[4:7], v25 offset:18432
    v_mfma_f32_16x16x32_bf16 v[60:63], a[28:31], a[88:91], v[60:63]
    v_add_f32 v44, v44, v92
    v_exp_f32 v44, v44
    v_mfma_f32_16x16x32_bf16 v[68:71], a[28:31], a[92:95], v[96:99]
    ds_read_b128 a[8:11], v24 offset:22528
    v_add_f32 v45, v45, v92
    v_exp_f32 v45, v45
    v_mfma_f32_16x16x32_bf16 v[68:71], a[24:27], a[84:87], v[68:71]
    v_add_f32 v46, v46, v92
    v_exp_f32 v46, v46
    v_mfma_f32_16x16x32_bf16 v[68:71], a[20:23], a[76:79], v[68:71]
    ds_read_b128 a[12:15], v25 offset:22528
    v_add_f32 v47, v47, v92
    v_mfma_f32_16x16x32_bf16 v[68:71], a[16:19], a[68:71], v[68:71]
    s_waitcnt lgkmcnt(4)
    v_exp_f32 v47, v47
    v_mfma_f32_16x16x32_bf16 v[68:71], a[32:35], a[100:103], v[68:71]
    ds_read_b128 a[16:19], v24 offset:26624
    v_cvt_pk_bf16_f32 v76, v44, v45
    v_mfma_f32_16x16x32_bf16 v[68:71], a[36:39], a[108:111], v[68:71]
    v_add_f32 v48, v48, v92
    v_exp_f32 v48, v48
    v_mfma_f32_16x16x32_bf16 v[68:71], a[40:43], a[116:119], v[68:71]
    ds_read_b128 a[20:23], v25 offset:26624
    v_add_f32 v49, v49, v92
    v_mfma_f32_16x16x32_bf16 v[68:71], a[44:47], a[124:127], v[68:71]
    v_exp_f32 v49, v49
    v_cvt_pk_bf16_f32 v77, v46, v47
    v_mfma_f32_16x16x32_bf16 v[60:63], a[44:47], a[120:123], v[60:63]
    ds_read_b128 a[24:27], v24 offset:30720
    v_add_f32 v50, v50, v92
    v_mfma_f32_16x16x32_bf16 v[60:63], a[40:43], a[112:115], v[60:63]
    v_exp_f32 v50, v50
    v_add_f32 v51, v51, v92
    v_mfma_f32_16x16x32_bf16 v[60:63], a[36:39], a[104:107], v[60:63]
    ds_read_b128 a[28:31], v25 offset:30720
    v_exp_f32 v51, v51
    v_mfma_f32_16x16x32_bf16 v[60:63], a[32:35], a[96:99], v[60:63]
    s_waitcnt vmcnt(28) lgkmcnt(4)
    v_cvt_pk_bf16_f32 v78, v48, v49
    v_add_f32 v52, v52, v96
    v_exp_f32 v52, v52
    v_add_f32 v53, v53, v96
    v_mfma_f32_16x16x32_bf16 v[64:67], a[0:3], a[64:67], v[92:95]
    s_barrier
    ds_read_b64_tr_b16 a[32:33], v8 offset:0
    v_mfma_f32_16x16x32_bf16 v[64:67], a[4:7], a[72:75], v[64:67]
    ds_read_b64_tr_b16 a[34:35], v8 offset:2048
    s_add_u32 m0, s67, 114688
    v_mfma_f32_16x16x32_bf16 v[64:67], a[8:11], a[80:83], v[64:67]
    ds_read_b64_tr_b16 a[36:37], v9 offset:0
    v_exp_f32 v53, v53
    v_cvt_pk_bf16_f32 v79, v50, v51
    v_mfma_f32_16x16x32_bf16 v[64:67], a[12:15], a[88:91], v[64:67]
    ds_read_b64_tr_b16 a[38:39], v9 offset:2048
    v_add_f32 v54, v54, v96
    v_mfma_f32_16x16x32_bf16 v[72:75], a[12:15], a[92:95], v[96:99]
    ds_read_b64_tr_b16 a[40:41], v10 offset:0
    v_exp_f32 v54, v54
    v_add_f32 v55, v55, v96
    v_mfma_f32_16x16x32_bf16 v[72:75], a[8:11], a[84:87], v[72:75]
    ds_read_b64_tr_b16 a[42:43], v10 offset:2048
    v_exp_f32 v55, v55
    v_cvt_pk_bf16_f32 v80, v52, v53
    v_add_f32 v56, v56, v96
    v_exp_f32 v56, v56
    v_mfma_f32_16x16x32_bf16 v[72:75], a[4:7], a[76:79], v[72:75]
    ds_read_b64_tr_b16 a[44:45], v11 offset:0
    s_mov_b32 s68, 81920
    v_mfma_f32_16x16x32_bf16 v[72:75], a[0:3], a[68:71], v[72:75]
    ds_read_b64_tr_b16 a[46:47], v11 offset:2048
    s_waitcnt lgkmcnt(8)
    v_mfma_f32_16x16x32_bf16 v[72:75], a[16:19], a[100:103], v[72:75]
    ds_read_b64_tr_b16 a[0:1], v8 offset:4096
    v_add_f32 v57, v57, v96
    v_mfma_f32_16x16x32_bf16 v[72:75], a[20:23], a[108:111], v[72:75]
    ds_read_b64_tr_b16 a[2:3], v8 offset:6144
    v_exp_f32 v57, v57
    v_cvt_pk_bf16_f32 v81, v54, v55
    v_mfma_f32_16x16x32_bf16 v[72:75], a[24:27], a[116:119], v[72:75]
    ds_read_b64_tr_b16 a[4:5], v9 offset:4096
    v_add_f32 v58, v58, v96
    v_exp_f32 v58, v58
    v_add_f32 v59, v59, v96
    v_mfma_f32_16x16x32_bf16 v[72:75], a[28:31], a[124:127], v[72:75]
    ds_read_b64_tr_b16 a[6:7], v9 offset:6144
    buffer_load_dwordx4 v36, s[40:43], s68 offen offset:0 sc1 lds
    v_mfma_f32_16x16x32_bf16 v[64:67], a[28:31], a[120:123], v[64:67]
    ds_read_b64_tr_b16 a[8:9], v10 offset:4096
    v_exp_f32 v59, v59
    v_mfma_f32_16x16x32_bf16 v[64:67], a[24:27], a[112:115], v[64:67]
    ds_read_b64_tr_b16 a[10:11], v10 offset:6144
    v_cvt_pk_bf16_f32 v82, v56, v57
    v_mfma_f32_16x16x32_bf16 v[64:67], a[20:23], a[104:107], v[64:67]
    ds_read_b64_tr_b16 a[12:13], v11 offset:4096
    v_cvt_pk_bf16_f32 v83, v58, v59
    v_add_f32 v100, v100, v44
    v_add_f32 v101, v101, v52
    v_add_f32 v100, v100, v45
    v_add_f32 v101, v101, v53
    v_add_f32 v100, v100, v46
    v_mfma_f32_16x16x32_bf16 v[64:67], a[16:19], a[96:99], v[64:67]
    ds_read_b64_tr_b16 a[14:15], v11 offset:6144
    s_waitcnt lgkmcnt(8)
    v_mfma_f32_16x16x32_bf16 v[128:131], a[32:35], v[76:79], 0
    ds_read_b64_tr_b16 a[16:17], v8 offset:8192
    buffer_load_dwordx4 v37, s[40:43], s68 offen offset:1024 sc1 lds
    v_mfma_f32_16x16x32_bf16 v[136:139], a[32:35], v[80:83], 0
    ds_read_b64_tr_b16 a[18:19], v8 offset:10240
    s_mul_i32 s93, s66, 112
    v_mfma_f32_16x16x32_bf16 v[140:143], a[36:39], v[80:83], 0
    ds_read_b64_tr_b16 a[20:21], v9 offset:8192
    v_add_u32 v27, s93, v26
    v_mfma_f32_16x16x32_bf16 v[132:135], a[36:39], v[76:79], 0
    ds_read_b64_tr_b16 a[22:23], v9 offset:10240
    v_mul_u32_u24 v27, 128, v27
    v_mfma_f32_16x16x32_bf16 v[144:147], a[40:43], v[76:79], 0
    ds_read_b64_tr_b16 a[24:25], v10 offset:8192
    s_mov_b32 s93, 0
    v_mfma_f32_16x16x32_bf16 v[152:155], a[40:43], v[80:83], 0
    ds_read_b64_tr_b16 a[26:27], v10 offset:10240
    buffer_load_dwordx4 v38, s[40:43], s68 offen offset:2048 sc1 lds
    v_mfma_f32_16x16x32_bf16 v[156:159], a[44:47], v[80:83], 0
    ds_read_b64_tr_b16 a[28:29], v11 offset:8192
    buffer_load_dword a62, v27, s[48:51], s93 offen
    v_mfma_f32_16x16x32_bf16 v[148:151], a[44:47], v[76:79], 0
    ds_read_b64_tr_b16 a[30:31], v11 offset:10240
    s_waitcnt lgkmcnt(8)
    v_mfma_f32_16x16x32_bf16 v[160:163], a[0:3], v[76:79], 0
    ds_read_b64_tr_b16 a[32:33], v8 offset:12288
    v_add_f32 v101, v101, v54
    v_mfma_f32_16x16x32_bf16 v[168:171], a[0:3], v[80:83], 0
    ds_read_b64_tr_b16 a[34:35], v8 offset:14336
    v_add_f32 v100, v100, v47
    v_mfma_f32_16x16x32_bf16 v[172:175], a[4:7], v[80:83], 0
    ds_read_b64_tr_b16 a[36:37], v9 offset:12288
    buffer_load_dwordx4 v39, s[40:43], s68 offen offset:3072 sc1 lds
    v_mfma_f32_16x16x32_bf16 v[164:167], a[4:7], v[76:79], 0
    ds_read_b64_tr_b16 a[38:39], v9 offset:14336
    s_add_u32 m0, s67, 131072
    v_mfma_f32_16x16x32_bf16 v[176:179], a[8:11], v[76:79], 0
    ds_read_b64_tr_b16 a[40:41], v10 offset:12288
    v_add_f32 v101, v101, v55
    v_mfma_f32_16x16x32_bf16 v[184:187], a[8:11], v[80:83], 0
    ds_read_b64_tr_b16 a[42:43], v10 offset:14336
    s_mov_b32 s68, 65536
    v_mfma_f32_16x16x32_bf16 v[188:191], a[12:15], v[80:83], 0
    ds_read_b64_tr_b16 a[44:45], v11 offset:12288
    v_add_f32 v100, v100, v48
    v_add_f32 v101, v101, v56
    v_mfma_f32_16x16x32_bf16 v[180:183], a[12:15], v[76:79], 0
    ds_read_b64_tr_b16 a[46:47], v11 offset:14336
    s_waitcnt lgkmcnt(8)
    v_mfma_f32_16x16x32_bf16 v[192:195], a[16:19], v[76:79], 0
    ds_read_b128 a[0:3], v20 offset:16384
    buffer_load_dwordx4 v40, s[44:47], s68 offen offset:0 sc1 lds
    v_mfma_f32_16x16x32_bf16 v[200:203], a[16:19], v[80:83], 0
    v_exp_f32 v60, v60
    v_mfma_f32_16x16x32_bf16 v[204:207], a[20:23], v[80:83], 0
    ds_read_b128 a[4:7], v21 offset:16384
    v_add_f32 v100, v100, v49
    v_add_f32 v101, v101, v57
    v_mfma_f32_16x16x32_bf16 v[196:199], a[20:23], v[76:79], 0
    v_exp_f32 v61, v61
    v_mfma_f32_16x16x32_bf16 v[208:211], a[24:27], v[76:79], 0
    ds_read_b128 a[8:11], v20 offset:20480
    buffer_load_dwordx4 v41, s[44:47], s68 offen offset:1024 sc1 lds
    v_mfma_f32_16x16x32_bf16 v[216:219], a[24:27], v[80:83], 0
    v_exp_f32 v62, v62
    v_mfma_f32_16x16x32_bf16 v[220:223], a[28:31], v[80:83], 0
    ds_read_b128 a[12:15], v21 offset:20480
    v_add_f32 v100, v100, v50
    v_add_f32 v101, v101, v58
    v_add_f32 v100, v100, v51
    v_mfma_f32_16x16x32_bf16 v[212:215], a[28:31], v[76:79], 0
    s_waitcnt lgkmcnt(4)
    v_exp_f32 v63, v63
    v_mfma_f32_16x16x32_bf16 v[224:227], a[32:35], v[76:79], 0
    ds_read_b128 a[16:19], v20 offset:24576
    buffer_load_dwordx4 v42, s[44:47], s68 offen offset:2048 sc1 lds
    v_mfma_f32_16x16x32_bf16 v[232:235], a[32:35], v[80:83], 0
    v_exp_f32 v64, v64
    v_mfma_f32_16x16x32_bf16 v[236:239], a[36:39], v[80:83], 0
    ds_read_b128 a[20:23], v21 offset:24576
    buffer_load_dwordx4 v43, s[44:47], s68 offen offset:3072 sc1 lds
    v_mfma_f32_16x16x32_bf16 v[228:231], a[36:39], v[76:79], 0
    v_exp_f32 v65, v65
    v_mfma_f32_16x16x32_bf16 v[240:243], a[40:43], v[76:79], 0
    ds_read_b128 a[24:27], v20 offset:28672
    v_add_f32 v101, v101, v59
    v_mfma_f32_16x16x32_bf16 v[248:251], a[40:43], v[80:83], 0
    v_exp_f32 v66, v66
    v_mfma_f32_16x16x32_bf16 v[252:255], a[44:47], v[80:83], 0
    ds_read_b128 a[28:31], v21 offset:28672
    v_cvt_pk_bf16_f32 v84, v60, v61
    v_mfma_f32_16x16x32_bf16 v[244:247], a[44:47], v[76:79], 0
    s_waitcnt lgkmcnt(4)
    v_exp_f32 v67, v67
    v_mfma_f32_16x16x32_bf16 v[44:47], a[0:3], a[64:67], v[92:95]
    ds_read_b128 a[32:35], v20 offset:18432
    v_cvt_pk_bf16_f32 v85, v62, v63
    v_mfma_f32_16x16x32_bf16 v[44:47], a[4:7], a[72:75], v[44:47]
    v_exp_f32 v68, v68
    v_mfma_f32_16x16x32_bf16 v[44:47], a[8:11], a[80:83], v[44:47]
    ds_read_b128 a[36:39], v21 offset:18432
    v_cvt_pk_bf16_f32 v86, v64, v65
    v_mfma_f32_16x16x32_bf16 v[44:47], a[12:15], a[88:91], v[44:47]
    v_exp_f32 v69, v69
    v_mfma_f32_16x16x32_bf16 v[52:55], a[12:15], a[92:95], v[96:99]
    ds_read_b128 a[40:43], v20 offset:22528
    v_cvt_pk_bf16_f32 v87, v66, v67
    v_mfma_f32_16x16x32_bf16 v[52:55], a[8:11], a[84:87], v[52:55]
    v_exp_f32 v70, v70
    v_mfma_f32_16x16x32_bf16 v[52:55], a[4:7], a[76:79], v[52:55]
    ds_read_b128 a[44:47], v21 offset:22528
    v_cvt_pk_bf16_f32 v88, v68, v69
    v_mfma_f32_16x16x32_bf16 v[52:55], a[0:3], a[68:71], v[52:55]
    s_waitcnt lgkmcnt(4)
    v_exp_f32 v71, v71
    v_mfma_f32_16x16x32_bf16 v[52:55], a[16:19], a[100:103], v[52:55]
    ds_read_b128 a[0:3], v20 offset:26624
    v_cvt_pk_bf16_f32 v89, v70, v71
    v_mfma_f32_16x16x32_bf16 v[52:55], a[20:23], a[108:111], v[52:55]
    v_exp_f32 v72, v72
    v_mfma_f32_16x16x32_bf16 v[52:55], a[24:27], a[116:119], v[52:55]
    ds_read_b128 a[4:7], v21 offset:26624
    v_add_f32 v100, v100, v60
    v_mfma_f32_16x16x32_bf16 v[52:55], a[28:31], a[124:127], v[52:55]
    v_exp_f32 v73, v73
    v_mfma_f32_16x16x32_bf16 v[44:47], a[28:31], a[120:123], v[44:47]
    ds_read_b128 a[8:11], v20 offset:30720
    v_cvt_pk_bf16_f32 v90, v72, v73
L_pg4:
    s_cbranch_execz L_pg8
    v_mfma_f32_16x16x32_bf16 v[44:47], a[24:27], a[112:115], v[44:47]
    v_exp_f32 v74, v74
    v_mfma_f32_16x16x32_bf16 v[44:47], a[20:23], a[104:107], v[44:47]
    ds_read_b128 a[12:15], v21 offset:30720
    v_add_f32 v100, v100, v61
    v_mfma_f32_16x16x32_bf16 v[44:47], a[16:19], a[96:99], v[44:47]
    s_waitcnt vmcnt(26) lgkmcnt(4)
    v_exp_f32 v75, v75
    v_mfma_f32_16x16x32_bf16 v[48:51], a[32:35], a[64:67], v[92:95]
    s_barrier
    ds_read_b64_tr_b16 a[16:17], v8 offset:32768
    v_mfma_f32_16x16x32_bf16 v[48:51], a[36:39], a[72:75], v[48:51]
    ds_read_b64_tr_b16 a[18:19], v8 offset:34816
    s_add_u32 m0, s67, 147456
    v_mfma_f32_16x16x32_bf16 v[48:51], a[40:43], a[80:83], v[48:51]
    ds_read_b64_tr_b16 a[20:21], v9 offset:32768
    v_cvt_pk_bf16_f32 v91, v74, v75
    v_mfma_f32_16x16x32_bf16 v[48:51], a[44:47], a[88:91], v[48:51]
    ds_read_b64_tr_b16 a[22:23], v9 offset:34816
    v_add_f32 v100, v100, v62
    v_mfma_f32_16x16x32_bf16 v[56:59], a[44:47], a[92:95], v[96:99]
    ds_read_b64_tr_b16 a[24:25], v10 offset:32768
    v_add_f32 v100, v100, v63
    v_mfma_f32_16x16x32_bf16 v[56:59], a[40:43], a[84:87], v[56:59]
    ds_read_b64_tr_b16 a[26:27], v10 offset:34816
    v_add_f32 v100, v100, v64
    v_mfma_f32_16x16x32_bf16 v[56:59], a[36:39], a[76:79], v[56:59]
    ds_read_b64_tr_b16 a[28:29], v11 offset:32768
    s_mov_b32 s68, 98304
    v_mfma_f32_16x16x32_bf16 v[56:59], a[32:35], a[68:71], v[56:59]
    ds_read_b64_tr_b16 a[30:31], v11 offset:34816
    s_waitcnt lgkmcnt(8)
    v_mfma_f32_16x16x32_bf16 v[56:59], a[0:3], a[100:103], v[56:59]
    ds_read_b64_tr_b16 a[32:33], v8 offset:36864
    v_add_f32 v100, v100, v65
    v_mfma_f32_16x16x32_bf16 v[56:59], a[4:7], a[108:111], v[56:59]
    ds_read_b64_tr_b16 a[34:35], v8 offset:38912
    v_add_f32 v100, v100, v66
    v_mfma_f32_16x16x32_bf16 v[56:59], a[8:11], a[116:119], v[56:59]
    ds_read_b64_tr_b16 a[36:37], v9 offset:36864
    v_add_f32 v100, v100, v67
    v_mfma_f32_16x16x32_bf16 v[56:59], a[12:15], a[124:127], v[56:59]
    ds_read_b64_tr_b16 a[38:39], v9 offset:38912
    buffer_load_dwordx4 v36, s[40:43], s68 offen offset:0 sc1 lds
    v_mfma_f32_16x16x32_bf16 v[48:51], a[12:15], a[120:123], v[48:51]
    ds_read_b64_tr_b16 a[40:41], v10 offset:36864
    v_add_f32 v101, v101, v68
    v_mfma_f32_16x16x32_bf16 v[48:51], a[8:11], a[112:115], v[48:51]
    ds_read_b64_tr_b16 a[42:43], v10 offset:38912
    v_add_f32 v101, v101, v69
    v_mfma_f32_16x16x32_bf16 v[48:51], a[4:7], a[104:107], v[48:51]
    ds_read_b64_tr_b16 a[44:45], v11 offset:36864
    v_add_f32 v101, v101, v70
    v_mfma_f32_16x16x32_bf16 v[48:51], a[0:3], a[96:99], v[48:51]
    ds_read_b64_tr_b16 a[46:47], v11 offset:38912
    s_waitcnt lgkmcnt(8)
    v_mfma_f32_16x16x32_bf16 v[128:131], a[16:19], v[84:87], v[128:131]
    ds_read_b64_tr_b16 a[0:1], v8 offset:40960
    buffer_load_dwordx4 v37, s[40:43], s68 offen offset:1024 sc1 lds
    v_mfma_f32_16x16x32_bf16 v[136:139], a[16:19], v[88:91], v[136:139]
    ds_read_b64_tr_b16 a[2:3], v8 offset:43008
    v_add_f32 v101, v101, v71
    v_mfma_f32_16x16x32_bf16 v[140:143], a[20:23], v[88:91], v[140:143]
    ds_read_b64_tr_b16 a[4:5], v9 offset:40960
    v_add_f32 v101, v101, v72
    v_mfma_f32_16x16x32_bf16 v[132:135], a[20:23], v[84:87], v[132:135]
    ds_read_b64_tr_b16 a[6:7], v9 offset:43008
    v_add_f32 v101, v101, v73
    v_mfma_f32_16x16x32_bf16 v[144:147], a[24:27], v[84:87], v[144:147]
    ds_read_b64_tr_b16 a[8:9], v10 offset:40960
    v_add_f32 v101, v101, v74
    v_mfma_f32_16x16x32_bf16 v[152:155], a[24:27], v[88:91], v[152:155]
    ds_read_b64_tr_b16 a[10:11], v10 offset:43008
    buffer_load_dwordx4 v38, s[40:43], s68 offen offset:2048 sc1 lds
    v_mfma_f32_16x16x32_bf16 v[156:159], a[28:31], v[88:91], v[156:159]
    ds_read_b64_tr_b16 a[12:13], v11 offset:40960
    v_add_f32 v101, v101, v75
    v_mfma_f32_16x16x32_bf16 v[148:151], a[28:31], v[84:87], v[148:151]
    ds_read_b64_tr_b16 a[14:15], v11 offset:43008
    s_waitcnt lgkmcnt(8)
    v_mfma_f32_16x16x32_bf16 v[160:163], a[32:35], v[84:87], v[160:163]
    ds_read_b64_tr_b16 a[16:17], v8 offset:45056
    v_add_u32 v108, s67, v8
    v_mfma_f32_16x16x32_bf16 v[168:171], a[32:35], v[88:91], v[168:171]
    ds_read_b64_tr_b16 a[18:19], v8 offset:47104
    v_add_u32 v109, s67, v9
    v_mfma_f32_16x16x32_bf16 v[172:175], a[36:39], v[88:91], v[172:175]
    ds_read_b64_tr_b16 a[20:21], v9 offset:45056
    buffer_load_dwordx4 v39, s[40:43], s68 offen offset:3072 sc1 lds
    v_mfma_f32_16x16x32_bf16 v[164:167], a[36:39], v[84:87], v[164:167]
    ds_read_b64_tr_b16 a[22:23], v9 offset:47104
    s_add_u32 m0, s67, 0
    v_mfma_f32_16x16x32_bf16 v[176:179], a[40:43], v[84:87], v[176:179]
    ds_read_b64_tr_b16 a[24:25], v10 offset:45056
    v_add_u32 v110, s67, v10
    v_mfma_f32_16x16x32_bf16 v[184:187], a[40:43], v[88:91], v[184:187]
    ds_read_b64_tr_b16 a[26:27], v10 offset:47104
    s_mov_b32 s68, 81920
    v_mfma_f32_16x16x32_bf16 v[188:191], a[44:47], v[88:91], v[188:191]
    ds_read_b64_tr_b16 a[28:29], v11 offset:45056
    v_add_u32 v111, s67, v11
    v_mfma_f32_16x16x32_bf16 v[180:183], a[44:47], v[84:87], v[180:183]
    ds_read_b64_tr_b16 a[30:31], v11 offset:47104
    s_waitcnt lgkmcnt(8)
    v_mfma_f32_16x16x32_bf16 v[192:195], a[0:3], v[84:87], v[192:195]
    ds_read_b128 a[32:35], v20 offset:49152
    buffer_load_dwordx4 v40, s[44:47], s68 offen offset:0 sc1 lds
    v_mfma_f32_16x16x32_bf16 v[200:203], a[0:3], v[88:91], v[200:203]
    v_exp_f32 v44, v44
    v_mfma_f32_16x16x32_bf16 v[204:207], a[4:7], v[88:91], v[204:207]
    ds_read_b128 a[36:39], v21 offset:49152
    v_add_f32 v100, v100, v44
    v_mfma_f32_16x16x32_bf16 v[196:199], a[4:7], v[84:87], v[196:199]
    v_exp_f32 v45, v45
    v_mfma_f32_16x16x32_bf16 v[208:211], a[8:11], v[84:87], v[208:211]
    ds_read_b128 a[40:43], v20 offset:53248
    buffer_load_dwordx4 v41, s[44:47], s68 offen offset:1024 sc1 lds
    v_mfma_f32_16x16x32_bf16 v[216:219], a[8:11], v[88:91], v[216:219]
    v_exp_f32 v46, v46
    v_mfma_f32_16x16x32_bf16 v[220:223], a[12:15], v[88:91], v[220:223]
    ds_read_b128 a[44:47], v21 offset:53248
    v_cvt_pk_bf16_f32 v76, v44, v45
    v_mfma_f32_16x16x32_bf16 v[212:215], a[12:15], v[84:87], v[212:215]
    s_waitcnt lgkmcnt(4)
    v_exp_f32 v47, v47
    v_mfma_f32_16x16x32_bf16 v[224:227], a[16:19], v[84:87], v[224:227]
    ds_read_b128 a[0:3], v20 offset:57344
    buffer_load_dwordx4 v42, s[44:47], s68 offen offset:2048 sc1 lds
    v_mfma_f32_16x16x32_bf16 v[232:235], a[16:19], v[88:91], v[232:235]
    v_exp_f32 v48, v48
    v_mfma_f32_16x16x32_bf16 v[236:239], a[20:23], v[88:91], v[236:239]
    ds_read_b128 a[4:7], v21 offset:57344
    buffer_load_dwordx4 v43, s[44:47], s68 offen offset:3072 sc1 lds
    v_mfma_f32_16x16x32_bf16 v[228:231], a[20:23], v[84:87], v[228:231]
    v_exp_f32 v49, v49
    v_mfma_f32_16x16x32_bf16 v[240:243], a[24:27], v[84:87], v[240:243]
    ds_read_b128 a[8:11], v20 offset:61440
    v_cvt_pk_bf16_f32 v77, v46, v47
    v_mfma_f32_16x16x32_bf16 v[248:251], a[24:27], v[88:91], v[248:251]
    v_exp_f32 v50, v50
    v_mfma_f32_16x16x32_bf16 v[252:255], a[28:31], v[88:91], v[252:255]
    ds_read_b128 a[12:15], v21 offset:61440
    v_cvt_pk_bf16_f32 v78, v48, v49
    v_mfma_f32_16x16x32_bf16 v[244:247], a[28:31], v[84:87], v[244:247]
    s_waitcnt lgkmcnt(4)
    v_exp_f32 v51, v51
    v_mfma_f32_16x16x32_bf16 v[60:63], a[32:35], a[64:67], v[92:95]
    ds_read_b128 a[16:19], v20 offset:51200
    v_cvt_pk_bf16_f32 v79, v50, v51
    v_mfma_f32_16x16x32_bf16 v[60:63], a[36:39], a[72:75], v[60:63]
    v_exp_f32 v52, v52
    v_mfma_f32_16x16x32_bf16 v[60:63], a[40:43], a[80:83], v[60:63]
    ds_read_b128 a[20:23], v21 offset:51200
    v_add_f32 v100, v100, v45
    v_mfma_f32_16x16x32_bf16 v[60:63], a[44:47], a[88:91], v[60:63]
    s_mov_b32 s93, 8192
    v_exp_f32 v53, v53
    v_mfma_f32_16x16x32_bf16 v[68:71], a[44:47], a[92:95], v[96:99]
    ds_read_b128 a[24:27], v20 offset:55296
    buffer_load_dword a63, v27, s[48:51], s93 offen
    v_mfma_f32_16x16x32_bf16 v[68:71], a[40:43], a[84:87], v[68:71]
    v_exp_f32 v54, v54
    v_mfma_f32_16x16x32_bf16 v[68:71], a[36:39], a[76:79], v[68:71]
    ds_read_b128 a[28:31], v21 offset:55296
    v_cvt_pk_bf16_f32 v80, v52, v53
    v_mfma_f32_16x16x32_bf16 v[68:71], a[32:35], a[68:71], v[68:71]
    s_waitcnt lgkmcnt(4)
    v_exp_f32 v55, v55
    v_mfma_f32_16x16x32_bf16 v[68:71], a[0:3], a[100:103], v[68:71]
    ds_read_b128 a[32:35], v20 offset:59392
    v_cvt_pk_bf16_f32 v81, v54, v55
    v_mfma_f32_16x16x32_bf16 v[68:71], a[4:7], a[108:111], v[68:71]
    v_exp_f32 v56, v56
    v_mfma_f32_16x16x32_bf16 v[68:71], a[8:11], a[116:119], v[68:71]
    ds_read_b128 a[36:39], v21 offset:59392
    v_add_f32 v100, v100, v46
    v_mfma_f32_16x16x32_bf16 v[68:71], a[12:15], a[124:127], v[68:71]
    v_exp_f32 v57, v57
    v_mfma_f32_16x16x32_bf16 v[60:63], a[12:15], a[120:123], v[60:63]
    ds_read_b128 a[40:43], v20 offset:63488
    v_cvt_pk_bf16_f32 v82, v56, v57
    v_mfma_f32_16x16x32_bf16 v[60:63], a[8:11], a[112:115], v[60:63]
    v_exp_f32 v58, v58
    v_mfma_f32_16x16x32_bf16 v[60:63], a[4:7], a[104:107], v[60:63]
    ds_read_b128 a[44:47], v21 offset:63488
    v_add_f32 v100, v100, v47
    v_mfma_f32_16x16x32_bf16 v[60:63], a[0:3], a[96:99], v[60:63]
    s_waitcnt vmcnt(23) lgkmcnt(4)
    v_exp_f32 v59, v59
    s_waitcnt vmcnt(21)
    v_mfma_f32_16x16x32_bf16 v[64:67], a[16:19], a[64:67], v[92:95]
    s_barrier
    ds_read_b64_tr_b16 a[0:1], v12 offset:0
    v_mfma_f32_16x16x32_bf16 v[64:67], a[20:23], a[72:75], v[64:67]
    ds_read_b64_tr_b16 a[2:3], v12 offset:2048
    s_add_u32 m0, s67, 16384
    s_cmp_lg_u32 s64, 0
    s_cbranch_scc1 L_nosig
    s_lshl_b32 s69, s66, 4
    v_mov_b32 v30, s69
    s_mov_b64 exec, 1
    global_atomic_add v30, v29, s[22:23] sc1
    s_mov_b64 exec, -1
L_nosig:
    v_mfma_f32_16x16x32_bf16 v[64:67], a[24:27], a[80:83], v[64:67]
    ds_read_b64_tr_b16 a[4:5], v13 offset:0
    v_cvt_pk_bf16_f32 v83, v58, v59
    v_mfma_f32_16x16x32_bf16 v[64:67], a[28:31], a[88:91], v[64:67]
    ds_read_b64_tr_b16 a[6:7], v13 offset:2048
    v_add_f32 v100, v100, v48
    v_mfma_f32_16x16x32_bf16 v[72:75], a[28:31], a[92:95], v[96:99]
    ds_read_b64_tr_b16 a[8:9], v14 offset:0
    v_add_f32 v100, v100, v49
    v_mfma_f32_16x16x32_bf16 v[72:75], a[24:27], a[84:87], v[72:75]
    ds_read_b64_tr_b16 a[10:11], v14 offset:2048
    v_add_f32 v100, v100, v50
    v_mfma_f32_16x16x32_bf16 v[72:75], a[20:23], a[76:79], v[72:75]
    ds_read_b64_tr_b16 a[12:13], v15 offset:0
    s_mov_b32 s68, 114688
    v_mfma_f32_16x16x32_bf16 v[72:75], a[16:19], a[68:71], v[72:75]
    ds_read_b64_tr_b16 a[14:15], v15 offset:2048
    s_waitcnt lgkmcnt(8)
    v_mfma_f32_16x16x32_bf16 v[72:75], a[32:35], a[100:103], v[72:75]
    ds_read_b64_tr_b16 a[16:17], v12 offset:4096
    v_add_f32 v100, v100, v51
    v_mfma_f32_16x16x32_bf16 v[72:75], a[36:39], a[108:111], v[72:75]
    ds_read_b64_tr_b16 a[18:19], v12 offset:6144
    v_add_f32 v101, v101, v52
    v_mfma_f32_16x16x32_bf16 v[72:75], a[40:43], a[116:119], v[72:75]
    ds_read_b64_tr_b16 a[20:21], v13 offset:4096
    v_add_f32 v101, v101, v53
    v_mfma_f32_16x16x32_bf16 v[72:75], a[44:47], a[124:127], v[72:75]
    ds_read_b64_tr_b16 a[22:23], v13 offset:6144
    buffer_load_dwordx4 v36, s[40:43], s68 offen offset:0 sc1 lds
    v_mfma_f32_16x16x32_bf16 v[64:67], a[44:47], a[120:123], v[64:67]
    ds_read_b64_tr_b16 a[24:25], v14 offset:4096
    v_add_f32 v101, v101, v54
    v_mfma_f32_16x16x32_bf16 v[64:67], a[40:43], a[112:115], v[64:67]
    ds_read_b64_tr_b16 a[26:27], v14 offset:6144
    v_add_f32 v101, v101, v55
    v_mfma_f32_16x16x32_bf16 v[64:67], a[36:39], a[104:107], v[64:67]
    ds_read_b64_tr_b16 a[28:29], v15 offset:4096
    v_add_f32 v101, v101, v56
    v_mfma_f32_16x16x32_bf16 v[64:67], a[32:35], a[96:99], v[64:67]
    ds_read_b64_tr_b16 a[30:31], v15 offset:6144
    s_waitcnt lgkmcnt(8)
    v_mfma_f32_16x16x32_bf16 v[128:131], a[0:3], v[76:79], v[128:131]
    ds_read_b64_tr_b16 a[32:33], v12 offset:8192
    buffer_load_dwordx4 v37, s[40:43], s68 offen offset:1024 sc1 lds
    v_mfma_f32_16x16x32_bf16 v[136:139], a[0:3], v[80:83], v[136:139]
    ds_read_b64_tr_b16 a[34:35], v12 offset:10240
    v_add_f32 v101, v101, v57
    v_mfma_f32_16x16x32_bf16 v[140:143], a[4:7], v[80:83], v[140:143]
    ds_read_b64_tr_b16 a[36:37], v13 offset:8192
    v_add_f32 v101, v101, v58
    v_mfma_f32_16x16x32_bf16 v[132:135], a[4:7], v[76:79], v[132:135]
    ds_read_b64_tr_b16 a[38:39], v13 offset:10240
    v_add_f32 v101, v101, v59
    v_mfma_f32_16x16x32_bf16 v[144:147], a[8:11], v[76:79], v[144:147]
    ds_read_b64_tr_b16 a[40:41], v14 offset:8192
    v_add_u32 v112, s67, v12
    v_mfma_f32_16x16x32_bf16 v[152:155], a[8:11], v[80:83], v[152:155]
    ds_read_b64_tr_b16 a[42:43], v14 offset:10240
    buffer_load_dwordx4 v38, s[40:43], s68 offen offset:2048 sc1 lds
    v_mfma_f32_16x16x32_bf16 v[156:159], a[12:15], v[80:83], v[156:159]
    ds_read_b64_tr_b16 a[44:45], v15 offset:8192
    v_add_u32 v113, s67, v13
    v_mfma_f32_16x16x32_bf16 v[148:151], a[12:15], v[76:79], v[148:151]
    ds_read_b64_tr_b16 a[46:47], v15 offset:10240
    s_waitcnt lgkmcnt(8)
    v_mfma_f32_16x16x32_bf16 v[160:163], a[16:19], v[76:79], v[160:163]
    ds_read_b64_tr_b16 a[0:1], v12 offset:12288
    v_add_u32 v114, s67, v14
    v_mfma_f32_16x16x32_bf16 v[168:171], a[16:19], v[80:83], v[168:171]
    ds_read_b64_tr_b16 a[2:3], v12 offset:14336
    v_add_u32 v115, s67, v15
    v_mfma_f32_16x16x32_bf16 v[172:175], a[20:23], v[80:83], v[172:175]
    ds_read_b64_tr_b16 a[4:5], v13 offset:12288
    buffer_load_dwordx4 v39, s[40:43], s68 offen offset:3072 sc1 lds
    v_mfma_f32_16x16x32_bf16 v[164:167], a[20:23], v[76:79], v[164:167]
    ds_read_b64_tr_b16 a[6:7], v13 offset:14336
    s_add_u32 m0, s67, 32768
    v_mfma_f32_16x16x32_bf16 v[176:179], a[24:27], v[76:79], v[176:179]
    ds_read_b64_tr_b16 a[8:9], v14 offset:12288
    v_add_u32 v116, s67, v16
    v_mfma_f32_16x16x32_bf16 v[184:187], a[24:27], v[80:83], v[184:187]
    ds_read_b64_tr_b16 a[10:11], v14 offset:14336
    s_mov_b32 s68, 98304
    v_mfma_f32_16x16x32_bf16 v[188:191], a[28:31], v[80:83], v[188:191]
    ds_read_b64_tr_b16 a[12:13], v15 offset:12288
    v_add_u32 v117, s67, v17
    v_mfma_f32_16x16x32_bf16 v[180:183], a[28:31], v[76:79], v[180:183]
    ds_read_b64_tr_b16 a[14:15], v15 offset:14336
    s_waitcnt lgkmcnt(8)
    v_mfma_f32_16x16x32_bf16 v[192:195], a[32:35], v[76:79], v[192:195]
    ds_read_b128 a[16:19], v22 offset:16384
    buffer_load_dwordx4 v40, s[44:47], s68 offen offset:0 sc1 lds
    v_mfma_f32_16x16x32_bf16 v[200:203], a[32:35], v[80:83], v[200:203]
    v_exp_f32 v60, v60
    v_mfma_f32_16x16x32_bf16 v[204:207], a[36:39], v[80:83], v[204:207]
    ds_read_b128 a[20:23], v23 offset:16384
    v_add_f32 v100, v100, v60
    v_mfma_f32_16x16x32_bf16 v[196:199], a[36:39], v[76:79], v[196:199]
    v_exp_f32 v61, v61
    v_mfma_f32_16x16x32_bf16 v[208:211], a[40:43], v[76:79], v[208:211]
    ds_read_b128 a[24:27], v22 offset:20480
    buffer_load_dwordx4 v41, s[44:47], s68 offen offset:1024 sc1 lds
    v_mfma_f32_16x16x32_bf16 v[216:219], a[40:43], v[80:83], v[216:219]
    v_exp_f32 v62, v62
    v_mfma_f32_16x16x32_bf16 v[220:223], a[44:47], v[80:83], v[220:223]
    ds_read_b128 a[28:31], v23 offset:20480
    v_cvt_pk_bf16_f32 v84, v60, v61
    v_mfma_f32_16x16x32_bf16 v[212:215], a[44:47], v[76:79], v[212:215]
    s_waitcnt lgkmcnt(4)
    v_exp_f32 v63, v63
    v_mfma_f32_16x16x32_bf16 v[224:227], a[0:3], v[76:79], v[224:227]
    ds_read_b128 a[32:35], v22 offset:24576
    buffer_load_dwordx4 v42, s[44:47], s68 offen offset:2048 sc1 lds
    v_mfma_f32_16x16x32_bf16 v[232:235], a[0:3], v[80:83], v[232:235]
    v_exp_f32 v64, v64
    v_mfma_f32_16x16x32_bf16 v[236:239], a[4:7], v[80:83], v[236:239]
    ds_read_b128 a[36:39], v23 offset:24576
    buffer_load_dwordx4 v43, s[44:47], s68 offen offset:3072 sc1 lds
    v_mfma_f32_16x16x32_bf16 v[228:231], a[4:7], v[76:79], v[228:231]
    v_exp_f32 v65, v65
    v_mfma_f32_16x16x32_bf16 v[240:243], a[8:11], v[76:79], v[240:243]
    ds_read_b128 a[40:43], v22 offset:28672
    v_cvt_pk_bf16_f32 v85, v62, v63
    v_mfma_f32_16x16x32_bf16 v[248:251], a[8:11], v[80:83], v[248:251]
    v_exp_f32 v66, v66
    v_mfma_f32_16x16x32_bf16 v[252:255], a[12:15], v[80:83], v[252:255]
    ds_read_b128 a[44:47], v23 offset:28672
    v_cvt_pk_bf16_f32 v86, v64, v65
    v_mfma_f32_16x16x32_bf16 v[244:247], a[12:15], v[76:79], v[244:247]
    s_waitcnt lgkmcnt(4)
    v_exp_f32 v67, v67
    v_mfma_f32_16x16x32_bf16 v[44:47], a[16:19], a[64:67], v[92:95]
    ds_read_b128 a[0:3], v22 offset:18432
    v_cvt_pk_bf16_f32 v87, v66, v67
    v_mfma_f32_16x16x32_bf16 v[44:47], a[20:23], a[72:75], v[44:47]
    v_exp_f32 v68, v68
    v_mfma_f32_16x16x32_bf16 v[44:47], a[24:27], a[80:83], v[44:47]
    ds_read_b128 a[4:7], v23 offset:18432
    v_add_f32 v100, v100, v61
    v_mfma_f32_16x16x32_bf16 v[44:47], a[28:31], a[88:91], v[44:47]
    v_exp_f32 v69, v69
    v_mfma_f32_16x16x32_bf16 v[52:55], a[28:31], a[92:95], v[96:99]
    ds_read_b128 a[8:11], v22 offset:22528
    v_cvt_pk_bf16_f32 v88, v68, v69
    v_mfma_f32_16x16x32_bf16 v[52:55], a[24:27], a[84:87], v[52:55]
    v_exp_f32 v70, v70
    v_mfma_f32_16x16x32_bf16 v[52:55], a[20:23], a[76:79], v[52:55]
    ds_read_b128 a[12:15], v23 offset:22528
    v_add_f32 v100, v100, v62
    v_mfma_f32_16x16x32_bf16 v[52:55], a[16:19], a[68:71], v[52:55]
    s_waitcnt lgkmcnt(4)
    v_exp_f32 v71, v71
    v_mfma_f32_16x16x32_bf16 v[52:55], a[32:35], a[100:103], v[52:55]
    ds_read_b128 a[16:19], v22 offset:26624
    v_cvt_pk_bf16_f32 v89, v70, v71
    v_mfma_f32_16x16x32_bf16 v[52:55], a[36:39], a[108:111], v[52:55]
    v_exp_f32 v72, v72
    v_mfma_f32_16x16x32_bf16 v[52:55], a[40:43], a[116:119], v[52:55]
    ds_read_b128 a[20:23], v23 offset:26624
    v_add_f32 v100, v100, v63
    v_mfma_f32_16x16x32_bf16 v[52:55], a[44:47], a[124:127], v[52:55]
    v_exp_f32 v73, v73
    v_mfma_f32_16x16x32_bf16 v[44:47], a[44:47], a[120:123], v[44:47]
    ds_read_b128 a[24:27], v22 offset:30720
    v_cvt_pk_bf16_f32 v90, v72, v73
    v_mfma_f32_16x16x32_bf16 v[44:47], a[40:43], a[112:115], v[44:47]
    v_exp_f32 v74, v74
    v_mfma_f32_16x16x32_bf16 v[44:47], a[36:39], a[104:107], v[44:47]
    ds_read_b128 a[28:31], v23 offset:30720
    v_add_f32 v100, v100, v64
    v_mfma_f32_16x16x32_bf16 v[44:47], a[32:35], a[96:99], v[44:47]
    s_waitcnt vmcnt(21) lgkmcnt(4)
    v_exp_f32 v75, v75
    v_mfma_f32_16x16x32_bf16 v[48:51], a[0:3], a[64:67], v[92:95]
    s_barrier
    ds_read_b64_tr_b16 a[32:33], v12 offset:32768
    v_mfma_f32_16x16x32_bf16 v[48:51], a[4:7], a[72:75], v[48:51]
    ds_read_b64_tr_b16 a[34:35], v12 offset:34816
    s_add_u32 m0, s67, 49152
    v_mfma_f32_16x16x32_bf16 v[48:51], a[8:11], a[80:83], v[48:51]
    ds_read_b64_tr_b16 a[36:37], v13 offset:32768
    v_cvt_pk_bf16_f32 v91, v74, v75
    v_mfma_f32_16x16x32_bf16 v[48:51], a[12:15], a[88:91], v[48:51]
    ds_read_b64_tr_b16 a[38:39], v13 offset:34816
    v_add_f32 v100, v100, v65
    v_mfma_f32_16x16x32_bf16 v[56:59], a[12:15], a[92:95], v[96:99]
    ds_read_b64_tr_b16 a[40:41], v14 offset:32768
    v_add_f32 v100, v100, v66
    v_mfma_f32_16x16x32_bf16 v[56:59], a[8:11], a[84:87], v[56:59]
    ds_read_b64_tr_b16 a[42:43], v14 offset:34816
    v_add_f32 v100, v100, v67
    v_mfma_f32_16x16x32_bf16 v[56:59], a[4:7], a[76:79], v[56:59]
    ds_read_b64_tr_b16 a[44:45], v15 offset:32768
    s_mov_b32 s68, 131072
    v_mfma_f32_16x16x32_bf16 v[56:59], a[0:3], a[68:71], v[56:59]
    ds_read_b64_tr_b16 a[46:47], v15 offset:34816
    s_waitcnt lgkmcnt(8)
    v_mfma_f32_16x16x32_bf16 v[56:59], a[16:19], a[100:103], v[56:59]
    ds_read_b64_tr_b16 a[0:1], v12 offset:36864
    v_add_f32 v101, v101, v68
    v_mfma_f32_16x16x32_bf16 v[56:59], a[20:23], a[108:111], v[56:59]
    ds_read_b64_tr_b16 a[2:3], v12 offset:38912
    v_add_f32 v101, v101, v69
    v_mfma_f32_16x16x32_bf16 v[56:59], a[24:27], a[116:119], v[56:59]
    ds_read_b64_tr_b16 a[4:5], v13 offset:36864
    v_add_f32 v101, v101, v70
    v_mfma_f32_16x16x32_bf16 v[56:59], a[28:31], a[124:127], v[56:59]
    ds_read_b64_tr_b16 a[6:7], v13 offset:38912
    buffer_load_dwordx4 v36, s[40:43], s68 offen offset:0 sc1 lds
    v_mfma_f32_16x16x32_bf16 v[48:51], a[28:31], a[120:123], v[48:51]
    ds_read_b64_tr_b16 a[8:9], v14 offset:36864
    v_add_f32 v101, v101, v71
    v_mfma_f32_16x16x32_bf16 v[48:51], a[24:27], a[112:115], v[48:51]
    ds_read_b64_tr_b16 a[10:11], v14 offset:38912
    v_add_f32 v101, v101, v72
    v_mfma_f32_16x16x32_bf16 v[48:51], a[20:23], a[104:107], v[48:51]
    ds_read_b64_tr_b16 a[12:13], v15 offset:36864
    v_add_f32 v101, v101, v73
    v_mfma_f32_16x16x32_bf16 v[48:51], a[16:19], a[96:99], v[48:51]
    ds_read_b64_tr_b16 a[14:15], v15 offset:38912
    s_waitcnt lgkmcnt(8)
    v_mfma_f32_16x16x32_bf16 v[128:131], a[32:35], v[84:87], v[128:131]
    ds_read_b64_tr_b16 a[16:17], v12 offset:40960
    buffer_load_dwordx4 v37, s[40:43], s68 offen offset:1024 sc1 lds
    v_mfma_f32_16x16x32_bf16 v[136:139], a[32:35], v[88:91], v[136:139]
    ds_read_b64_tr_b16 a[18:19], v12 offset:43008
    v_add_f32 v101, v101, v74
    v_mfma_f32_16x16x32_bf16 v[140:143], a[36:39], v[88:91], v[140:143]
    ds_read_b64_tr_b16 a[20:21], v13 offset:40960
    v_add_f32 v101, v101, v75
    v_mfma_f32_16x16x32_bf16 v[132:135], a[36:39], v[84:87], v[132:135]
    ds_read_b64_tr_b16 a[22:23], v13 offset:43008
    v_add_u32 v118, s67, v18
    v_mfma_f32_16x16x32_bf16 v[144:147], a[40:43], v[84:87], v[144:147]
    ds_read_b64_tr_b16 a[24:25], v14 offset:40960
    v_add_u32 v119, s67, v19
    v_mfma_f32_16x16x32_bf16 v[152:155], a[40:43], v[88:91], v[152:155]
    ds_read_b64_tr_b16 a[26:27], v14 offset:43008
    buffer_load_dwordx4 v38, s[40:43], s68 offen offset:2048 sc1 lds
    v_mfma_f32_16x16x32_bf16 v[156:159], a[44:47], v[88:91], v[156:159]
    ds_read_b64_tr_b16 a[28:29], v15 offset:40960
    v_mfma_f32_16x16x32_bf16 v[148:151], a[44:47], v[84:87], v[148:151]
    ds_read_b64_tr_b16 a[30:31], v15 offset:43008
    s_waitcnt lgkmcnt(8)
    v_mfma_f32_16x16x32_bf16 v[160:163], a[0:3], v[84:87], v[160:163]
    ds_read_b64_tr_b16 a[32:33], v12 offset:45056
    s_mul_i32 s93, s24, 448
    v_mfma_f32_16x16x32_bf16 v[168:171], a[0:3], v[88:91], v[168:171]
    ds_read_b64_tr_b16 a[34:35], v12 offset:47104
    v_add_u32 v27, s93, v26
    v_mfma_f32_16x16x32_bf16 v[172:175], a[4:7], v[88:91], v[172:175]
    ds_read_b64_tr_b16 a[36:37], v13 offset:45056
    buffer_load_dwordx4 v39, s[40:43], s68 offen offset:3072 sc1 lds
    v_mfma_f32_16x16x32_bf16 v[164:167], a[4:7], v[84:87], v[164:167]
    ds_read_b64_tr_b16 a[38:39], v13 offset:47104
    s_add_u32 m0, s67, 65536
    v_mfma_f32_16x16x32_bf16 v[176:179], a[8:11], v[84:87], v[176:179]
    ds_read_b64_tr_b16 a[40:41], v14 offset:45056
    v_mul_u32_u24 v27, 896, v27
    v_mfma_f32_16x16x32_bf16 v[184:187], a[8:11], v[88:91], v[184:187]
    ds_read_b64_tr_b16 a[42:43], v14 offset:47104
    s_mov_b32 s68, 114688
    v_mfma_f32_16x16x32_bf16 v[188:191], a[12:15], v[88:91], v[188:191]
    ds_read_b64_tr_b16 a[44:45], v15 offset:45056
    s_lshr_b32 s93, s19, 1
    v_mfma_f32_16x16x32_bf16 v[180:183], a[12:15], v[84:87], v[180:183]
    ds_read_b64_tr_b16 a[46:47], v15 offset:47104
    s_waitcnt lgkmcnt(8)
    v_mfma_f32_16x16x32_bf16 v[192:195], a[16:19], v[84:87], v[192:195]
    ds_read_b128 a[0:3], v22 offset:49152
    buffer_load_dwordx4 v40, s[44:47], s68 offen offset:0 sc1 lds
    v_mfma_f32_16x16x32_bf16 v[200:203], a[16:19], v[88:91], v[200:203]
    s_sub_u32 s92, s93, 7
    v_exp_f32 v44, v44
    v_mfma_f32_16x16x32_bf16 v[204:207], a[20:23], v[88:91], v[204:207]
    ds_read_b128 a[4:7], v23 offset:49152
    s_min_u32 s93, s93, s92
    v_mfma_f32_16x16x32_bf16 v[196:199], a[20:23], v[84:87], v[196:199]
    s_mul_i32 s93, s93, 57344
    v_exp_f32 v45, v45
    v_mfma_f32_16x16x32_bf16 v[208:211], a[24:27], v[84:87], v[208:211]
    ds_read_b128 a[8:11], v22 offset:53248
    buffer_load_dwordx4 v41, s[44:47], s68 offen offset:1024 sc1 lds
    v_mfma_f32_16x16x32_bf16 v[216:219], a[24:27], v[88:91], v[216:219]
    buffer_load_dword a57, v27, s[52:55], s93 offen
    v_exp_f32 v46, v46
    v_mfma_f32_16x16x32_bf16 v[220:223], a[28:31], v[88:91], v[220:223]
    ds_read_b128 a[12:15], v23 offset:53248
    v_cvt_pk_bf16_f32 v76, v44, v45
    v_mfma_f32_16x16x32_bf16 v[212:215], a[28:31], v[84:87], v[212:215]
    s_waitcnt lgkmcnt(4)
    v_exp_f32 v47, v47
    v_mfma_f32_16x16x32_bf16 v[224:227], a[32:35], v[84:87], v[224:227]
    ds_read_b128 a[16:19], v22 offset:57344
    buffer_load_dwordx4 v42, s[44:47], s68 offen offset:2048 sc1 lds
    v_mfma_f32_16x16x32_bf16 v[232:235], a[32:35], v[88:91], v[232:235]
    v_exp_f32 v48, v48
    v_mfma_f32_16x16x32_bf16 v[236:239], a[36:39], v[88:91], v[236:239]
    ds_read_b128 a[20:23], v23 offset:57344
    buffer_load_dwordx4 v43, s[44:47], s68 offen offset:3072 sc1 lds
    v_mfma_f32_16x16x32_bf16 v[228:231], a[36:39], v[84:87], v[228:231]
    v_exp_f32 v49, v49
    v_mfma_f32_16x16x32_bf16 v[240:243], a[40:43], v[84:87], v[240:243]
    ds_read_b128 a[24:27], v22 offset:61440
    v_cvt_pk_bf16_f32 v77, v46, v47
    v_mfma_f32_16x16x32_bf16 v[248:251], a[40:43], v[88:91], v[248:251]
    v_exp_f32 v50, v50
    v_mfma_f32_16x16x32_bf16 v[252:255], a[44:47], v[88:91], v[252:255]
    ds_read_b128 a[28:31], v23 offset:61440
    v_cvt_pk_bf16_f32 v78, v48, v49
    v_mfma_f32_16x16x32_bf16 v[244:247], a[44:47], v[84:87], v[244:247]
    s_waitcnt lgkmcnt(4)
    v_exp_f32 v51, v51
    v_mfma_f32_16x16x32_bf16 v[60:63], a[0:3], a[64:67], v[92:95]
    ds_read_b128 a[32:35], v22 offset:51200
    v_cvt_pk_bf16_f32 v79, v50, v51
    v_mfma_f32_16x16x32_bf16 v[60:63], a[4:7], a[72:75], v[60:63]
    v_exp_f32 v52, v52
    v_mfma_f32_16x16x32_bf16 v[60:63], a[8:11], a[80:83], v[60:63]
    ds_read_b128 a[36:39], v23 offset:51200
    v_add_f32 v100, v100, v44
    v_mfma_f32_16x16x32_bf16 v[60:63], a[12:15], a[88:91], v[60:63]
    v_exp_f32 v53, v53
    v_mfma_f32_16x16x32_bf16 v[68:71], a[12:15], a[92:95], v[96:99]
    ds_read_b128 a[40:43], v22 offset:55296
    v_cvt_pk_bf16_f32 v80, v52, v53
    v_mfma_f32_16x16x32_bf16 v[68:71], a[8:11], a[84:87], v[68:71]
    v_exp_f32 v54, v54
    v_mfma_f32_16x16x32_bf16 v[68:71], a[4:7], a[76:79], v[68:71]
    ds_read_b128 a[44:47], v23 offset:55296
    v_add_f32 v100, v100, v45
    v_mfma_f32_16x16x32_bf16 v[68:71], a[0:3], a[68:71], v[68:71]
    s_waitcnt lgkmcnt(4)
    v_exp_f32 v55, v55
    v_mfma_f32_16x16x32_bf16 v[68:71], a[16:19], a[100:103], v[68:71]
    ds_read_b128 a[0:3], v22 offset:59392
    v_cvt_pk_bf16_f32 v81, v54, v55
    v_mfma_f32_16x16x32_bf16 v[68:71], a[20:23], a[108:111], v[68:71]
    v_exp_f32 v56, v56
    v_mfma_f32_16x16x32_bf16 v[68:71], a[24:27], a[116:119], v[68:71]
    ds_read_b128 a[4:7], v23 offset:59392
    v_add_f32 v100, v100, v46
    v_mfma_f32_16x16x32_bf16 v[68:71], a[28:31], a[124:127], v[68:71]
    v_exp_f32 v57, v57
    v_mfma_f32_16x16x32_bf16 v[60:63], a[28:31], a[120:123], v[60:63]
    ds_read_b128 a[8:11], v22 offset:63488
    v_cvt_pk_bf16_f32 v82, v56, v57
    v_mfma_f32_16x16x32_bf16 v[60:63], a[24:27], a[112:115], v[60:63]
    v_exp_f32 v58, v58
    v_mfma_f32_16x16x32_bf16 v[60:63], a[20:23], a[104:107], v[60:63]
    ds_read_b128 a[12:15], v23 offset:63488
    v_add_f32 v100, v100, v47
    v_mfma_f32_16x16x32_bf16 v[60:63], a[16:19], a[96:99], v[60:63]
    s_waitcnt vmcnt(22) lgkmcnt(4)
    v_exp_f32 v59, v59
    v_mfma_f32_16x16x32_bf16 v[64:67], a[32:35], a[64:67], v[92:95]
    s_barrier
    ds_read_b64_tr_b16 a[16:17], v16 offset:0
    v_mfma_f32_16x16x32_bf16 v[64:67], a[36:39], a[72:75], v[64:67]
    ds_read_b64_tr_b16 a[18:19], v16 offset:2048
    s_add_u32 m0, s67, 81920
    v_mfma_f32_16x16x32_bf16 v[64:67], a[40:43], a[80:83], v[64:67]
    ds_read_b64_tr_b16 a[20:21], v17 offset:0
    v_cvt_pk_bf16_f32 v83, v58, v59
    v_mfma_f32_16x16x32_bf16 v[64:67], a[44:47], a[88:91], v[64:67]
    ds_read_b64_tr_b16 a[22:23], v17 offset:2048
    v_add_f32 v100, v100, v48
    v_mfma_f32_16x16x32_bf16 v[72:75], a[44:47], a[92:95], v[96:99]
    ds_read_b64_tr_b16 a[24:25], v18 offset:0
    v_add_f32 v100, v100, v49
    v_mfma_f32_16x16x32_bf16 v[72:75], a[40:43], a[84:87], v[72:75]
    ds_read_b64_tr_b16 a[26:27], v18 offset:2048
    v_add_f32 v100, v100, v50
    v_mfma_f32_16x16x32_bf16 v[72:75], a[36:39], a[76:79], v[72:75]
    ds_read_b64_tr_b16 a[28:29], v19 offset:0
    s_mov_b32 s68, 147456
    v_mfma_f32_16x16x32_bf16 v[72:75], a[32:35], a[68:71], v[72:75]
    ds_read_b64_tr_b16 a[30:31], v19 offset:2048
    s_waitcnt lgkmcnt(8)
    v_mfma_f32_16x16x32_bf16 v[72:75], a[0:3], a[100:103], v[72:75]
    ds_read_b64_tr_b16 a[32:33], v16 offset:4096
    v_add_f32 v100, v100, v51
    v_mfma_f32_16x16x32_bf16 v[72:75], a[4:7], a[108:111], v[72:75]
    ds_read_b64_tr_b16 a[34:35], v16 offset:6144
    v_add_f32 v101, v101, v52
    v_mfma_f32_16x16x32_bf16 v[72:75], a[8:11], a[116:119], v[72:75]
    ds_read_b64_tr_b16 a[36:37], v17 offset:4096
    v_add_f32 v101, v101, v53
L_pg5:
    s_cbranch_execz L_main
    v_mfma_f32_16x16x32_bf16 v[72:75], a[12:15], a[124:127], v[72:75]
    ds_read_b64_tr_b16 a[38:39], v17 offset:6144
    buffer_load_dwordx4 v36, s[40:43], s68 offen offset:0 sc1 lds
    v_mfma_f32_16x16x32_bf16 v[64:67], a[12:15], a[120:123], v[64:67]
    ds_read_b64_tr_b16 a[40:41], v18 offset:4096
    v_add_f32 v101, v101, v54
    v_mfma_f32_16x16x32_bf16 v[64:67], a[8:11], a[112:115], v[64:67]
    ds_read_b64_tr_b16 a[42:43], v18 offset:6144
    v_add_f32 v101, v101, v55
    v_mfma_f32_16x16x32_bf16 v[64:67], a[4:7], a[104:107], v[64:67]
    ds_read_b64_tr_b16 a[44:45], v19 offset:4096
    v_add_f32 v101, v101, v56
    v_mfma_f32_16x16x32_bf16 v[64:67], a[0:3], a[96:99], v[64:67]
    ds_read_b64_tr_b16 a[46:47], v19 offset:6144
    s_waitcnt lgkmcnt(8)
    v_mfma_f32_16x16x32_bf16 v[128:131], a[16:19], v[76:79], v[128:131]
    ds_read_b64_tr_b16 a[0:1], v16 offset:8192
    buffer_load_dwordx4 v37, s[40:43], s68 offen offset:1024 sc1 lds
    v_mfma_f32_16x16x32_bf16 v[136:139], a[16:19], v[80:83], v[136:139]
    ds_read_b64_tr_b16 a[2:3], v16 offset:10240
    v_add_f32 v101, v101, v57
    v_mfma_f32_16x16x32_bf16 v[140:143], a[20:23], v[80:83], v[140:143]
    ds_read_b64_tr_b16 a[4:5], v17 offset:8192
    v_add_f32 v101, v101, v58
    v_mfma_f32_16x16x32_bf16 v[132:135], a[20:23], v[76:79], v[132:135]
    ds_read_b64_tr_b16 a[6:7], v17 offset:10240
    v_add_f32 v101, v101, v59
    v_mfma_f32_16x16x32_bf16 v[144:147], a[24:27], v[76:79], v[144:147]
    ds_read_b64_tr_b16 a[8:9], v18 offset:8192
    v_mfma_f32_16x16x32_bf16 v[152:155], a[24:27], v[80:83], v[152:155]
    ds_read_b64_tr_b16 a[10:11], v18 offset:10240
    buffer_load_dwordx4 v38, s[40:43], s68 offen offset:2048 sc1 lds
    v_mfma_f32_16x16x32_bf16 v[156:159], a[28:31], v[80:83], v[156:159]
    ds_read_b64_tr_b16 a[12:13], v19 offset:8192
    v_mfma_f32_16x16x32_bf16 v[148:151], a[28:31], v[76:79], v[148:151]
    ds_read_b64_tr_b16 a[14:15], v19 offset:10240
    s_waitcnt lgkmcnt(8)
    v_mfma_f32_16x16x32_bf16 v[160:163], a[32:35], v[76:79], v[160:163]
    ds_read_b64_tr_b16 a[16:17], v16 offset:12288
    v_mfma_f32_16x16x32_bf16 v[168:171], a[32:35], v[80:83], v[168:171]
    ds_read_b64_tr_b16 a[18:19], v16 offset:14336
    v_mfma_f32_16x16x32_bf16 v[172:175], a[36:39], v[80:83], v[172:175]
    ds_read_b64_tr_b16 a[20:21], v17 offset:12288
    buffer_load_dwordx4 v39, s[40:43], s68 offen offset:3072 sc1 lds
    v_mfma_f32_16x16x32_bf16 v[164:167], a[36:39], v[76:79], v[164:167]
    ds_read_b64_tr_b16 a[22:23], v17 offset:14336
    s_add_u32 m0, s67, 98304
    v_mfma_f32_16x16x32_bf16 v[176:179], a[40:43], v[76:79], v[176:179]
    ds_read_b64_tr_b16 a[24:25], v18 offset:12288
    v_mfma_f32_16x16x32_bf16 v[184:187], a[40:43], v[80:83], v[184:187]
    ds_read_b64_tr_b16 a[26:27], v18 offset:14336
    s_mov_b32 s68, 131072
    v_mfma_f32_16x16x32_bf16 v[188:191], a[44:47], v[80:83], v[188:191]
    ds_read_b64_tr_b16 a[28:29], v19 offset:12288
    v_mfma_f32_16x16x32_bf16 v[180:183], a[44:47], v[76:79], v[180:183]
    ds_read_b64_tr_b16 a[30:31], v19 offset:14336
    s_waitcnt lgkmcnt(8)
    v_mfma_f32_16x16x32_bf16 v[192:195], a[0:3], v[76:79], v[192:195]
    ds_read_b128 a[32:35], v24 offset:16384
    buffer_load_dwordx4 v40, s[44:47], s68 offen offset:0 sc1 lds
    v_mfma_f32_16x16x32_bf16 v[200:203], a[0:3], v[80:83], v[200:203]
    v_exp_f32 v60, v60
    v_mfma_f32_16x16x32_bf16 v[204:207], a[4:7], v[80:83], v[204:207]
    ds_read_b128 a[36:39], v25 offset:16384
    v_add_f32 v100, v100, v60
    v_mfma_f32_16x16x32_bf16 v[196:199], a[4:7], v[76:79], v[196:199]
    v_exp_f32 v61, v61
    v_mfma_f32_16x16x32_bf16 v[208:211], a[8:11], v[76:79], v[208:211]
    ds_read_b128 a[40:43], v24 offset:20480
    buffer_load_dwordx4 v41, s[44:47], s68 offen offset:1024 sc1 lds
    v_mfma_f32_16x16x32_bf16 v[216:219], a[8:11], v[80:83], v[216:219]
    v_exp_f32 v62, v62
    v_mfma_f32_16x16x32_bf16 v[220:223], a[12:15], v[80:83], v[220:223]
    ds_read_b128 a[44:47], v25 offset:20480
    v_cvt_pk_bf16_f32 v84, v60, v61
    v_mfma_f32_16x16x32_bf16 v[212:215], a[12:15], v[76:79], v[212:215]
    s_waitcnt lgkmcnt(4)
    v_exp_f32 v63, v63
    v_mfma_f32_16x16x32_bf16 v[224:227], a[16:19], v[76:79], v[224:227]
    ds_read_b128 a[0:3], v24 offset:24576
    buffer_load_dwordx4 v42, s[44:47], s68 offen offset:2048 sc1 lds
    v_mfma_f32_16x16x32_bf16 v[232:235], a[16:19], v[80:83], v[232:235]
    v_exp_f32 v64, v64
    v_mfma_f32_16x16x32_bf16 v[236:239], a[20:23], v[80:83], v[236:239]
    ds_read_b128 a[4:7], v25 offset:24576
    buffer_load_dwordx4 v43, s[44:47], s68 offen offset:3072 sc1 lds
    v_mfma_f32_16x16x32_bf16 v[228:231], a[20:23], v[76:79], v[228:231]
    v_exp_f32 v65, v65
    v_mfma_f32_16x16x32_bf16 v[240:243], a[24:27], v[76:79], v[240:243]
    ds_read_b128 a[8:11], v24 offset:28672
    v_cvt_pk_bf16_f32 v85, v62, v63
    v_mfma_f32_16x16x32_bf16 v[248:251], a[24:27], v[80:83], v[248:251]
    v_exp_f32 v66, v66
    v_mfma_f32_16x16x32_bf16 v[252:255], a[28:31], v[80:83], v[252:255]
    ds_read_b128 a[12:15], v25 offset:28672
    v_cvt_pk_bf16_f32 v86, v64, v65
    v_mfma_f32_16x16x32_bf16 v[244:247], a[28:31], v[76:79], v[244:247]
    s_waitcnt lgkmcnt(4)
    v_exp_f32 v67, v67
    v_mfma_f32_16x16x32_bf16 v[44:47], a[32:35], a[64:67], v[92:95]
    ds_read_b128 a[16:19], v24 offset:18432
    v_cvt_pk_bf16_f32 v87, v66, v67
    v_mfma_f32_16x16x32_bf16 v[44:47], a[36:39], a[72:75], v[44:47]
    v_exp_f32 v68, v68
    v_mfma_f32_16x16x32_bf16 v[44:47], a[40:43], a[80:83], v[44:47]
    ds_read_b128 a[20:23], v25 offset:18432
    v_add_f32 v100, v100, v61
    v_mfma_f32_16x16x32_bf16 v[44:47], a[44:47], a[88:91], v[44:47]
    v_exp_f32 v69, v69
    v_mfma_f32_16x16x32_bf16 v[52:55], a[44:47], a[92:95], v[96:99]
    ds_read_b128 a[24:27], v24 offset:22528
    v_cvt_pk_bf16_f32 v88, v68, v69
    v_mfma_f32_16x16x32_bf16 v[52:55], a[40:43], a[84:87], v[52:55]
    v_exp_f32 v70, v70
    v_mfma_f32_16x16x32_bf16 v[52:55], a[36:39], a[76:79], v[52:55]
    ds_read_b128 a[28:31], v25 offset:22528
    v_add_f32 v100, v100, v62
    v_mfma_f32_16x16x32_bf16 v[52:55], a[32:35], a[68:71], v[52:55]
    s_waitcnt lgkmcnt(4)
    v_exp_f32 v71, v71
    v_mfma_f32_16x16x32_bf16 v[52:55], a[0:3], a[100:103], v[52:55]
    ds_read_b128 a[32:35], v24 offset:26624
    v_cvt_pk_bf16_f32 v89, v70, v71
    v_mfma_f32_16x16x32_bf16 v[52:55], a[4:7], a[108:111], v[52:55]
    v_exp_f32 v72, v72
    v_mfma_f32_16x16x32_bf16 v[52:55], a[8:11], a[116:119], v[52:55]
    ds_read_b128 a[36:39], v25 offset:26624
    s_add_u32 s93, s93, 57344
    v_mfma_f32_16x16x32_bf16 v[52:55], a[12:15], a[124:127], v[52:55]
    s_sub_u32 s92, s93, 401408
    v_exp_f32 v73, v73
    v_mfma_f32_16x16x32_bf16 v[44:47], a[12:15], a[120:123], v[44:47]
    ds_read_b128 a[40:43], v24 offset:30720
    s_min_u32 s93, s93, s92
    v_mfma_f32_16x16x32_bf16 v[44:47], a[8:11], a[112:115], v[44:47]
    buffer_load_dword a58, v27, s[52:55], s93 offen
    v_exp_f32 v74, v74
    v_mfma_f32_16x16x32_bf16 v[44:47], a[4:7], a[104:107], v[44:47]
    ds_read_b128 a[44:47], v25 offset:30720
    v_cvt_pk_bf16_f32 v90, v72, v73
    v_mfma_f32_16x16x32_bf16 v[44:47], a[0:3], a[96:99], v[44:47]
    s_waitcnt vmcnt(22) lgkmcnt(4)
    v_exp_f32 v75, v75
    v_mfma_f32_16x16x32_bf16 v[48:51], a[16:19], a[64:67], v[92:95]
    s_barrier
    ds_read_b64_tr_b16 a[0:1], v8 offset:0
    v_mfma_f32_16x16x32_bf16 v[48:51], a[20:23], a[72:75], v[48:51]
    ds_read_b64_tr_b16 a[2:3], v8 offset:2048
    s_add_u32 m0, s67, 114688
    v_mfma_f32_16x16x32_bf16 v[48:51], a[24:27], a[80:83], v[48:51]
    ds_read_b64_tr_b16 a[4:5], v9 offset:0
    v_cvt_pk_bf16_f32 v91, v74, v75
    v_mfma_f32_16x16x32_bf16 v[48:51], a[28:31], a[88:91], v[48:51]
    ds_read_b64_tr_b16 a[6:7], v9 offset:2048
    v_add_f32 v100, v100, v63
    v_mfma_f32_16x16x32_bf16 v[56:59], a[28:31], a[92:95], v[96:99]
    ds_read_b64_tr_b16 a[8:9], v10 offset:0
    v_add_f32 v100, v100, v64
    v_mfma_f32_16x16x32_bf16 v[56:59], a[24:27], a[84:87], v[56:59]
    ds_read_b64_tr_b16 a[10:11], v10 offset:2048
    v_add_f32 v100, v100, v65
    v_mfma_f32_16x16x32_bf16 v[56:59], a[20:23], a[76:79], v[56:59]
    ds_read_b64_tr_b16 a[12:13], v11 offset:0
    s_mov_b32 s68, 163840
    v_mfma_f32_16x16x32_bf16 v[56:59], a[16:19], a[68:71], v[56:59]
    ds_read_b64_tr_b16 a[14:15], v11 offset:2048
    s_waitcnt lgkmcnt(8)
    v_mfma_f32_16x16x32_bf16 v[56:59], a[32:35], a[100:103], v[56:59]
    ds_read_b64_tr_b16 a[16:17], v8 offset:4096
    v_add_f32 v100, v100, v66
    v_mfma_f32_16x16x32_bf16 v[56:59], a[36:39], a[108:111], v[56:59]
    ds_read_b64_tr_b16 a[18:19], v8 offset:6144
    v_add_f32 v100, v100, v67
    v_mfma_f32_16x16x32_bf16 v[56:59], a[40:43], a[116:119], v[56:59]
    ds_read_b64_tr_b16 a[20:21], v9 offset:4096
    v_add_f32 v101, v101, v68
    v_mfma_f32_16x16x32_bf16 v[56:59], a[44:47], a[124:127], v[56:59]
    ds_read_b64_tr_b16 a[22:23], v9 offset:6144
    buffer_load_dwordx4 v36, s[40:43], s68 offen offset:0 sc1 lds
    v_mfma_f32_16x16x32_bf16 v[48:51], a[44:47], a[120:123], v[48:51]
    ds_read_b64_tr_b16 a[24:25], v10 offset:4096
    v_add_f32 v101, v101, v69
    v_mfma_f32_16x16x32_bf16 v[48:51], a[40:43], a[112:115], v[48:51]
    ds_read_b64_tr_b16 a[26:27], v10 offset:6144
    v_add_f32 v101, v101, v70
    v_mfma_f32_16x16x32_bf16 v[48:51], a[36:39], a[104:107], v[48:51]
    ds_read_b64_tr_b16 a[28:29], v11 offset:4096
    v_add_f32 v101, v101, v71
    v_mfma_f32_16x16x32_bf16 v[48:51], a[32:35], a[96:99], v[48:51]
    ds_read_b64_tr_b16 a[30:31], v11 offset:6144
    s_waitcnt lgkmcnt(8)
    v_mfma_f32_16x16x32_bf16 v[128:131], a[0:3], v[84:87], v[128:131]
    ds_read_b64_tr_b16 a[32:33], v8 offset:8192
    buffer_load_dwordx4 v37, s[40:43], s68 offen offset:1024 sc1 lds
    v_mfma_f32_16x16x32_bf16 v[136:139], a[0:3], v[88:91], v[136:139]
    ds_read_b64_tr_b16 a[34:35], v8 offset:10240
    v_add_f32 v101, v101, v72
    v_mfma_f32_16x16x32_bf16 v[140:143], a[4:7], v[88:91], v[140:143]
    ds_read_b64_tr_b16 a[36:37], v9 offset:8192
    v_add_f32 v101, v101, v73
    v_mfma_f32_16x16x32_bf16 v[132:135], a[4:7], v[84:87], v[132:135]
    ds_read_b64_tr_b16 a[38:39], v9 offset:10240
    v_add_f32 v101, v101, v74
    v_mfma_f32_16x16x32_bf16 v[144:147], a[8:11], v[84:87], v[144:147]
    ds_read_b64_tr_b16 a[40:41], v10 offset:8192
    v_add_f32 v101, v101, v75
    v_mfma_f32_16x16x32_bf16 v[152:155], a[8:11], v[88:91], v[152:155]
    ds_read_b64_tr_b16 a[42:43], v10 offset:10240
    buffer_load_dwordx4 v38, s[40:43], s68 offen offset:2048 sc1 lds
    v_mfma_f32_16x16x32_bf16 v[156:159], a[12:15], v[88:91], v[156:159]
    ds_read_b64_tr_b16 a[44:45], v11 offset:8192
    v_mfma_f32_16x16x32_bf16 v[148:151], a[12:15], v[84:87], v[148:151]
    ds_read_b64_tr_b16 a[46:47], v11 offset:10240
    s_waitcnt lgkmcnt(8)
    v_mfma_f32_16x16x32_bf16 v[160:163], a[16:19], v[84:87], v[160:163]
    ds_read_b64_tr_b16 a[0:1], v8 offset:12288
    v_mfma_f32_16x16x32_bf16 v[168:171], a[16:19], v[88:91], v[168:171]
    ds_read_b64_tr_b16 a[2:3], v8 offset:14336
    v_mfma_f32_16x16x32_bf16 v[172:175], a[20:23], v[88:91], v[172:175]
    ds_read_b64_tr_b16 a[4:5], v9 offset:12288
    buffer_load_dwordx4 v39, s[40:43], s68 offen offset:3072 sc1 lds
    v_mfma_f32_16x16x32_bf16 v[164:167], a[20:23], v[84:87], v[164:167]
    ds_read_b64_tr_b16 a[6:7], v9 offset:14336
    s_add_u32 m0, s67, 131072
    v_mfma_f32_16x16x32_bf16 v[176:179], a[24:27], v[84:87], v[176:179]
    ds_read_b64_tr_b16 a[8:9], v10 offset:12288
    v_mfma_f32_16x16x32_bf16 v[184:187], a[24:27], v[88:91], v[184:187]
    ds_read_b64_tr_b16 a[10:11], v10 offset:14336
    s_mov_b32 s68, 147456
    v_mfma_f32_16x16x32_bf16 v[188:191], a[28:31], v[88:91], v[188:191]
    ds_read_b64_tr_b16 a[12:13], v11 offset:12288
    v_mfma_f32_16x16x32_bf16 v[180:183], a[28:31], v[84:87], v[180:183]
    ds_read_b64_tr_b16 a[14:15], v11 offset:14336
    s_waitcnt lgkmcnt(8)
    v_mfma_f32_16x16x32_bf16 v[192:195], a[32:35], v[84:87], v[192:195]
    ds_read_b128 a[16:19], v20 offset:16384
    buffer_load_dwordx4 v40, s[44:47], s68 offen offset:0 sc1 lds
    v_mfma_f32_16x16x32_bf16 v[200:203], a[32:35], v[88:91], v[200:203]
    v_exp_f32 v44, v44
    v_mfma_f32_16x16x32_bf16 v[204:207], a[36:39], v[88:91], v[204:207]
    ds_read_b128 a[20:23], v21 offset:16384
    v_add_f32 v100, v100, v44
    v_mfma_f32_16x16x32_bf16 v[196:199], a[36:39], v[84:87], v[196:199]
    v_exp_f32 v45, v45
    v_mfma_f32_16x16x32_bf16 v[208:211], a[40:43], v[84:87], v[208:211]
    ds_read_b128 a[24:27], v20 offset:20480
    buffer_load_dwordx4 v41, s[44:47], s68 offen offset:1024 sc1 lds
    v_mfma_f32_16x16x32_bf16 v[216:219], a[40:43], v[88:91], v[216:219]
    v_exp_f32 v46, v46
    v_mfma_f32_16x16x32_bf16 v[220:223], a[44:47], v[88:91], v[220:223]
    ds_read_b128 a[28:31], v21 offset:20480
    v_cvt_pk_bf16_f32 v76, v44, v45
    v_mfma_f32_16x16x32_bf16 v[212:215], a[44:47], v[84:87], v[212:215]
    s_waitcnt lgkmcnt(4)
    v_exp_f32 v47, v47
    v_mfma_f32_16x16x32_bf16 v[224:227], a[0:3], v[84:87], v[224:227]
    ds_read_b128 a[32:35], v20 offset:24576
    buffer_load_dwordx4 v42, s[44:47], s68 offen offset:2048 sc1 lds
    v_mfma_f32_16x16x32_bf16 v[232:235], a[0:3], v[88:91], v[232:235]
    v_exp_f32 v48, v48
    v_mfma_f32_16x16x32_bf16 v[236:239], a[4:7], v[88:91], v[236:239]
    ds_read_b128 a[36:39], v21 offset:24576
    buffer_load_dwordx4 v43, s[44:47], s68 offen offset:3072 sc1 lds
    v_mfma_f32_16x16x32_bf16 v[228:231], a[4:7], v[84:87], v[228:231]
    v_exp_f32 v49, v49
    v_mfma_f32_16x16x32_bf16 v[240:243], a[8:11], v[84:87], v[240:243]
    ds_read_b128 a[40:43], v20 offset:28672
    v_cvt_pk_bf16_f32 v77, v46, v47
    v_mfma_f32_16x16x32_bf16 v[248:251], a[8:11], v[88:91], v[248:251]
    v_exp_f32 v50, v50
    v_mfma_f32_16x16x32_bf16 v[252:255], a[12:15], v[88:91], v[252:255]
    ds_read_b128 a[44:47], v21 offset:28672
    v_cvt_pk_bf16_f32 v78, v48, v49
    v_mfma_f32_16x16x32_bf16 v[244:247], a[12:15], v[84:87], v[244:247]
    s_waitcnt lgkmcnt(4)
    v_exp_f32 v51, v51
    v_mfma_f32_16x16x32_bf16 v[60:63], a[16:19], a[64:67], v[92:95]
    ds_read_b128 a[0:3], v20 offset:18432
    v_cvt_pk_bf16_f32 v79, v50, v51
    v_mfma_f32_16x16x32_bf16 v[60:63], a[20:23], a[72:75], v[60:63]
    v_exp_f32 v52, v52
    v_mfma_f32_16x16x32_bf16 v[60:63], a[24:27], a[80:83], v[60:63]
    ds_read_b128 a[4:7], v21 offset:18432
    s_lshl_b32 s69, s19, 4
    v_mfma_f32_16x16x32_bf16 v[60:63], a[28:31], a[88:91], v[60:63]
    v_exp_f32 v53, v53
    v_mfma_f32_16x16x32_bf16 v[68:71], a[28:31], a[92:95], v[96:99]
    ds_read_b128 a[8:11], v20 offset:22528
    v_mov_b32 v30, s69
    v_mfma_f32_16x16x32_bf16 v[68:71], a[24:27], a[84:87], v[68:71]
    global_load_dword v30, v30, s[22:23] sc1
    v_exp_f32 v54, v54
    v_mfma_f32_16x16x32_bf16 v[68:71], a[20:23], a[76:79], v[68:71]
    ds_read_b128 a[12:15], v21 offset:22528
    v_add_u32 v2, s20, v1
    v_mfma_f32_16x16x32_bf16 v[68:71], a[16:19], a[68:71], v[68:71]
    s_waitcnt lgkmcnt(4)
    v_exp_f32 v55, v55
    v_mfma_f32_16x16x32_bf16 v[68:71], a[32:35], a[100:103], v[68:71]
    ds_read_b128 a[16:19], v20 offset:26624
    v_cvt_pk_bf16_f32 v80, v52, v53
    v_mfma_f32_16x16x32_bf16 v[68:71], a[36:39], a[108:111], v[68:71]
    v_exp_f32 v56, v56
    v_mfma_f32_16x16x32_bf16 v[68:71], a[40:43], a[116:119], v[68:71]
    ds_read_b128 a[20:23], v21 offset:26624
    v_cvt_pk_bf16_f32 v81, v54, v55
    v_mfma_f32_16x16x32_bf16 v[68:71], a[44:47], a[124:127], v[68:71]
    v_exp_f32 v57, v57
    v_mfma_f32_16x16x32_bf16 v[60:63], a[44:47], a[120:123], v[60:63]
    ds_read_b128 a[24:27], v20 offset:30720
    v_cvt_pk_bf16_f32 v82, v56, v57
    v_mfma_f32_16x16x32_bf16 v[60:63], a[40:43], a[112:115], v[60:63]
    v_exp_f32 v58, v58
    v_mfma_f32_16x16x32_bf16 v[60:63], a[36:39], a[104:107], v[60:63]
    ds_read_b128 a[28:31], v21 offset:30720
    v_add_f32 v100, v100, v45
    v_mfma_f32_16x16x32_bf16 v[60:63], a[32:35], a[96:99], v[60:63]
    s_waitcnt vmcnt(23) lgkmcnt(4)
    v_exp_f32 v59, v59
    v_mfma_f32_16x16x32_bf16 v[64:67], a[0:3], a[64:67], v[92:95]
    s_barrier
    ds_read_b64_tr_b16 a[32:33], v8 offset:32768
    v_mfma_f32_16x16x32_bf16 v[64:67], a[4:7], a[72:75], v[64:67]
    ds_read_b64_tr_b16 a[34:35], v8 offset:34816
    s_add_u32 m0, s67, 147456
    v_mfma_f32_16x16x32_bf16 v[64:67], a[8:11], a[80:83], v[64:67]
    ds_read_b64_tr_b16 a[36:37], v9 offset:32768
    v_cvt_pk_bf16_f32 v83, v58, v59
    v_mfma_f32_16x16x32_bf16 v[64:67], a[12:15], a[88:91], v[64:67]
    ds_read_b64_tr_b16 a[38:39], v9 offset:34816
    v_add_f32 v100, v100, v46
    v_mfma_f32_16x16x32_bf16 v[72:75], a[12:15], a[92:95], v[96:99]
    ds_read_b64_tr_b16 a[40:41], v10 offset:32768
    v_add_f32 v100, v100, v47
    v_mfma_f32_16x16x32_bf16 v[72:75], a[8:11], a[84:87], v[72:75]
    ds_read_b64_tr_b16 a[42:43], v10 offset:34816
    v_add_f32 v100, v100, v48
    v_mfma_f32_16x16x32_bf16 v[72:75], a[4:7], a[76:79], v[72:75]
    ds_read_b64_tr_b16 a[44:45], v11 offset:32768
    s_mov_b32 s68, 180224
    v_mfma_f32_16x16x32_bf16 v[72:75], a[0:3], a[68:71], v[72:75]
    ds_read_b64_tr_b16 a[46:47], v11 offset:34816
    s_waitcnt lgkmcnt(8)
    v_mfma_f32_16x16x32_bf16 v[72:75], a[16:19], a[100:103], v[72:75]
    ds_read_b64_tr_b16 a[0:1], v8 offset:36864
    v_add_f32 v100, v100, v49
    v_mfma_f32_16x16x32_bf16 v[72:75], a[20:23], a[108:111], v[72:75]
    ds_read_b64_tr_b16 a[2:3], v8 offset:38912
    v_add_f32 v100, v100, v50
    v_mfma_f32_16x16x32_bf16 v[72:75], a[24:27], a[116:119], v[72:75]
    ds_read_b64_tr_b16 a[4:5], v9 offset:36864
    v_add_f32 v100, v100, v51
    v_mfma_f32_16x16x32_bf16 v[72:75], a[28:31], a[124:127], v[72:75]
    ds_read_b64_tr_b16 a[6:7], v9 offset:38912
    buffer_load_dwordx4 v36, s[40:43], s68 offen offset:0 sc1 lds
    v_mfma_f32_16x16x32_bf16 v[64:67], a[28:31], a[120:123], v[64:67]
    ds_read_b64_tr_b16 a[8:9], v10 offset:36864
    v_add_f32 v101, v101, v52
    v_mfma_f32_16x16x32_bf16 v[64:67], a[24:27], a[112:115], v[64:67]
    ds_read_b64_tr_b16 a[10:11], v10 offset:38912
    v_add_f32 v101, v101, v53
    v_mfma_f32_16x16x32_bf16 v[64:67], a[20:23], a[104:107], v[64:67]
    ds_read_b64_tr_b16 a[12:13], v11 offset:36864
    v_add_f32 v101, v101, v54
    v_mfma_f32_16x16x32_bf16 v[64:67], a[16:19], a[96:99], v[64:67]
    ds_read_b64_tr_b16 a[14:15], v11 offset:38912
    s_waitcnt lgkmcnt(8)
    v_mfma_f32_16x16x32_bf16 v[128:131], a[32:35], v[76:79], v[128:131]
    ds_read_b64_tr_b16 a[16:17], v8 offset:40960
    buffer_load_dwordx4 v37, s[40:43], s68 offen offset:1024 sc1 lds
    v_mfma_f32_16x16x32_bf16 v[136:139], a[32:35], v[80:83], v[136:139]
    ds_read_b64_tr_b16 a[18:19], v8 offset:43008
    v_add_f32 v101, v101, v55
    v_mfma_f32_16x16x32_bf16 v[140:143], a[36:39], v[80:83], v[140:143]
    ds_read_b64_tr_b16 a[20:21], v9 offset:40960
    v_add_f32 v101, v101, v56
    v_mfma_f32_16x16x32_bf16 v[132:135], a[36:39], v[76:79], v[132:135]
    ds_read_b64_tr_b16 a[22:23], v9 offset:43008
    v_add_f32 v101, v101, v57
    v_mfma_f32_16x16x32_bf16 v[144:147], a[40:43], v[76:79], v[144:147]
    ds_read_b64_tr_b16 a[24:25], v10 offset:40960
    v_add_f32 v101, v101, v58
    v_mfma_f32_16x16x32_bf16 v[152:155], a[40:43], v[80:83], v[152:155]
    ds_read_b64_tr_b16 a[26:27], v10 offset:43008
    buffer_load_dwordx4 v38, s[40:43], s68 offen offset:2048 sc1 lds
    v_mfma_f32_16x16x32_bf16 v[156:159], a[44:47], v[80:83], v[156:159]
    ds_read_b64_tr_b16 a[28:29], v11 offset:40960
    v_add_f32 v101, v101, v59
    v_mfma_f32_16x16x32_bf16 v[148:151], a[44:47], v[76:79], v[148:151]
    ds_read_b64_tr_b16 a[30:31], v11 offset:43008
    s_waitcnt lgkmcnt(8)
    v_mfma_f32_16x16x32_bf16 v[160:163], a[0:3], v[76:79], v[160:163]
    ds_read_b64_tr_b16 a[32:33], v8 offset:45056
    v_mfma_f32_16x16x32_bf16 v[168:171], a[0:3], v[80:83], v[168:171]
    ds_read_b64_tr_b16 a[34:35], v8 offset:47104
    v_mfma_f32_16x16x32_bf16 v[172:175], a[4:7], v[80:83], v[172:175]
    ds_read_b64_tr_b16 a[36:37], v9 offset:45056
    buffer_load_dwordx4 v39, s[40:43], s68 offen offset:3072 sc1 lds
    v_mfma_f32_16x16x32_bf16 v[164:167], a[4:7], v[76:79], v[164:167]
    ds_read_b64_tr_b16 a[38:39], v9 offset:47104
    s_add_u32 m0, s67, 0
    v_mfma_f32_16x16x32_bf16 v[176:179], a[8:11], v[76:79], v[176:179]
    ds_read_b64_tr_b16 a[40:41], v10 offset:45056
    v_mfma_f32_16x16x32_bf16 v[184:187], a[8:11], v[80:83], v[184:187]
    ds_read_b64_tr_b16 a[42:43], v10 offset:47104
    s_mov_b32 s68, 163840
    v_mfma_f32_16x16x32_bf16 v[188:191], a[12:15], v[80:83], v[188:191]
    ds_read_b64_tr_b16 a[44:45], v11 offset:45056
    s_add_u32 s93, s93, 57344
    v_mfma_f32_16x16x32_bf16 v[180:183], a[12:15], v[76:79], v[180:183]
    ds_read_b64_tr_b16 a[46:47], v11 offset:47104
    s_waitcnt lgkmcnt(8)
    v_mfma_f32_16x16x32_bf16 v[192:195], a[16:19], v[76:79], v[192:195]
    ds_read_b128 a[0:3], v20 offset:49152
    buffer_load_dwordx4 v40, s[44:47], s68 offen offset:0 sc1 lds
    v_mfma_f32_16x16x32_bf16 v[200:203], a[16:19], v[80:83], v[200:203]
    s_sub_u32 s92, s93, 401408
    v_exp_f32 v60, v60
    v_mfma_f32_16x16x32_bf16 v[204:207], a[20:23], v[80:83], v[204:207]
    ds_read_b128 a[4:7], v21 offset:49152
    s_min_u32 s93, s93, s92
    v_mfma_f32_16x16x32_bf16 v[196:199], a[20:23], v[76:79], v[196:199]
    buffer_load_dword a59, v27, s[52:55], s93 offen
    v_exp_f32 v61, v61
    v_mfma_f32_16x16x32_bf16 v[208:211], a[24:27], v[76:79], v[208:211]
    ds_read_b128 a[8:11], v20 offset:53248
    buffer_load_dwordx4 v41, s[44:47], s68 offen offset:1024 sc1 lds
    v_mfma_f32_16x16x32_bf16 v[216:219], a[24:27], v[80:83], v[216:219]
    v_exp_f32 v62, v62
    v_mfma_f32_16x16x32_bf16 v[220:223], a[28:31], v[80:83], v[220:223]
    ds_read_b128 a[12:15], v21 offset:53248
    v_cvt_pk_bf16_f32 v84, v60, v61
    v_mfma_f32_16x16x32_bf16 v[212:215], a[28:31], v[76:79], v[212:215]
    s_waitcnt lgkmcnt(4)
    v_exp_f32 v63, v63
    v_mfma_f32_16x16x32_bf16 v[224:227], a[32:35], v[76:79], v[224:227]
    ds_read_b128 a[16:19], v20 offset:57344
    buffer_load_dwordx4 v42, s[44:47], s68 offen offset:2048 sc1 lds
    v_mfma_f32_16x16x32_bf16 v[232:235], a[32:35], v[80:83], v[232:235]
    v_exp_f32 v64, v64
    v_mfma_f32_16x16x32_bf16 v[236:239], a[36:39], v[80:83], v[236:239]
    ds_read_b128 a[20:23], v21 offset:57344
    buffer_load_dwordx4 v43, s[44:47], s68 offen offset:3072 sc1 lds
    v_mfma_f32_16x16x32_bf16 v[228:231], a[36:39], v[76:79], v[228:231]
    v_exp_f32 v65, v65
    v_mfma_f32_16x16x32_bf16 v[240:243], a[40:43], v[76:79], v[240:243]
    ds_read_b128 a[24:27], v20 offset:61440
    v_cvt_pk_bf16_f32 v85, v62, v63
    v_mfma_f32_16x16x32_bf16 v[248:251], a[40:43], v[80:83], v[248:251]
    v_exp_f32 v66, v66
    v_mfma_f32_16x16x32_bf16 v[252:255], a[44:47], v[80:83], v[252:255]
    ds_read_b128 a[28:31], v21 offset:61440
    v_cvt_pk_bf16_f32 v86, v64, v65
    v_mfma_f32_16x16x32_bf16 v[244:247], a[44:47], v[76:79], v[244:247]
    s_waitcnt lgkmcnt(4)
    v_exp_f32 v67, v67
    v_mfma_f32_16x16x32_bf16 v[44:47], a[0:3], a[64:67], v[92:95]
    ds_read_b128 a[32:35], v20 offset:51200
    v_cvt_pk_bf16_f32 v87, v66, v67
    v_mfma_f32_16x16x32_bf16 v[44:47], a[4:7], a[72:75], v[44:47]
    v_exp_f32 v68, v68
    v_mfma_f32_16x16x32_bf16 v[44:47], a[8:11], a[80:83], v[44:47]
    ds_read_b128 a[36:39], v21 offset:51200
    v_add_f32 v100, v100, v60
    v_mfma_f32_16x16x32_bf16 v[44:47], a[12:15], a[88:91], v[44:47]
    v_exp_f32 v69, v69
    v_mfma_f32_16x16x32_bf16 v[52:55], a[12:15], a[92:95], v[96:99]
    ds_read_b128 a[40:43], v20 offset:55296
    v_cvt_pk_bf16_f32 v88, v68, v69
    v_mfma_f32_16x16x32_bf16 v[52:55], a[8:11], a[84:87], v[52:55]
    v_exp_f32 v70, v70
    v_mfma_f32_16x16x32_bf16 v[52:55], a[4:7], a[76:79], v[52:55]
    ds_read_b128 a[44:47], v21 offset:55296
    v_add_f32 v100, v100, v61
    v_mfma_f32_16x16x32_bf16 v[52:55], a[0:3], a[68:71], v[52:55]
    s_waitcnt lgkmcnt(4)
    v_exp_f32 v71, v71
    v_mfma_f32_16x16x32_bf16 v[52:55], a[16:19], a[100:103], v[52:55]
    ds_read_b128 a[0:3], v20 offset:59392
    v_cvt_pk_bf16_f32 v89, v70, v71
    v_mfma_f32_16x16x32_bf16 v[52:55], a[20:23], a[108:111], v[52:55]
    v_exp_f32 v72, v72
    v_mfma_f32_16x16x32_bf16 v[52:55], a[24:27], a[116:119], v[52:55]
    ds_read_b128 a[4:7], v21 offset:59392
    v_add_f32 v100, v100, v62
    v_mfma_f32_16x16x32_bf16 v[52:55], a[28:31], a[124:127], v[52:55]
    v_exp_f32 v73, v73
    v_mfma_f32_16x16x32_bf16 v[44:47], a[28:31], a[120:123], v[44:47]
    ds_read_b128 a[8:11], v20 offset:63488
    v_cvt_pk_bf16_f32 v90, v72, v73
    v_mfma_f32_16x16x32_bf16 v[44:47], a[24:27], a[112:115], v[44:47]
    v_exp_f32 v74, v74
    v_mfma_f32_16x16x32_bf16 v[44:47], a[20:23], a[104:107], v[44:47]
    ds_read_b128 a[12:15], v21 offset:63488
    v_add_f32 v100, v100, v63
    v_mfma_f32_16x16x32_bf16 v[44:47], a[16:19], a[96:99], v[44:47]
    s_waitcnt vmcnt(23) lgkmcnt(4)
    v_exp_f32 v75, v75
    v_mfma_f32_16x16x32_bf16 v[48:51], a[32:35], a[64:67], v[92:95]
    s_barrier
    ds_read_b64_tr_b16 a[16:17], v12 offset:0
    v_mfma_f32_16x16x32_bf16 v[48:51], a[36:39], a[72:75], v[48:51]
    ds_read_b64_tr_b16 a[18:19], v12 offset:2048
    s_add_u32 m0, s67, 16384
    v_mfma_f32_16x16x32_bf16 v[48:51], a[40:43], a[80:83], v[48:51]
    ds_read_b64_tr_b16 a[20:21], v13 offset:0
    v_cvt_pk_bf16_f32 v91, v74, v75
    v_mfma_f32_16x16x32_bf16 v[48:51], a[44:47], a[88:91], v[48:51]
    ds_read_b64_tr_b16 a[22:23], v13 offset:2048
    v_add_f32 v100, v100, v64
    v_mfma_f32_16x16x32_bf16 v[56:59], a[44:47], a[92:95], v[96:99]
    ds_read_b64_tr_b16 a[24:25], v14 offset:0
    v_add_f32 v100, v100, v65
    v_mfma_f32_16x16x32_bf16 v[56:59], a[40:43], a[84:87], v[56:59]
    ds_read_b64_tr_b16 a[26:27], v14 offset:2048
    v_add_f32 v100, v100, v66
    v_mfma_f32_16x16x32_bf16 v[56:59], a[36:39], a[76:79], v[56:59]
    ds_read_b64_tr_b16 a[28:29], v15 offset:0
    s_mov_b32 s68, 196608
    v_mfma_f32_16x16x32_bf16 v[56:59], a[32:35], a[68:71], v[56:59]
    ds_read_b64_tr_b16 a[30:31], v15 offset:2048
    s_waitcnt lgkmcnt(8)
    v_mfma_f32_16x16x32_bf16 v[56:59], a[0:3], a[100:103], v[56:59]
    ds_read_b64_tr_b16 a[32:33], v12 offset:4096
    v_add_f32 v100, v100, v67
    v_mfma_f32_16x16x32_bf16 v[56:59], a[4:7], a[108:111], v[56:59]
    ds_read_b64_tr_b16 a[34:35], v12 offset:6144
    v_add_f32 v101, v101, v68
    v_mfma_f32_16x16x32_bf16 v[56:59], a[8:11], a[116:119], v[56:59]
    ds_read_b64_tr_b16 a[36:37], v13 offset:4096
    v_add_f32 v101, v101, v69
    v_mfma_f32_16x16x32_bf16 v[56:59], a[12:15], a[124:127], v[56:59]
    ds_read_b64_tr_b16 a[38:39], v13 offset:6144
    buffer_load_dwordx4 v36, s[40:43], s68 offen offset:0 sc1 lds
    v_mfma_f32_16x16x32_bf16 v[48:51], a[12:15], a[120:123], v[48:51]
    ds_read_b64_tr_b16 a[40:41], v14 offset:4096
    v_add_f32 v101, v101, v70
    v_mfma_f32_16x16x32_bf16 v[48:51], a[8:11], a[112:115], v[48:51]
    ds_read_b64_tr_b16 a[42:43], v14 offset:6144
    v_add_f32 v101, v101, v71
    v_mfma_f32_16x16x32_bf16 v[48:51], a[4:7], a[104:107], v[48:51]
    ds_read_b64_tr_b16 a[44:45], v15 offset:4096
    v_add_f32 v101, v101, v72
    v_mfma_f32_16x16x32_bf16 v[48:51], a[0:3], a[96:99], v[48:51]
    ds_read_b64_tr_b16 a[46:47], v15 offset:6144
    s_waitcnt lgkmcnt(8)
    v_mfma_f32_16x16x32_bf16 v[128:131], a[16:19], v[84:87], v[128:131]
    ds_read_b64_tr_b16 a[0:1], v12 offset:8192
    buffer_load_dwordx4 v37, s[40:43], s68 offen offset:1024 sc1 lds
    s_waitcnt vmcnt(11)
    v_cmp_gt_u32 vcc, 16, v30
    s_nop 0
    s_cbranch_vccnz L_spinh
L_spinh_ret:
    v_mfma_f32_16x16x32_bf16 v[136:139], a[16:19], v[88:91], v[136:139]
    ds_read_b64_tr_b16 a[2:3], v12 offset:10240
    v_add_f32 v101, v101, v73
    v_mfma_f32_16x16x32_bf16 v[140:143], a[20:23], v[88:91], v[140:143]
    ds_read_b64_tr_b16 a[4:5], v13 offset:8192
    s_add_u32 s69, s98, 0
    v_mfma_f32_16x16x32_bf16 v[132:135], a[20:23], v[84:87], v[132:135]
    ds_read_b64_tr_b16 a[6:7], v13 offset:10240
    v_add_f32 v101, v101, v74
    v_mfma_f32_16x16x32_bf16 v[144:147], a[24:27], v[84:87], v[144:147]
    ds_read_b64_tr_b16 a[8:9], v14 offset:8192
    v_add_f32 v101, v101, v75
    v_mfma_f32_16x16x32_bf16 v[152:155], a[24:27], v[88:91], v[152:155]
    ds_read_b64_tr_b16 a[10:11], v14 offset:10240
    buffer_load_dwordx4 v38, s[40:43], s68 offen offset:2048 sc1 lds
    v_mfma_f32_16x16x32_bf16 v[156:159], a[28:31], v[88:91], v[156:159]
    ds_read_b64_tr_b16 a[12:13], v15 offset:8192
    v_mfma_f32_16x16x32_bf16 v[148:151], a[28:31], v[84:87], v[148:151]
    ds_read_b64_tr_b16 a[14:15], v15 offset:10240
    s_waitcnt lgkmcnt(8)
    v_mfma_f32_16x16x32_bf16 v[160:163], a[32:35], v[84:87], v[160:163]
    ds_read_b64_tr_b16 a[16:17], v12 offset:12288
    v_mfma_f32_16x16x32_bf16 v[168:171], a[32:35], v[88:91], v[168:171]
    ds_read_b64_tr_b16 a[18:19], v12 offset:14336
    v_mfma_f32_16x16x32_bf16 v[172:175], a[36:39], v[88:91], v[172:175]
    ds_read_b64_tr_b16 a[20:21], v13 offset:12288
    buffer_load_dwordx4 v39, s[40:43], s68 offen offset:3072 sc1 lds
    v_mfma_f32_16x16x32_bf16 v[164:167], a[36:39], v[84:87], v[164:167]
    ds_read_b64_tr_b16 a[22:23], v13 offset:14336
    s_add_u32 m0, s67, 32768
L_pg6:
    s_cbranch_execz L_main
    v_mfma_f32_16x16x32_bf16 v[176:179], a[40:43], v[84:87], v[176:179]
    ds_read_b64_tr_b16 a[24:25], v14 offset:12288
    buffer_load_dwordx4 a[128:131], v2, s[56:59], s69 offen offset:0 sc1
    v_mfma_f32_16x16x32_bf16 v[184:187], a[40:43], v[88:91], v[184:187]
    ds_read_b64_tr_b16 a[26:27], v14 offset:14336
    s_mov_b32 s68, 180224
    v_mfma_f32_16x16x32_bf16 v[188:191], a[44:47], v[88:91], v[188:191]
    ds_read_b64_tr_b16 a[28:29], v15 offset:12288
    v_mfma_f32_16x16x32_bf16 v[180:183], a[44:47], v[84:87], v[180:183]
    ds_read_b64_tr_b16 a[30:31], v15 offset:14336
    s_waitcnt lgkmcnt(8)
    v_mfma_f32_16x16x32_bf16 v[192:195], a[0:3], v[84:87], v[192:195]
    ds_read_b128 a[32:35], v22 offset:16384
    buffer_load_dwordx4 v40, s[44:47], s68 offen offset:0 sc1 lds
    v_mfma_f32_16x16x32_bf16 v[200:203], a[0:3], v[88:91], v[200:203]
    v_exp_f32 v44, v44
    v_mfma_f32_16x16x32_bf16 v[204:207], a[4:7], v[88:91], v[204:207]
    ds_read_b128 a[36:39], v23 offset:16384
    v_add_f32 v100, v100, v44
    v_mfma_f32_16x16x32_bf16 v[196:199], a[4:7], v[84:87], v[196:199]
    v_exp_f32 v45, v45
    v_mfma_f32_16x16x32_bf16 v[208:211], a[8:11], v[84:87], v[208:211]
    ds_read_b128 a[40:43], v22 offset:20480
    buffer_load_dwordx4 v41, s[44:47], s68 offen offset:1024 sc1 lds
    v_mfma_f32_16x16x32_bf16 v[216:219], a[8:11], v[88:91], v[216:219]
    buffer_load_dwordx4 a[144:147], v2, s[56:59], s69 offen offset:2048 sc1
    v_exp_f32 v46, v46
    v_mfma_f32_16x16x32_bf16 v[220:223], a[12:15], v[88:91], v[220:223]
    ds_read_b128 a[44:47], v23 offset:20480
    v_cvt_pk_bf16_f32 v76, v44, v45
    v_mfma_f32_16x16x32_bf16 v[212:215], a[12:15], v[84:87], v[212:215]
    s_waitcnt lgkmcnt(4)
    v_exp_f32 v47, v47
    v_mfma_f32_16x16x32_bf16 v[224:227], a[16:19], v[84:87], v[224:227]
    ds_read_b128 a[0:3], v22 offset:24576
    buffer_load_dwordx4 v42, s[44:47], s68 offen offset:2048 sc1 lds
    v_mfma_f32_16x16x32_bf16 v[232:235], a[16:19], v[88:91], v[232:235]
    v_exp_f32 v48, v48
    v_mfma_f32_16x16x32_bf16 v[236:239], a[20:23], v[88:91], v[236:239]
    ds_read_b128 a[4:7], v23 offset:24576
    buffer_load_dwordx4 v43, s[44:47], s68 offen offset:3072 sc1 lds
    v_mfma_f32_16x16x32_bf16 v[228:231], a[20:23], v[84:87], v[228:231]
    v_exp_f32 v49, v49
    v_mfma_f32_16x16x32_bf16 v[240:243], a[24:27], v[84:87], v[240:243]
    ds_read_b128 a[8:11], v22 offset:28672
    v_cvt_pk_bf16_f32 v77, v46, v47
    v_mfma_f32_16x16x32_bf16 v[248:251], a[24:27], v[88:91], v[248:251]
    s_add_u32 s69, s99, 0
    v_exp_f32 v50, v50
    v_mfma_f32_16x16x32_bf16 v[252:255], a[28:31], v[88:91], v[252:255]
    ds_read_b128 a[12:15], v23 offset:28672
    v_cvt_pk_bf16_f32 v78, v48, v49
    v_mfma_f32_16x16x32_bf16 v[244:247], a[28:31], v[84:87], v[244:247]
    s_waitcnt lgkmcnt(4)
    v_exp_f32 v51, v51
    v_mfma_f32_16x16x32_bf16 v[60:63], a[32:35], a[64:67], v[92:95]
    ds_read_b128 a[16:19], v22 offset:18432
    v_cvt_pk_bf16_f32 v79, v50, v51
    v_mfma_f32_16x16x32_bf16 v[60:63], a[36:39], a[72:75], v[60:63]
    v_exp_f32 v52, v52
    v_mfma_f32_16x16x32_bf16 v[60:63], a[40:43], a[80:83], v[60:63]
    ds_read_b128 a[20:23], v23 offset:18432
    v_add_f32 v100, v100, v45
    v_mfma_f32_16x16x32_bf16 v[60:63], a[44:47], a[88:91], v[60:63]
    v_exp_f32 v53, v53
    v_mfma_f32_16x16x32_bf16 v[68:71], a[44:47], a[92:95], v[96:99]
    ds_read_b128 a[24:27], v22 offset:22528
    v_cvt_pk_bf16_f32 v80, v52, v53
    v_mfma_f32_16x16x32_bf16 v[68:71], a[40:43], a[84:87], v[68:71]
    v_exp_f32 v54, v54
    v_mfma_f32_16x16x32_bf16 v[68:71], a[36:39], a[76:79], v[68:71]
    ds_read_b128 a[28:31], v23 offset:22528
    buffer_load_dwordx4 a[132:135], v2, s[56:59], s69 offen offset:0 sc1
    v_mfma_f32_16x16x32_bf16 v[68:71], a[32:35], a[68:71], v[68:71]
    s_waitcnt lgkmcnt(4)
    v_exp_f32 v55, v55
    v_mfma_f32_16x16x32_bf16 v[68:71], a[0:3], a[100:103], v[68:71]
    ds_read_b128 a[32:35], v22 offset:26624
    v_cvt_pk_bf16_f32 v81, v54, v55
    v_mfma_f32_16x16x32_bf16 v[68:71], a[4:7], a[108:111], v[68:71]
    v_exp_f32 v56, v56
    v_mfma_f32_16x16x32_bf16 v[68:71], a[8:11], a[116:119], v[68:71]
    ds_read_b128 a[36:39], v23 offset:26624
    v_add_f32 v100, v100, v46
    v_mfma_f32_16x16x32_bf16 v[68:71], a[12:15], a[124:127], v[68:71]
    v_exp_f32 v57, v57
    v_mfma_f32_16x16x32_bf16 v[60:63], a[12:15], a[120:123], v[60:63]
    ds_read_b128 a[40:43], v22 offset:30720
    v_cvt_pk_bf16_f32 v82, v56, v57
    v_mfma_f32_16x16x32_bf16 v[60:63], a[8:11], a[112:115], v[60:63]
    v_exp_f32 v58, v58
    v_mfma_f32_16x16x32_bf16 v[60:63], a[4:7], a[104:107], v[60:63]
    ds_read_b128 a[44:47], v23 offset:30720
    v_add_f32 v100, v100, v47
    v_mfma_f32_16x16x32_bf16 v[60:63], a[0:3], a[96:99], v[60:63]
    s_waitcnt lgkmcnt(4)
    v_exp_f32 v59, v59
    v_mfma_f32_16x16x32_bf16 v[64:67], a[16:19], a[64:67], v[92:95]
    s_barrier
    ds_read_b64_tr_b16 a[0:1], v12 offset:32768
    v_mfma_f32_16x16x32_bf16 v[64:67], a[20:23], a[72:75], v[64:67]
    ds_read_b64_tr_b16 a[2:3], v12 offset:34816
    s_add_u32 m0, s67, 49152
    v_mfma_f32_16x16x32_bf16 v[64:67], a[24:27], a[80:83], v[64:67]
    ds_read_b64_tr_b16 a[4:5], v13 offset:32768
    buffer_load_dwordx4 a[148:151], v2, s[56:59], s69 offen offset:2048 sc1
    v_mfma_f32_16x16x32_bf16 v[64:67], a[28:31], a[88:91], v[64:67]
    ds_read_b64_tr_b16 a[6:7], v13 offset:34816
    s_add_u32 s93, s93, 57344
    v_mfma_f32_16x16x32_bf16 v[72:75], a[28:31], a[92:95], v[96:99]
    ds_read_b64_tr_b16 a[8:9], v14 offset:32768
    s_sub_u32 s92, s93, 401408
    v_mfma_f32_16x16x32_bf16 v[72:75], a[24:27], a[84:87], v[72:75]
    ds_read_b64_tr_b16 a[10:11], v14 offset:34816
    s_min_u32 s93, s93, s92
    v_mfma_f32_16x16x32_bf16 v[72:75], a[20:23], a[76:79], v[72:75]
    ds_read_b64_tr_b16 a[12:13], v15 offset:32768
    s_mov_b32 s68, 212992
    v_mfma_f32_16x16x32_bf16 v[72:75], a[16:19], a[68:71], v[72:75]
    ds_read_b64_tr_b16 a[14:15], v15 offset:34816
    s_waitcnt lgkmcnt(8)
    v_mfma_f32_16x16x32_bf16 v[72:75], a[32:35], a[100:103], v[72:75]
    ds_read_b64_tr_b16 a[16:17], v12 offset:36864
    s_add_u32 s69, s100, 0
    v_mfma_f32_16x16x32_bf16 v[72:75], a[36:39], a[108:111], v[72:75]
    ds_read_b64_tr_b16 a[18:19], v12 offset:38912
    buffer_load_dword a60, v27, s[52:55], s93 offen
    v_mfma_f32_16x16x32_bf16 v[72:75], a[40:43], a[116:119], v[72:75]
    ds_read_b64_tr_b16 a[20:21], v13 offset:36864
    v_cvt_pk_bf16_f32 v83, v58, v59
    v_mfma_f32_16x16x32_bf16 v[72:75], a[44:47], a[124:127], v[72:75]
    ds_read_b64_tr_b16 a[22:23], v13 offset:38912
    buffer_load_dwordx4 v36, s[40:43], s68 offen offset:0 sc1 lds
    v_mfma_f32_16x16x32_bf16 v[64:67], a[44:47], a[120:123], v[64:67]
    ds_read_b64_tr_b16 a[24:25], v14 offset:36864
    v_add_f32 v100, v100, v48
    v_mfma_f32_16x16x32_bf16 v[64:67], a[40:43], a[112:115], v[64:67]
    ds_read_b64_tr_b16 a[26:27], v14 offset:38912
    v_add_f32 v100, v100, v49
    v_mfma_f32_16x16x32_bf16 v[64:67], a[36:39], a[104:107], v[64:67]
    ds_read_b64_tr_b16 a[28:29], v15 offset:36864
    v_add_f32 v100, v100, v50
    v_mfma_f32_16x16x32_bf16 v[64:67], a[32:35], a[96:99], v[64:67]
    ds_read_b64_tr_b16 a[30:31], v15 offset:38912
    s_waitcnt lgkmcnt(8)
    v_mfma_f32_16x16x32_bf16 v[128:131], a[0:3], v[76:79], v[128:131]
    ds_read_b64_tr_b16 a[32:33], v12 offset:40960
    buffer_load_dwordx4 v37, s[40:43], s68 offen offset:1024 sc1 lds
    v_mfma_f32_16x16x32_bf16 v[136:139], a[0:3], v[80:83], v[136:139]
    ds_read_b64_tr_b16 a[34:35], v12 offset:43008
    buffer_load_dwordx4 a[136:139], v2, s[56:59], s69 offen offset:0 sc1
    v_mfma_f32_16x16x32_bf16 v[140:143], a[4:7], v[80:83], v[140:143]
    ds_read_b64_tr_b16 a[36:37], v13 offset:40960
    v_add_f32 v100, v100, v51
    v_mfma_f32_16x16x32_bf16 v[132:135], a[4:7], v[76:79], v[132:135]
    ds_read_b64_tr_b16 a[38:39], v13 offset:43008
    v_add_f32 v101, v101, v52
    v_mfma_f32_16x16x32_bf16 v[144:147], a[8:11], v[76:79], v[144:147]
    ds_read_b64_tr_b16 a[40:41], v14 offset:40960
    v_add_f32 v101, v101, v53
    v_mfma_f32_16x16x32_bf16 v[152:155], a[8:11], v[80:83], v[152:155]
    ds_read_b64_tr_b16 a[42:43], v14 offset:43008
    buffer_load_dwordx4 v38, s[40:43], s68 offen offset:2048 sc1 lds
    v_mfma_f32_16x16x32_bf16 v[156:159], a[12:15], v[80:83], v[156:159]
    ds_read_b64_tr_b16 a[44:45], v15 offset:40960
    v_add_f32 v101, v101, v54
    v_mfma_f32_16x16x32_bf16 v[148:151], a[12:15], v[76:79], v[148:151]
    ds_read_b64_tr_b16 a[46:47], v15 offset:43008
    s_waitcnt lgkmcnt(8)
    v_mfma_f32_16x16x32_bf16 v[160:163], a[16:19], v[76:79], v[160:163]
    ds_read_b64_tr_b16 a[0:1], v12 offset:45056
    v_add_f32 v101, v101, v55
    v_mfma_f32_16x16x32_bf16 v[168:171], a[16:19], v[80:83], v[168:171]
    ds_read_b64_tr_b16 a[2:3], v12 offset:47104
    v_add_f32 v101, v101, v56
    v_mfma_f32_16x16x32_bf16 v[172:175], a[20:23], v[80:83], v[172:175]
    ds_read_b64_tr_b16 a[4:5], v13 offset:45056
    buffer_load_dwordx4 v39, s[40:43], s68 offen offset:3072 sc1 lds
    v_mfma_f32_16x16x32_bf16 v[164:167], a[20:23], v[76:79], v[164:167]
    ds_read_b64_tr_b16 a[6:7], v13 offset:47104
    s_add_u32 m0, s67, 65536
    v_mfma_f32_16x16x32_bf16 v[176:179], a[24:27], v[76:79], v[176:179]
    ds_read_b64_tr_b16 a[8:9], v14 offset:45056
    buffer_load_dwordx4 a[152:155], v2, s[56:59], s69 offen offset:2048 sc1
    v_mfma_f32_16x16x32_bf16 v[184:187], a[24:27], v[80:83], v[184:187]
    ds_read_b64_tr_b16 a[10:11], v14 offset:47104
    s_mov_b32 s68, 196608
    v_mfma_f32_16x16x32_bf16 v[188:191], a[28:31], v[80:83], v[188:191]
    ds_read_b64_tr_b16 a[12:13], v15 offset:45056
    v_add_f32 v101, v101, v57
    v_mfma_f32_16x16x32_bf16 v[180:183], a[28:31], v[76:79], v[180:183]
    ds_read_b64_tr_b16 a[14:15], v15 offset:47104
    s_waitcnt lgkmcnt(8)
    v_mfma_f32_16x16x32_bf16 v[192:195], a[32:35], v[76:79], v[192:195]
    ds_read_b128 a[16:19], v22 offset:49152
    buffer_load_dwordx4 v40, s[44:47], s68 offen offset:0 sc1 lds
    v_mfma_f32_16x16x32_bf16 v[200:203], a[32:35], v[80:83], v[200:203]
    v_exp_f32 v60, v60
    v_mfma_f32_16x16x32_bf16 v[204:207], a[36:39], v[80:83], v[204:207]
    ds_read_b128 a[20:23], v23 offset:49152
    v_add_f32 v101, v101, v58
    v_mfma_f32_16x16x32_bf16 v[196:199], a[36:39], v[76:79], v[196:199]
    v_exp_f32 v61, v61
    v_mfma_f32_16x16x32_bf16 v[208:211], a[40:43], v[76:79], v[208:211]
    ds_read_b128 a[24:27], v22 offset:53248
    buffer_load_dwordx4 v41, s[44:47], s68 offen offset:1024 sc1 lds
    v_mfma_f32_16x16x32_bf16 v[216:219], a[40:43], v[80:83], v[216:219]
    s_add_u32 s69, s101, 0
    v_exp_f32 v62, v62
    v_mfma_f32_16x16x32_bf16 v[220:223], a[44:47], v[80:83], v[220:223]
    ds_read_b128 a[28:31], v23 offset:53248
    v_add_f32 v101, v101, v59
    v_mfma_f32_16x16x32_bf16 v[212:215], a[44:47], v[76:79], v[212:215]
    s_waitcnt lgkmcnt(4)
    v_exp_f32 v63, v63
    v_mfma_f32_16x16x32_bf16 v[224:227], a[0:3], v[76:79], v[224:227]
    ds_read_b128 a[32:35], v22 offset:57344
    buffer_load_dwordx4 v42, s[44:47], s68 offen offset:2048 sc1 lds
    v_mfma_f32_16x16x32_bf16 v[232:235], a[0:3], v[80:83], v[232:235]
    v_exp_f32 v64, v64
    v_mfma_f32_16x16x32_bf16 v[236:239], a[4:7], v[80:83], v[236:239]
    ds_read_b128 a[36:39], v23 offset:57344
    buffer_load_dwordx4 v43, s[44:47], s68 offen offset:3072 sc1 lds
    v_mfma_f32_16x16x32_bf16 v[228:231], a[4:7], v[76:79], v[228:231]
    v_exp_f32 v65, v65
    v_mfma_f32_16x16x32_bf16 v[240:243], a[8:11], v[76:79], v[240:243]
    ds_read_b128 a[40:43], v22 offset:61440
    v_cvt_pk_bf16_f32 v84, v60, v61
    v_mfma_f32_16x16x32_bf16 v[248:251], a[8:11], v[80:83], v[248:251]
    buffer_load_dwordx4 a[140:143], v2, s[56:59], s69 offen offset:0 sc1
    v_exp_f32 v66, v66
    v_mfma_f32_16x16x32_bf16 v[252:255], a[12:15], v[80:83], v[252:255]
    ds_read_b128 a[44:47], v23 offset:61440
    v_cvt_pk_bf16_f32 v85, v62, v63
    v_mfma_f32_16x16x32_bf16 v[244:247], a[12:15], v[76:79], v[244:247]
    s_waitcnt lgkmcnt(4)
    v_exp_f32 v67, v67
    v_mfma_f32_16x16x32_bf16 v[44:47], a[16:19], a[64:67], v[92:95]
    ds_read_b128 a[0:3], v22 offset:51200
    v_cvt_pk_bf16_f32 v86, v64, v65
    v_mfma_f32_16x16x32_bf16 v[44:47], a[20:23], a[72:75], v[44:47]
    v_exp_f32 v68, v68
    v_mfma_f32_16x16x32_bf16 v[44:47], a[24:27], a[80:83], v[44:47]
    ds_read_b128 a[4:7], v23 offset:51200
    v_cvt_pk_bf16_f32 v87, v66, v67
    v_mfma_f32_16x16x32_bf16 v[44:47], a[28:31], a[88:91], v[44:47]
    v_exp_f32 v69, v69
    v_mfma_f32_16x16x32_bf16 v[52:55], a[28:31], a[92:95], v[96:99]
    ds_read_b128 a[8:11], v22 offset:55296
    v_cvt_pk_bf16_f32 v88, v68, v69
    v_mfma_f32_16x16x32_bf16 v[52:55], a[24:27], a[84:87], v[52:55]
    v_exp_f32 v70, v70
    v_mfma_f32_16x16x32_bf16 v[52:55], a[20:23], a[76:79], v[52:55]
    ds_read_b128 a[12:15], v23 offset:55296
    buffer_load_dwordx4 a[156:159], v2, s[56:59], s69 offen offset:2048 sc1
    v_mfma_f32_16x16x32_bf16 v[52:55], a[16:19], a[68:71], v[52:55]
    s_waitcnt lgkmcnt(4)
    v_exp_f32 v71, v71
    v_mfma_f32_16x16x32_bf16 v[52:55], a[32:35], a[100:103], v[52:55]
    ds_read_b128 a[16:19], v22 offset:59392
    v_cvt_pk_bf16_f32 v89, v70, v71
    v_mfma_f32_16x16x32_bf16 v[52:55], a[36:39], a[108:111], v[52:55]
    v_exp_f32 v72, v72
    v_mfma_f32_16x16x32_bf16 v[52:55], a[40:43], a[116:119], v[52:55]
    ds_read_b128 a[20:23], v23 offset:59392
    v_add_f32 v100, v100, v60
    v_mfma_f32_16x16x32_bf16 v[52:55], a[44:47], a[124:127], v[52:55]
    v_exp_f32 v73, v73
    v_mfma_f32_16x16x32_bf16 v[44:47], a[44:47], a[120:123], v[44:47]
    ds_read_b128 a[24:27], v22 offset:63488
    v_cvt_pk_bf16_f32 v90, v72, v73
    v_mfma_f32_16x16x32_bf16 v[44:47], a[40:43], a[112:115], v[44:47]
    v_exp_f32 v74, v74
    v_mfma_f32_16x16x32_bf16 v[44:47], a[36:39], a[104:107], v[44:47]
    ds_read_b128 a[28:31], v23 offset:63488
    v_add_f32 v100, v100, v61
    v_mfma_f32_16x16x32_bf16 v[44:47], a[32:35], a[96:99], v[44:47]
    s_waitcnt vmcnt(30) lgkmcnt(4)
    v_exp_f32 v75, v75
    v_mfma_f32_16x16x32_bf16 v[48:51], a[0:3], a[64:67], v[92:95]
    s_barrier
    ds_read_b64_tr_b16 a[32:33], v16 offset:0
    v_mfma_f32_16x16x32_bf16 v[48:51], a[4:7], a[72:75], v[48:51]
    ds_read_b64_tr_b16 a[34:35], v16 offset:2048
    s_add_u32 m0, s67, 81920
    v_mfma_f32_16x16x32_bf16 v[48:51], a[8:11], a[80:83], v[48:51]
    ds_read_b64_tr_b16 a[36:37], v17 offset:0
    s_add_u32 s69, s98, 4096
    v_mfma_f32_16x16x32_bf16 v[48:51], a[12:15], a[88:91], v[48:51]
    ds_read_b64_tr_b16 a[38:39], v17 offset:2048
    v_cvt_pk_bf16_f32 v91, v74, v75
    v_mfma_f32_16x16x32_bf16 v[56:59], a[12:15], a[92:95], v[96:99]
    ds_read_b64_tr_b16 a[40:41], v18 offset:0
    v_add_f32 v100, v100, v62
    v_mfma_f32_16x16x32_bf16 v[56:59], a[8:11], a[84:87], v[56:59]
    ds_read_b64_tr_b16 a[42:43], v18 offset:2048
    v_add_f32 v100, v100, v63
    v_mfma_f32_16x16x32_bf16 v[56:59], a[4:7], a[76:79], v[56:59]
    ds_read_b64_tr_b16 a[44:45], v19 offset:0
    s_mov_b32 s68, 229376
    v_mfma_f32_16x16x32_bf16 v[56:59], a[0:3], a[68:71], v[56:59]
    ds_read_b64_tr_b16 a[46:47], v19 offset:2048
    s_waitcnt lgkmcnt(8)
    v_mfma_f32_16x16x32_bf16 v[56:59], a[16:19], a[100:103], v[56:59]
    ds_read_b64_tr_b16 a[0:1], v16 offset:4096
    buffer_load_dwordx4 a[160:163], v2, s[56:59], s69 offen offset:0 sc1
    v_mfma_f32_16x16x32_bf16 v[56:59], a[20:23], a[108:111], v[56:59]
    ds_read_b64_tr_b16 a[2:3], v16 offset:6144
    v_add_f32 v100, v100, v64
    v_mfma_f32_16x16x32_bf16 v[56:59], a[24:27], a[116:119], v[56:59]
    ds_read_b64_tr_b16 a[4:5], v17 offset:4096
    v_add_f32 v100, v100, v65
    v_mfma_f32_16x16x32_bf16 v[56:59], a[28:31], a[124:127], v[56:59]
    ds_read_b64_tr_b16 a[6:7], v17 offset:6144
    buffer_load_dwordx4 v36, s[40:43], s68 offen offset:0 sc1 lds
    v_mfma_f32_16x16x32_bf16 v[48:51], a[28:31], a[120:123], v[48:51]
    ds_read_b64_tr_b16 a[8:9], v18 offset:4096
    v_add_f32 v100, v100, v66
    v_mfma_f32_16x16x32_bf16 v[48:51], a[24:27], a[112:115], v[48:51]
    ds_read_b64_tr_b16 a[10:11], v18 offset:6144
    v_add_f32 v100, v100, v67
    v_mfma_f32_16x16x32_bf16 v[48:51], a[20:23], a[104:107], v[48:51]
    ds_read_b64_tr_b16 a[12:13], v19 offset:4096
    v_add_f32 v101, v101, v68
    v_mfma_f32_16x16x32_bf16 v[48:51], a[16:19], a[96:99], v[48:51]
    ds_read_b64_tr_b16 a[14:15], v19 offset:6144
    s_waitcnt lgkmcnt(8)
    v_mfma_f32_16x16x32_bf16 v[128:131], a[32:35], v[84:87], v[128:131]
    ds_read_b64_tr_b16 a[16:17], v16 offset:8192
    buffer_load_dwordx4 v37, s[40:43], s68 offen offset:1024 sc1 lds
    v_mfma_f32_16x16x32_bf16 v[136:139], a[32:35], v[88:91], v[136:139]
    ds_read_b64_tr_b16 a[18:19], v16 offset:10240
    buffer_load_dwordx4 a[176:179], v2, s[56:59], s69 offen offset:2048 sc1
    v_mfma_f32_16x16x32_bf16 v[140:143], a[36:39], v[88:91], v[140:143]
    ds_read_b64_tr_b16 a[20:21], v17 offset:8192
    v_add_f32 v101, v101, v69
    v_mfma_f32_16x16x32_bf16 v[132:135], a[36:39], v[84:87], v[132:135]
    ds_read_b64_tr_b16 a[22:23], v17 offset:10240
    v_add_f32 v101, v101, v70
    v_mfma_f32_16x16x32_bf16 v[144:147], a[40:43], v[84:87], v[144:147]
    ds_read_b64_tr_b16 a[24:25], v18 offset:8192
    v_add_f32 v101, v101, v71
    v_mfma_f32_16x16x32_bf16 v[152:155], a[40:43], v[88:91], v[152:155]
    ds_read_b64_tr_b16 a[26:27], v18 offset:10240
    buffer_load_dwordx4 v38, s[40:43], s68 offen offset:2048 sc1 lds
    v_mfma_f32_16x16x32_bf16 v[156:159], a[44:47], v[88:91], v[156:159]
    ds_read_b64_tr_b16 a[28:29], v19 offset:8192
    v_add_f32 v101, v101, v72
    v_mfma_f32_16x16x32_bf16 v[148:151], a[44:47], v[84:87], v[148:151]
    ds_read_b64_tr_b16 a[30:31], v19 offset:10240
    s_waitcnt lgkmcnt(8)
    v_mfma_f32_16x16x32_bf16 v[160:163], a[0:3], v[84:87], v[160:163]
    ds_read_b64_tr_b16 a[32:33], v16 offset:12288
    v_add_f32 v101, v101, v73
    v_mfma_f32_16x16x32_bf16 v[168:171], a[0:3], v[88:91], v[168:171]
    ds_read_b64_tr_b16 a[34:35], v16 offset:14336
    v_add_f32 v101, v101, v74
    v_mfma_f32_16x16x32_bf16 v[172:175], a[4:7], v[88:91], v[172:175]
    ds_read_b64_tr_b16 a[36:37], v17 offset:12288
    buffer_load_dwordx4 v39, s[40:43], s68 offen offset:3072 sc1 lds
    v_mfma_f32_16x16x32_bf16 v[164:167], a[4:7], v[84:87], v[164:167]
    ds_read_b64_tr_b16 a[38:39], v17 offset:14336
    s_add_u32 m0, s67, 98304
    v_mfma_f32_16x16x32_bf16 v[176:179], a[8:11], v[84:87], v[176:179]
    ds_read_b64_tr_b16 a[40:41], v18 offset:12288
    s_add_u32 s69, s99, 4096
    v_mfma_f32_16x16x32_bf16 v[184:187], a[8:11], v[88:91], v[184:187]
    ds_read_b64_tr_b16 a[42:43], v18 offset:14336
    s_mov_b32 s68, 212992
    v_mfma_f32_16x16x32_bf16 v[188:191], a[12:15], v[88:91], v[188:191]
    ds_read_b64_tr_b16 a[44:45], v19 offset:12288
    v_add_f32 v101, v101, v75
    v_mfma_f32_16x16x32_bf16 v[180:183], a[12:15], v[84:87], v[180:183]
    ds_read_b64_tr_b16 a[46:47], v19 offset:14336
    s_waitcnt lgkmcnt(8)
    v_mfma_f32_16x16x32_bf16 v[192:195], a[16:19], v[84:87], v[192:195]
    ds_read_b128 a[0:3], v24 offset:16384
    buffer_load_dwordx4 v40, s[44:47], s68 offen offset:0 sc1 lds
    v_mfma_f32_16x16x32_bf16 v[200:203], a[16:19], v[88:91], v[200:203]
    v_exp_f32 v44, v44
    v_mfma_f32_16x16x32_bf16 v[204:207], a[20:23], v[88:91], v[204:207]
    ds_read_b128 a[4:7], v25 offset:16384
    v_add_f32 v100, v100, v44
    v_mfma_f32_16x16x32_bf16 v[196:199], a[20:23], v[84:87], v[196:199]
    v_exp_f32 v45, v45
    v_mfma_f32_16x16x32_bf16 v[208:211], a[24:27], v[84:87], v[208:211]
    ds_read_b128 a[8:11], v24 offset:20480
    buffer_load_dwordx4 v41, s[44:47], s68 offen offset:1024 sc1 lds
    v_mfma_f32_16x16x32_bf16 v[216:219], a[24:27], v[88:91], v[216:219]
    buffer_load_dwordx4 a[164:167], v2, s[56:59], s69 offen offset:0 sc1
    v_exp_f32 v46, v46
    v_mfma_f32_16x16x32_bf16 v[220:223], a[28:31], v[88:91], v[220:223]
    ds_read_b128 a[12:15], v25 offset:20480
    s_add_u32 s93, s93, 57344
    v_mfma_f32_16x16x32_bf16 v[212:215], a[28:31], v[84:87], v[212:215]
    s_waitcnt lgkmcnt(4)
    v_exp_f32 v47, v47
    v_mfma_f32_16x16x32_bf16 v[224:227], a[32:35], v[84:87], v[224:227]
    ds_read_b128 a[16:19], v24 offset:24576
    buffer_load_dwordx4 v42, s[44:47], s68 offen offset:2048 sc1 lds
    v_mfma_f32_16x16x32_bf16 v[232:235], a[32:35], v[88:91], v[232:235]
    s_sub_u32 s92, s93, 401408
    v_exp_f32 v48, v48
    v_mfma_f32_16x16x32_bf16 v[236:239], a[36:39], v[88:91], v[236:239]
    ds_read_b128 a[20:23], v25 offset:24576
    buffer_load_dwordx4 v43, s[44:47], s68 offen offset:3072 sc1 lds
    v_mfma_f32_16x16x32_bf16 v[228:231], a[36:39], v[84:87], v[228:231]
    s_min_u32 s93, s93, s92
    v_exp_f32 v49, v49
    v_mfma_f32_16x16x32_bf16 v[240:243], a[40:43], v[84:87], v[240:243]
    ds_read_b128 a[24:27], v24 offset:28672
    buffer_load_dword a61, v27, s[52:55], s93 offen
    v_mfma_f32_16x16x32_bf16 v[248:251], a[40:43], v[88:91], v[248:251]
    buffer_load_dwordx4 a[180:183], v2, s[56:59], s69 offen offset:2048 sc1
    v_exp_f32 v50, v50
    v_mfma_f32_16x16x32_bf16 v[252:255], a[44:47], v[88:91], v[252:255]
    ds_read_b128 a[28:31], v25 offset:28672
    v_cvt_pk_bf16_f32 v76, v44, v45
    v_mfma_f32_16x16x32_bf16 v[244:247], a[44:47], v[84:87], v[244:247]
    s_waitcnt lgkmcnt(4)
    v_exp_f32 v51, v51
    v_mfma_f32_16x16x32_bf16 v[60:63], a[0:3], a[64:67], v[92:95]
    ds_read_b128 a[32:35], v24 offset:18432
    v_cvt_pk_bf16_f32 v77, v46, v47
    v_mfma_f32_16x16x32_bf16 v[60:63], a[4:7], a[72:75], v[60:63]
    v_exp_f32 v52, v52
    v_mfma_f32_16x16x32_bf16 v[60:63], a[8:11], a[80:83], v[60:63]
    ds_read_b128 a[36:39], v25 offset:18432
    v_cvt_pk_bf16_f32 v78, v48, v49
    v_mfma_f32_16x16x32_bf16 v[60:63], a[12:15], a[88:91], v[60:63]
    v_exp_f32 v53, v53
    v_mfma_f32_16x16x32_bf16 v[68:71], a[12:15], a[92:95], v[96:99]
    ds_read_b128 a[40:43], v24 offset:22528
    v_cvt_pk_bf16_f32 v79, v50, v51
    v_mfma_f32_16x16x32_bf16 v[68:71], a[8:11], a[84:87], v[68:71]
    v_exp_f32 v54, v54
    v_mfma_f32_16x16x32_bf16 v[68:71], a[4:7], a[76:79], v[68:71]
    ds_read_b128 a[44:47], v25 offset:22528
    s_add_u32 s69, s100, 4096
    v_mfma_f32_16x16x32_bf16 v[68:71], a[0:3], a[68:71], v[68:71]
    s_waitcnt lgkmcnt(4)
    v_exp_f32 v55, v55
    v_mfma_f32_16x16x32_bf16 v[68:71], a[16:19], a[100:103], v[68:71]
    ds_read_b128 a[0:3], v24 offset:26624
    v_cvt_pk_bf16_f32 v80, v52, v53
    v_mfma_f32_16x16x32_bf16 v[68:71], a[20:23], a[108:111], v[68:71]
    v_exp_f32 v56, v56
    v_mfma_f32_16x16x32_bf16 v[68:71], a[24:27], a[116:119], v[68:71]
    ds_read_b128 a[4:7], v25 offset:26624
    v_cvt_pk_bf16_f32 v81, v54, v55
    v_mfma_f32_16x16x32_bf16 v[68:71], a[28:31], a[124:127], v[68:71]
    v_exp_f32 v57, v57
    v_mfma_f32_16x16x32_bf16 v[60:63], a[28:31], a[120:123], v[60:63]
    ds_read_b128 a[8:11], v24 offset:30720
    v_cvt_pk_bf16_f32 v82, v56, v57
    v_mfma_f32_16x16x32_bf16 v[60:63], a[24:27], a[112:115], v[60:63]
    v_exp_f32 v58, v58
    v_mfma_f32_16x16x32_bf16 v[60:63], a[20:23], a[104:107], v[60:63]
    ds_read_b128 a[12:15], v25 offset:30720
    v_add_f32 v100, v100, v45
    v_mfma_f32_16x16x32_bf16 v[60:63], a[16:19], a[96:99], v[60:63]
    s_waitcnt vmcnt(34) lgkmcnt(4)
    v_exp_f32 v59, v59
    v_mfma_f32_16x16x32_bf16 v[64:67], a[32:35], a[64:67], v[92:95]
    s_barrier
    ds_read_b64_tr_b16 a[16:17], v8 offset:0
    v_mfma_f32_16x16x32_bf16 v[64:67], a[36:39], a[72:75], v[64:67]
    ds_read_b64_tr_b16 a[18:19], v8 offset:2048
    s_add_u32 m0, s67, 114688
    v_mfma_f32_16x16x32_bf16 v[64:67], a[40:43], a[80:83], v[64:67]
    ds_read_b64_tr_b16 a[20:21], v9 offset:0
    buffer_load_dwordx4 a[168:171], v2, s[56:59], s69 offen offset:0 sc1
    v_mfma_f32_16x16x32_bf16 v[64:67], a[44:47], a[88:91], v[64:67]
    ds_read_b64_tr_b16 a[22:23], v9 offset:2048
    v_cvt_pk_bf16_f32 v83, v58, v59
    v_mfma_f32_16x16x32_bf16 v[72:75], a[44:47], a[92:95], v[96:99]
    ds_read_b64_tr_b16 a[24:25], v10 offset:0
    v_add_f32 v100, v100, v46
    v_mfma_f32_16x16x32_bf16 v[72:75], a[40:43], a[84:87], v[72:75]
    ds_read_b64_tr_b16 a[26:27], v10 offset:2048
    v_add_f32 v100, v100, v47
    v_mfma_f32_16x16x32_bf16 v[72:75], a[36:39], a[76:79], v[72:75]
    ds_read_b64_tr_b16 a[28:29], v11 offset:0
    s_mov_b32 s68, 245760
    v_mfma_f32_16x16x32_bf16 v[72:75], a[32:35], a[68:71], v[72:75]
    ds_read_b64_tr_b16 a[30:31], v11 offset:2048
    s_waitcnt lgkmcnt(8)
    v_mfma_f32_16x16x32_bf16 v[72:75], a[0:3], a[100:103], v[72:75]
    ds_read_b64_tr_b16 a[32:33], v8 offset:4096
    buffer_load_dwordx4 a[184:187], v2, s[56:59], s69 offen offset:2048 sc1
    v_mfma_f32_16x16x32_bf16 v[72:75], a[4:7], a[108:111], v[72:75]
    ds_read_b64_tr_b16 a[34:35], v8 offset:6144
    v_add_f32 v100, v100, v48
    v_mfma_f32_16x16x32_bf16 v[72:75], a[8:11], a[116:119], v[72:75]
    ds_read_b64_tr_b16 a[36:37], v9 offset:4096
    v_add_f32 v100, v100, v49
    v_mfma_f32_16x16x32_bf16 v[72:75], a[12:15], a[124:127], v[72:75]
    ds_read_b64_tr_b16 a[38:39], v9 offset:6144
    buffer_load_dwordx4 v36, s[40:43], s68 offen offset:0 sc1 lds
    v_mfma_f32_16x16x32_bf16 v[64:67], a[12:15], a[120:123], v[64:67]
    ds_read_b64_tr_b16 a[40:41], v10 offset:4096
    v_add_f32 v100, v100, v50
    v_mfma_f32_16x16x32_bf16 v[64:67], a[8:11], a[112:115], v[64:67]
    ds_read_b64_tr_b16 a[42:43], v10 offset:6144
    v_add_f32 v100, v100, v51
    v_mfma_f32_16x16x32_bf16 v[64:67], a[4:7], a[104:107], v[64:67]
    ds_read_b64_tr_b16 a[44:45], v11 offset:4096
    v_add_f32 v101, v101, v52
    v_mfma_f32_16x16x32_bf16 v[64:67], a[0:3], a[96:99], v[64:67]
    ds_read_b64_tr_b16 a[46:47], v11 offset:6144
    s_waitcnt lgkmcnt(8)
    v_mfma_f32_16x16x32_bf16 v[128:131], a[16:19], v[76:79], v[128:131]
    ds_read_b64_tr_b16 a[0:1], v8 offset:8192
    buffer_load_dwordx4 v37, s[40:43], s68 offen offset:1024 sc1 lds
    v_mfma_f32_16x16x32_bf16 v[136:139], a[16:19], v[80:83], v[136:139]
    ds_read_b64_tr_b16 a[2:3], v8 offset:10240
    s_add_u32 s69, s101, 4096
    v_mfma_f32_16x16x32_bf16 v[140:143], a[20:23], v[80:83], v[140:143]
    ds_read_b64_tr_b16 a[4:5], v9 offset:8192
    v_add_f32 v101, v101, v53
    v_mfma_f32_16x16x32_bf16 v[132:135], a[20:23], v[76:79], v[132:135]
    ds_read_b64_tr_b16 a[6:7], v9 offset:10240
    v_add_f32 v101, v101, v54
    v_mfma_f32_16x16x32_bf16 v[144:147], a[24:27], v[76:79], v[144:147]
    ds_read_b64_tr_b16 a[8:9], v10 offset:8192
    v_add_f32 v101, v101, v55
    v_mfma_f32_16x16x32_bf16 v[152:155], a[24:27], v[80:83], v[152:155]
    ds_read_b64_tr_b16 a[10:11], v10 offset:10240
    buffer_load_dwordx4 v38, s[40:43], s68 offen offset:2048 sc1 lds
    v_mfma_f32_16x16x32_bf16 v[156:159], a[28:31], v[80:83], v[156:159]
    ds_read_b64_tr_b16 a[12:13], v11 offset:8192
    v_add_f32 v101, v101, v56
    v_mfma_f32_16x16x32_bf16 v[148:151], a[28:31], v[76:79], v[148:151]
    ds_read_b64_tr_b16 a[14:15], v11 offset:10240
    s_waitcnt lgkmcnt(8)
    v_mfma_f32_16x16x32_bf16 v[160:163], a[32:35], v[76:79], v[160:163]
    ds_read_b64_tr_b16 a[16:17], v8 offset:12288
    v_add_f32 v101, v101, v57
    v_mfma_f32_16x16x32_bf16 v[168:171], a[32:35], v[80:83], v[168:171]
    ds_read_b64_tr_b16 a[18:19], v8 offset:14336
    v_add_f32 v101, v101, v58
    v_mfma_f32_16x16x32_bf16 v[172:175], a[36:39], v[80:83], v[172:175]
    ds_read_b64_tr_b16 a[20:21], v9 offset:12288
    buffer_load_dwordx4 v39, s[40:43], s68 offen offset:3072 sc1 lds
    v_mfma_f32_16x16x32_bf16 v[164:167], a[36:39], v[76:79], v[164:167]
    ds_read_b64_tr_b16 a[22:23], v9 offset:14336
    s_add_u32 m0, s67, 131072
    v_mfma_f32_16x16x32_bf16 v[176:179], a[40:43], v[76:79], v[176:179]
    ds_read_b64_tr_b16 a[24:25], v10 offset:12288
    buffer_load_dwordx4 a[172:175], v2, s[56:59], s69 offen offset:0 sc1
    v_mfma_f32_16x16x32_bf16 v[184:187], a[40:43], v[80:83], v[184:187]
    ds_read_b64_tr_b16 a[26:27], v10 offset:14336
    s_mov_b32 s68, 229376
    v_mfma_f32_16x16x32_bf16 v[188:191], a[44:47], v[80:83], v[188:191]
    ds_read_b64_tr_b16 a[28:29], v11 offset:12288
    v_add_f32 v101, v101, v59
    v_mfma_f32_16x16x32_bf16 v[180:183], a[44:47], v[76:79], v[180:183]
    ds_read_b64_tr_b16 a[30:31], v11 offset:14336
    s_waitcnt lgkmcnt(8)
    v_mfma_f32_16x16x32_bf16 v[192:195], a[0:3], v[76:79], v[192:195]
    ds_read_b128 a[32:35], v20 offset:16384
    buffer_load_dwordx4 v40, s[44:47], s68 offen offset:0 sc1 lds
    v_mfma_f32_16x16x32_bf16 v[200:203], a[0:3], v[80:83], v[200:203]
    v_exp_f32 v60, v60
    v_mfma_f32_16x16x32_bf16 v[204:207], a[4:7], v[80:83], v[204:207]
    ds_read_b128 a[36:39], v21 offset:16384
    v_add_f32 v100, v100, v60
    v_mfma_f32_16x16x32_bf16 v[196:199], a[4:7], v[76:79], v[196:199]
    buffer_load_dwordx4 a[188:191], v2, s[56:59], s69 offen offset:2048 sc1
    v_exp_f32 v61, v61
    v_mfma_f32_16x16x32_bf16 v[208:211], a[8:11], v[76:79], v[208:211]
    ds_read_b128 a[40:43], v20 offset:20480
    buffer_load_dwordx4 v41, s[44:47], s68 offen offset:1024 sc1 lds
    v_mfma_f32_16x16x32_bf16 v[216:219], a[8:11], v[80:83], v[216:219]
    v_exp_f32 v62, v62
    v_mfma_f32_16x16x32_bf16 v[220:223], a[12:15], v[80:83], v[220:223]
    ds_read_b128 a[44:47], v21 offset:20480
    v_cvt_pk_bf16_f32 v84, v60, v61
L_pg7:
    s_cbranch_execz L_main
    v_mfma_f32_16x16x32_bf16 v[212:215], a[12:15], v[76:79], v[212:215]
    s_waitcnt lgkmcnt(4)
    v_exp_f32 v63, v63
    v_mfma_f32_16x16x32_bf16 v[224:227], a[16:19], v[76:79], v[224:227]
    ds_read_b128 a[0:3], v20 offset:24576
    buffer_load_dwordx4 v42, s[44:47], s68 offen offset:2048 sc1 lds
    v_mfma_f32_16x16x32_bf16 v[232:235], a[16:19], v[80:83], v[232:235]
    v_exp_f32 v64, v64
    v_mfma_f32_16x16x32_bf16 v[236:239], a[20:23], v[80:83], v[236:239]
    ds_read_b128 a[4:7], v21 offset:24576
    buffer_load_dwordx4 v43, s[44:47], s68 offen offset:3072 sc1 lds
    v_mfma_f32_16x16x32_bf16 v[228:231], a[20:23], v[76:79], v[228:231]
    v_exp_f32 v65, v65
    v_mfma_f32_16x16x32_bf16 v[240:243], a[24:27], v[76:79], v[240:243]
    ds_read_b128 a[8:11], v20 offset:28672
    v_cvt_pk_bf16_f32 v85, v62, v63
    v_mfma_f32_16x16x32_bf16 v[248:251], a[24:27], v[80:83], v[248:251]
    s_add_u32 s69, s98, 8192
    v_exp_f32 v66, v66
    v_mfma_f32_16x16x32_bf16 v[252:255], a[28:31], v[80:83], v[252:255]
    ds_read_b128 a[12:15], v21 offset:28672
    v_cvt_pk_bf16_f32 v86, v64, v65
    v_mfma_f32_16x16x32_bf16 v[244:247], a[28:31], v[76:79], v[244:247]
    s_waitcnt lgkmcnt(4)
    v_exp_f32 v67, v67
    v_mfma_f32_16x16x32_bf16 v[44:47], a[32:35], a[64:67], v[92:95]
    ds_read_b128 a[16:19], v20 offset:18432
    v_cvt_pk_bf16_f32 v87, v66, v67
    v_mfma_f32_16x16x32_bf16 v[44:47], a[36:39], a[72:75], v[44:47]
    v_exp_f32 v68, v68
    v_mfma_f32_16x16x32_bf16 v[44:47], a[40:43], a[80:83], v[44:47]
    ds_read_b128 a[20:23], v21 offset:18432
    v_add_f32 v100, v100, v61
    v_mfma_f32_16x16x32_bf16 v[44:47], a[44:47], a[88:91], v[44:47]
    v_exp_f32 v69, v69
    v_mfma_f32_16x16x32_bf16 v[52:55], a[44:47], a[92:95], v[96:99]
    ds_read_b128 a[24:27], v20 offset:22528
    v_cvt_pk_bf16_f32 v88, v68, v69
    v_mfma_f32_16x16x32_bf16 v[52:55], a[40:43], a[84:87], v[52:55]
    v_exp_f32 v70, v70
    v_mfma_f32_16x16x32_bf16 v[52:55], a[36:39], a[76:79], v[52:55]
    ds_read_b128 a[28:31], v21 offset:22528
    buffer_load_dwordx4 a[192:195], v2, s[56:59], s69 offen offset:0 sc1
    v_mfma_f32_16x16x32_bf16 v[52:55], a[32:35], a[68:71], v[52:55]
    s_waitcnt lgkmcnt(4)
    v_exp_f32 v71, v71
    v_mfma_f32_16x16x32_bf16 v[52:55], a[0:3], a[100:103], v[52:55]
    ds_read_b128 a[32:35], v20 offset:26624
    v_cvt_pk_bf16_f32 v89, v70, v71
    v_mfma_f32_16x16x32_bf16 v[52:55], a[4:7], a[108:111], v[52:55]
    v_exp_f32 v72, v72
    v_mfma_f32_16x16x32_bf16 v[52:55], a[8:11], a[116:119], v[52:55]
    ds_read_b128 a[36:39], v21 offset:26624
    v_add_f32 v100, v100, v62
    v_mfma_f32_16x16x32_bf16 v[52:55], a[12:15], a[124:127], v[52:55]
    v_exp_f32 v73, v73
    v_mfma_f32_16x16x32_bf16 v[44:47], a[12:15], a[120:123], v[44:47]
    ds_read_b128 a[40:43], v20 offset:30720
    v_cvt_pk_bf16_f32 v90, v72, v73
    v_mfma_f32_16x16x32_bf16 v[44:47], a[8:11], a[112:115], v[44:47]
    v_exp_f32 v74, v74
    v_mfma_f32_16x16x32_bf16 v[44:47], a[4:7], a[104:107], v[44:47]
    ds_read_b128 a[44:47], v21 offset:30720
    v_add_f32 v100, v100, v63
    v_mfma_f32_16x16x32_bf16 v[44:47], a[0:3], a[96:99], v[44:47]
    s_waitcnt vmcnt(33) lgkmcnt(4)
    v_exp_f32 v75, v75
    v_mfma_f32_16x16x32_bf16 v[48:51], a[16:19], a[64:67], v[92:95]
    s_barrier
    ds_read_b64_tr_b16 a[0:1], v8 offset:32768
    v_mfma_f32_16x16x32_bf16 v[48:51], a[20:23], a[72:75], v[48:51]
    ds_read_b64_tr_b16 a[2:3], v8 offset:34816
    s_add_u32 m0, s67, 147456
    v_mfma_f32_16x16x32_bf16 v[48:51], a[24:27], a[80:83], v[48:51]
    ds_read_b64_tr_b16 a[4:5], v9 offset:32768
    buffer_load_dwordx4 a[208:211], v2, s[56:59], s69 offen offset:2048 sc1
    v_mfma_f32_16x16x32_bf16 v[48:51], a[28:31], a[88:91], v[48:51]
    ds_read_b64_tr_b16 a[6:7], v9 offset:34816
    v_cvt_pk_bf16_f32 v91, v74, v75
    v_mfma_f32_16x16x32_bf16 v[56:59], a[28:31], a[92:95], v[96:99]
    ds_read_b64_tr_b16 a[8:9], v10 offset:32768
    v_add_f32 v100, v100, v64
    v_mfma_f32_16x16x32_bf16 v[56:59], a[24:27], a[84:87], v[56:59]
    ds_read_b64_tr_b16 a[10:11], v10 offset:34816
    v_add_f32 v100, v100, v65
    v_mfma_f32_16x16x32_bf16 v[56:59], a[20:23], a[76:79], v[56:59]
    ds_read_b64_tr_b16 a[12:13], v11 offset:32768
    s_mov_b32 s68, 245760
    v_mfma_f32_16x16x32_bf16 v[56:59], a[16:19], a[68:71], v[56:59]
    ds_read_b64_tr_b16 a[14:15], v11 offset:34816
    s_waitcnt lgkmcnt(8)
    v_mfma_f32_16x16x32_bf16 v[56:59], a[32:35], a[100:103], v[56:59]
    ds_read_b64_tr_b16 a[16:17], v8 offset:36864
    s_add_u32 s69, s99, 8192
    v_mfma_f32_16x16x32_bf16 v[56:59], a[36:39], a[108:111], v[56:59]
    ds_read_b64_tr_b16 a[18:19], v8 offset:38912
    s_add_u32 s93, s93, 57344
    v_mfma_f32_16x16x32_bf16 v[56:59], a[40:43], a[116:119], v[56:59]
    ds_read_b64_tr_b16 a[20:21], v9 offset:36864
    s_sub_u32 s92, s93, 401408
    v_mfma_f32_16x16x32_bf16 v[56:59], a[44:47], a[124:127], v[56:59]
    ds_read_b64_tr_b16 a[22:23], v9 offset:38912
    buffer_load_dwordx4 v40, s[44:47], s68 offen offset:0 sc1 lds
    v_mfma_f32_16x16x32_bf16 v[48:51], a[44:47], a[120:123], v[48:51]
    ds_read_b64_tr_b16 a[24:25], v10 offset:36864
    s_min_u32 s93, s93, s92
    v_mfma_f32_16x16x32_bf16 v[48:51], a[40:43], a[112:115], v[48:51]
    ds_read_b64_tr_b16 a[26:27], v10 offset:38912
    buffer_load_dword a62, v27, s[52:55], s93 offen
    v_mfma_f32_16x16x32_bf16 v[48:51], a[36:39], a[104:107], v[48:51]
    ds_read_b64_tr_b16 a[28:29], v11 offset:36864
    v_add_f32 v100, v100, v66
    v_mfma_f32_16x16x32_bf16 v[48:51], a[32:35], a[96:99], v[48:51]
    ds_read_b64_tr_b16 a[30:31], v11 offset:38912
    s_waitcnt lgkmcnt(8)
    v_mfma_f32_16x16x32_bf16 v[128:131], a[0:3], v[84:87], v[128:131]
    ds_read_b64_tr_b16 a[32:33], v8 offset:40960
    buffer_load_dwordx4 v41, s[44:47], s68 offen offset:1024 sc1 lds
    v_mfma_f32_16x16x32_bf16 v[136:139], a[0:3], v[88:91], v[136:139]
    ds_read_b64_tr_b16 a[34:35], v8 offset:43008
    buffer_load_dwordx4 a[196:199], v2, s[56:59], s69 offen offset:0 sc1
    v_mfma_f32_16x16x32_bf16 v[140:143], a[4:7], v[88:91], v[140:143]
    ds_read_b64_tr_b16 a[36:37], v9 offset:40960
    v_add_f32 v100, v100, v67
    v_mfma_f32_16x16x32_bf16 v[132:135], a[4:7], v[84:87], v[132:135]
    ds_read_b64_tr_b16 a[38:39], v9 offset:43008
    v_add_f32 v101, v101, v68
    v_mfma_f32_16x16x32_bf16 v[144:147], a[8:11], v[84:87], v[144:147]
    ds_read_b64_tr_b16 a[40:41], v10 offset:40960
    v_add_f32 v101, v101, v69
    v_mfma_f32_16x16x32_bf16 v[152:155], a[8:11], v[88:91], v[152:155]
    ds_read_b64_tr_b16 a[42:43], v10 offset:43008
    buffer_load_dwordx4 v42, s[44:47], s68 offen offset:2048 sc1 lds
    v_mfma_f32_16x16x32_bf16 v[156:159], a[12:15], v[88:91], v[156:159]
    ds_read_b64_tr_b16 a[44:45], v11 offset:40960
    v_add_f32 v101, v101, v70
    v_mfma_f32_16x16x32_bf16 v[148:151], a[12:15], v[84:87], v[148:151]
    ds_read_b64_tr_b16 a[46:47], v11 offset:43008
    s_waitcnt lgkmcnt(8)
    v_mfma_f32_16x16x32_bf16 v[160:163], a[16:19], v[84:87], v[160:163]
    ds_read_b64_tr_b16 a[0:1], v8 offset:45056
    v_add_f32 v101, v101, v71
    v_mfma_f32_16x16x32_bf16 v[168:171], a[16:19], v[88:91], v[168:171]
    ds_read_b64_tr_b16 a[2:3], v8 offset:47104
    v_add_f32 v101, v101, v72
    v_mfma_f32_16x16x32_bf16 v[172:175], a[20:23], v[88:91], v[172:175]
    ds_read_b64_tr_b16 a[4:5], v9 offset:45056
    buffer_load_dwordx4 v43, s[44:47], s68 offen offset:3072 sc1 lds
    v_mfma_f32_16x16x32_bf16 v[164:167], a[20:23], v[84:87], v[164:167]
    ds_read_b64_tr_b16 a[6:7], v9 offset:47104
    v_accvgpr_read_b32 v32, a48
    v_mfma_f32_16x16x32_bf16 v[176:179], a[24:27], v[84:87], v[176:179]
    ds_read_b64_tr_b16 a[8:9], v10 offset:45056
    v_accvgpr_read_b32 v33, a49
    v_mfma_f32_16x16x32_bf16 v[184:187], a[24:27], v[88:91], v[184:187]
    ds_read_b64_tr_b16 a[10:11], v10 offset:47104
    buffer_load_dwordx4 a[212:215], v2, s[56:59], s69 offen offset:2048 sc1
    v_mfma_f32_16x16x32_bf16 v[188:191], a[28:31], v[88:91], v[188:191]
    ds_read_b64_tr_b16 a[12:13], v11 offset:45056
    v_accvgpr_read_b32 v34, a50
    v_mfma_f32_16x16x32_bf16 v[180:183], a[28:31], v[84:87], v[180:183]
    ds_read_b64_tr_b16 a[14:15], v11 offset:47104
    s_waitcnt lgkmcnt(8)
    v_mfma_f32_16x16x32_bf16 v[192:195], a[32:35], v[84:87], v[192:195]
    ds_read_b128 a[16:19], v20 offset:49152
    v_accvgpr_read_b32 v35, a51
    v_mfma_f32_16x16x32_bf16 v[200:203], a[32:35], v[88:91], v[200:203]
    v_exp_f32 v44, v44
    v_mfma_f32_16x16x32_bf16 v[204:207], a[36:39], v[88:91], v[204:207]
    ds_read_b128 a[20:23], v21 offset:49152
    s_add_u32 m0, s67, 0
    v_mfma_f32_16x16x32_bf16 v[196:199], a[36:39], v[84:87], v[196:199]
    s_add_u32 s69, s100, 8192
    v_exp_f32 v45, v45
    v_mfma_f32_16x16x32_bf16 v[208:211], a[40:43], v[84:87], v[208:211]
    ds_read_b128 a[24:27], v20 offset:53248
    v_add_f32 v101, v101, v73
    v_mfma_f32_16x16x32_bf16 v[216:219], a[40:43], v[88:91], v[216:219]
    buffer_load_dwordx4 v32, s[48:51], s72 offen offset:0 sc1 lds
    v_exp_f32 v46, v46
    v_mfma_f32_16x16x32_bf16 v[220:223], a[44:47], v[88:91], v[220:223]
    ds_read_b128 a[28:31], v21 offset:53248
    v_add_f32 v101, v101, v74
    v_mfma_f32_16x16x32_bf16 v[212:215], a[44:47], v[84:87], v[212:215]
    s_waitcnt lgkmcnt(4)
    v_exp_f32 v47, v47
    v_mfma_f32_16x16x32_bf16 v[224:227], a[0:3], v[84:87], v[224:227]
    ds_read_b128 a[32:35], v20 offset:57344
    buffer_load_dwordx4 v33, s[48:51], s72 offen offset:1024 sc1 lds
    v_mfma_f32_16x16x32_bf16 v[232:235], a[0:3], v[88:91], v[232:235]
    buffer_load_dwordx4 v34, s[48:51], s72 offen offset:2048 sc1 lds
    v_exp_f32 v48, v48
    v_mfma_f32_16x16x32_bf16 v[236:239], a[4:7], v[88:91], v[236:239]
    ds_read_b128 a[36:39], v21 offset:57344
    v_add_f32 v101, v101, v75
    v_mfma_f32_16x16x32_bf16 v[228:231], a[4:7], v[84:87], v[228:231]
    buffer_load_dwordx4 v35, s[48:51], s72 offen offset:3072 sc1 lds
    v_exp_f32 v49, v49
    v_mfma_f32_16x16x32_bf16 v[240:243], a[8:11], v[84:87], v[240:243]
    ds_read_b128 a[40:43], v20 offset:61440
    buffer_load_dwordx4 a[200:203], v2, s[56:59], s69 offen offset:0 sc1
    v_mfma_f32_16x16x32_bf16 v[248:251], a[8:11], v[88:91], v[248:251]
    v_exp_f32 v50, v50
    v_mfma_f32_16x16x32_bf16 v[252:255], a[12:15], v[88:91], v[252:255]
    ds_read_b128 a[44:47], v21 offset:61440
    v_cvt_pk_bf16_f32 v76, v44, v45
    v_mfma_f32_16x16x32_bf16 v[244:247], a[12:15], v[84:87], v[244:247]
    s_waitcnt lgkmcnt(4)
    v_exp_f32 v51, v51
    v_mfma_f32_16x16x32_bf16 v[60:63], a[16:19], a[64:67], v[92:95]
    ds_read_b128 a[0:3], v20 offset:51200
    v_accvgpr_read_b32 v4, a56
    v_mfma_f32_16x16x32_bf16 v[60:63], a[20:23], a[72:75], v[60:63]
    v_exp_f32 v52, v52
    v_mfma_f32_16x16x32_bf16 v[60:63], a[24:27], a[80:83], v[60:63]
    ds_read_b128 a[4:7], v21 offset:51200
    v_cvt_pk_bf16_f32 v77, v46, v47
    v_mfma_f32_16x16x32_bf16 v[60:63], a[28:31], a[88:91], v[60:63]
    v_exp_f32 v53, v53
    v_mfma_f32_16x16x32_bf16 v[68:71], a[28:31], a[92:95], v[96:99]
    ds_read_b128 a[8:11], v20 offset:55296
    v_cvt_pk_bf16_f32 v78, v48, v49
    v_mfma_f32_16x16x32_bf16 v[68:71], a[24:27], a[84:87], v[68:71]
    v_exp_f32 v54, v54
    v_mfma_f32_16x16x32_bf16 v[68:71], a[20:23], a[76:79], v[68:71]
    ds_read_b128 a[12:15], v21 offset:55296
    buffer_load_dwordx4 a[216:219], v2, s[56:59], s69 offen offset:2048 sc1
    v_mfma_f32_16x16x32_bf16 v[68:71], a[16:19], a[68:71], v[68:71]
    s_waitcnt lgkmcnt(4)
    v_exp_f32 v55, v55
    v_mfma_f32_16x16x32_bf16 v[68:71], a[32:35], a[100:103], v[68:71]
    ds_read_b128 a[16:19], v20 offset:59392
    v_readfirstlane_b32 s71, v4
    v_mfma_f32_16x16x32_bf16 v[68:71], a[36:39], a[108:111], v[68:71]
    v_exp_f32 v56, v56
    v_mfma_f32_16x16x32_bf16 v[68:71], a[40:43], a[116:119], v[68:71]
    ds_read_b128 a[20:23], v21 offset:59392
    v_cvt_pk_bf16_f32 v79, v50, v51
    v_mfma_f32_16x16x32_bf16 v[68:71], a[44:47], a[124:127], v[68:71]
    v_exp_f32 v57, v57
    v_mfma_f32_16x16x32_bf16 v[60:63], a[44:47], a[120:123], v[60:63]
    ds_read_b128 a[24:27], v20 offset:63488
    v_cvt_pk_bf16_f32 v80, v52, v53
    v_add_f32 v101, v101, v57
    v_mfma_f32_16x16x32_bf16 v[60:63], a[40:43], a[112:115], v[60:63]
    v_exp_f32 v58, v58
    v_mfma_f32_16x16x32_bf16 v[60:63], a[36:39], a[104:107], v[60:63]
    ds_read_b128 a[28:31], v21 offset:63488
    v_cvt_pk_bf16_f32 v81, v54, v55
    v_add_f32 v101, v101, v58
    v_mfma_f32_16x16x32_bf16 v[60:63], a[32:35], a[96:99], v[60:63]
    s_waitcnt vmcnt(34) lgkmcnt(4)
    v_exp_f32 v59, v59
    v_mfma_f32_16x16x32_bf16 v[64:67], a[0:3], a[64:67], v[92:95]
    s_barrier
    ds_read_b64_tr_b16 a[32:33], v12 offset:0
    v_add_f32 v101, v101, v59
    v_mfma_f32_16x16x32_bf16 v[64:67], a[4:7], a[72:75], v[64:67]
    ds_read_b64_tr_b16 a[34:35], v12 offset:2048
    s_add_u32 m0, s67, 16384
    v_mfma_f32_16x16x32_bf16 v[64:67], a[8:11], a[80:83], v[64:67]
    ds_read_b64_tr_b16 a[36:37], v13 offset:0
    s_add_u32 s69, s101, 8192
    v_mfma_f32_16x16x32_bf16 v[64:67], a[12:15], a[88:91], v[64:67]
    ds_read_b64_tr_b16 a[38:39], v13 offset:2048
    s_nop 0
    v_mfma_f32_16x16x32_bf16 v[72:75], a[12:15], a[92:95], v[96:99]
    ds_read_b64_tr_b16 a[40:41], v14 offset:0
    v_cvt_pk_bf16_f32 v82, v56, v57
    v_mfma_f32_16x16x32_bf16 v[72:75], a[8:11], a[84:87], v[72:75]
    ds_read_b64_tr_b16 a[42:43], v14 offset:2048
    v_cvt_pk_bf16_f32 v83, v58, v59
    v_mfma_f32_16x16x32_bf16 v[72:75], a[4:7], a[76:79], v[72:75]
    ds_read_b64_tr_b16 a[44:45], v15 offset:0
    s_add_u32 s68, s72, 114688
    v_mfma_f32_16x16x32_bf16 v[72:75], a[0:3], a[68:71], v[72:75]
    ds_read_b64_tr_b16 a[46:47], v15 offset:2048
    s_waitcnt lgkmcnt(8)
    v_mfma_f32_16x16x32_bf16 v[72:75], a[16:19], a[100:103], v[72:75]
    ds_read_b64_tr_b16 a[0:1], v12 offset:4096
    buffer_load_dwordx4 a[204:207], v2, s[56:59], s69 offen offset:0 sc1
    v_mfma_f32_16x16x32_bf16 v[72:75], a[20:23], a[108:111], v[72:75]
    ds_read_b64_tr_b16 a[2:3], v12 offset:6144
    s_nop 0
    v_mfma_f32_16x16x32_bf16 v[72:75], a[24:27], a[116:119], v[72:75]
    ds_read_b64_tr_b16 a[4:5], v13 offset:4096
    v_add_f32 v100, v100, v44
    v_mfma_f32_16x16x32_bf16 v[72:75], a[28:31], a[124:127], v[72:75]
    ds_read_b64_tr_b16 a[6:7], v13 offset:6144
    buffer_load_dwordx4 v32, s[48:51], s68 offen offset:0 sc1 lds
    v_mfma_f32_16x16x32_bf16 v[64:67], a[28:31], a[120:123], v[64:67]
    ds_read_b64_tr_b16 a[8:9], v14 offset:4096
    v_add_f32 v100, v100, v45
    v_mfma_f32_16x16x32_bf16 v[64:67], a[24:27], a[112:115], v[64:67]
    ds_read_b64_tr_b16 a[10:11], v14 offset:6144
    v_add_f32 v100, v100, v46
    v_mfma_f32_16x16x32_bf16 v[64:67], a[20:23], a[104:107], v[64:67]
    ds_read_b64_tr_b16 a[12:13], v15 offset:4096
    v_add_f32 v100, v100, v47
    v_mfma_f32_16x16x32_bf16 v[64:67], a[16:19], a[96:99], v[64:67]
    ds_read_b64_tr_b16 a[14:15], v15 offset:6144
    s_waitcnt lgkmcnt(8)
    v_mfma_f32_16x16x32_bf16 v[128:131], a[32:35], v[76:79], v[128:131]
    ds_read_b64_tr_b16 a[16:17], v12 offset:8192
    buffer_load_dwordx4 v33, s[48:51], s68 offen offset:1024 sc1 lds
    v_mfma_f32_16x16x32_bf16 v[136:139], a[32:35], v[80:83], v[136:139]
    ds_read_b64_tr_b16 a[18:19], v12 offset:10240
    buffer_load_dwordx4 a[220:223], v2, s[56:59], s69 offen offset:2048 sc1
    v_mfma_f32_16x16x32_bf16 v[140:143], a[36:39], v[80:83], v[140:143]
    ds_read_b64_tr_b16 a[20:21], v13 offset:8192
    buffer_load_dword a57, v28, s[60:63], s71 offen
    v_mfma_f32_16x16x32_bf16 v[132:135], a[36:39], v[76:79], v[132:135]
    ds_read_b64_tr_b16 a[22:23], v13 offset:10240
    v_add_f32 v100, v100, v48
    v_mfma_f32_16x16x32_bf16 v[144:147], a[40:43], v[76:79], v[144:147]
    ds_read_b64_tr_b16 a[24:25], v14 offset:8192
    v_add_f32 v100, v100, v49
    v_mfma_f32_16x16x32_bf16 v[152:155], a[40:43], v[80:83], v[152:155]
    ds_read_b64_tr_b16 a[26:27], v14 offset:10240
    buffer_load_dwordx4 v34, s[48:51], s68 offen offset:2048 sc1 lds
    v_mfma_f32_16x16x32_bf16 v[156:159], a[44:47], v[80:83], v[156:159]
    ds_read_b64_tr_b16 a[28:29], v15 offset:8192
    v_add_f32 v100, v100, v50
    v_mfma_f32_16x16x32_bf16 v[148:151], a[44:47], v[76:79], v[148:151]
    ds_read_b64_tr_b16 a[30:31], v15 offset:10240
    s_waitcnt lgkmcnt(8)
    v_mfma_f32_16x16x32_bf16 v[160:163], a[0:3], v[76:79], v[160:163]
    ds_read_b64_tr_b16 a[32:33], v12 offset:12288
    v_add_f32 v100, v100, v51
    v_mfma_f32_16x16x32_bf16 v[168:171], a[0:3], v[80:83], v[168:171]
    ds_read_b64_tr_b16 a[34:35], v12 offset:14336
    v_add_f32 v101, v101, v52
    v_mfma_f32_16x16x32_bf16 v[172:175], a[4:7], v[80:83], v[172:175]
    ds_read_b64_tr_b16 a[36:37], v13 offset:12288
    buffer_load_dwordx4 v35, s[48:51], s68 offen offset:3072 sc1 lds
    v_mfma_f32_16x16x32_bf16 v[164:167], a[4:7], v[76:79], v[164:167]
    ds_read_b64_tr_b16 a[38:39], v13 offset:14336
    s_add_u32 m0, s67, 32768
    v_mfma_f32_16x16x32_bf16 v[176:179], a[8:11], v[76:79], v[176:179]
    ds_read_b64_tr_b16 a[40:41], v14 offset:12288
    s_add_u32 s69, s98, 12288
    v_mfma_f32_16x16x32_bf16 v[184:187], a[8:11], v[80:83], v[184:187]
    ds_read_b64_tr_b16 a[42:43], v14 offset:14336
    v_add_f32 v101, v101, v53
    v_mfma_f32_16x16x32_bf16 v[188:191], a[12:15], v[80:83], v[188:191]
    ds_read_b64_tr_b16 a[44:45], v15 offset:12288
    buffer_load_dwordx4 v32, s[48:51], s73 offen offset:0 sc1 lds
    v_mfma_f32_16x16x32_bf16 v[180:183], a[12:15], v[76:79], v[180:183]
    ds_read_b64_tr_b16 a[46:47], v15 offset:14336
    s_waitcnt lgkmcnt(8)
    v_mfma_f32_16x16x32_bf16 v[192:195], a[16:19], v[76:79], v[192:195]
    ds_read_b128 a[0:3], v22 offset:16384
    v_add_f32 v101, v101, v54
    v_mfma_f32_16x16x32_bf16 v[200:203], a[16:19], v[80:83], v[200:203]
    v_exp_f32 v60, v60
    v_mfma_f32_16x16x32_bf16 v[204:207], a[20:23], v[80:83], v[204:207]
    ds_read_b128 a[4:7], v23 offset:16384
    buffer_load_dwordx4 v33, s[48:51], s73 offen offset:1024 sc1 lds
    v_mfma_f32_16x16x32_bf16 v[196:199], a[20:23], v[76:79], v[196:199]
    buffer_load_dwordx4 a[224:227], v2, s[56:59], s69 offen offset:0 sc1
    v_exp_f32 v61, v61
    v_mfma_f32_16x16x32_bf16 v[208:211], a[24:27], v[76:79], v[208:211]
    ds_read_b128 a[8:11], v22 offset:20480
    v_add_f32 v101, v101, v55
    v_mfma_f32_16x16x32_bf16 v[216:219], a[24:27], v[80:83], v[216:219]
    v_exp_f32 v62, v62
    v_mfma_f32_16x16x32_bf16 v[220:223], a[28:31], v[80:83], v[220:223]
    ds_read_b128 a[12:15], v23 offset:20480
    buffer_load_dwordx4 v34, s[48:51], s73 offen offset:2048 sc1 lds
    v_mfma_f32_16x16x32_bf16 v[212:215], a[28:31], v[76:79], v[212:215]
    s_waitcnt lgkmcnt(4)
    v_exp_f32 v63, v63
    v_mfma_f32_16x16x32_bf16 v[224:227], a[32:35], v[76:79], v[224:227]
    ds_read_b128 a[16:19], v22 offset:24576
    v_add_f32 v101, v101, v56
    v_mfma_f32_16x16x32_bf16 v[232:235], a[32:35], v[80:83], v[232:235]
    v_exp_f32 v64, v64
    v_mfma_f32_16x16x32_bf16 v[236:239], a[36:39], v[80:83], v[236:239]
    ds_read_b128 a[20:23], v23 offset:24576
    buffer_load_dwordx4 v35, s[48:51], s73 offen offset:3072 sc1 lds
    v_mfma_f32_16x16x32_bf16 v[228:231], a[36:39], v[76:79], v[228:231]
    v_exp_f32 v65, v65
    v_mfma_f32_16x16x32_bf16 v[240:243], a[40:43], v[76:79], v[240:243]
    ds_read_b128 a[24:27], v22 offset:28672
    buffer_load_dwordx4 a[240:243], v2, s[56:59], s69 offen offset:2048 sc1
    v_mfma_f32_16x16x32_bf16 v[248:251], a[40:43], v[80:83], v[248:251]
    s_add_u32 s93, s93, 57344
    v_exp_f32 v66, v66
    v_mfma_f32_16x16x32_bf16 v[252:255], a[44:47], v[80:83], v[252:255]
    ds_read_b128 a[28:31], v23 offset:28672
    s_sub_u32 s92, s93, 401408
    v_mfma_f32_16x16x32_bf16 v[244:247], a[44:47], v[76:79], v[244:247]
    s_waitcnt lgkmcnt(4)
    v_exp_f32 v67, v67
    v_mfma_f32_16x16x32_bf16 v[44:47], a[0:3], a[64:67], v[92:95]
    ds_read_b128 a[32:35], v22 offset:18432
    s_min_u32 s93, s93, s92
    v_mfma_f32_16x16x32_bf16 v[44:47], a[4:7], a[72:75], v[44:47]
    buffer_load_dword a63, v27, s[52:55], s93 offen
    v_exp_f32 v68, v68
    v_mfma_f32_16x16x32_bf16 v[44:47], a[8:11], a[80:83], v[44:47]
    ds_read_b128 a[36:39], v23 offset:18432
    v_cvt_pk_bf16_f32 v84, v60, v61
    v_mfma_f32_16x16x32_bf16 v[44:47], a[12:15], a[88:91], v[44:47]
    v_exp_f32 v69, v69
    v_mfma_f32_16x16x32_bf16 v[52:55], a[12:15], a[92:95], v[96:99]
    ds_read_b128 a[40:43], v22 offset:22528
    v_cvt_pk_bf16_f32 v85, v62, v63
    v_mfma_f32_16x16x32_bf16 v[52:55], a[8:11], a[84:87], v[52:55]
    s_add_u32 s69, s99, 12288
    v_exp_f32 v70, v70
    v_mfma_f32_16x16x32_bf16 v[52:55], a[4:7], a[76:79], v[52:55]
    ds_read_b128 a[44:47], v23 offset:22528
    v_cvt_pk_bf16_f32 v86, v64, v65
    v_mfma_f32_16x16x32_bf16 v[52:55], a[0:3], a[68:71], v[52:55]
    s_waitcnt lgkmcnt(4)
    v_exp_f32 v71, v71
    v_mfma_f32_16x16x32_bf16 v[52:55], a[16:19], a[100:103], v[52:55]
    ds_read_b128 a[0:3], v22 offset:26624
    v_cvt_pk_bf16_f32 v87, v66, v67
    v_mfma_f32_16x16x32_bf16 v[52:55], a[20:23], a[108:111], v[52:55]
    v_exp_f32 v72, v72
    v_mfma_f32_16x16x32_bf16 v[52:55], a[24:27], a[116:119], v[52:55]
    ds_read_b128 a[4:7], v23 offset:26624
    v_cvt_pk_bf16_f32 v88, v68, v69
    v_mfma_f32_16x16x32_bf16 v[52:55], a[28:31], a[124:127], v[52:55]
    v_exp_f32 v73, v73
    v_mfma_f32_16x16x32_bf16 v[44:47], a[28:31], a[120:123], v[44:47]
    ds_read_b128 a[8:11], v22 offset:30720
    v_cvt_pk_bf16_f32 v89, v70, v71
    v_mfma_f32_16x16x32_bf16 v[44:47], a[24:27], a[112:115], v[44:47]
    v_exp_f32 v74, v74
    v_mfma_f32_16x16x32_bf16 v[44:47], a[20:23], a[104:107], v[44:47]
    ds_read_b128 a[12:15], v23 offset:30720
    v_cvt_pk_bf16_f32 v90, v72, v73
    v_mfma_f32_16x16x32_bf16 v[44:47], a[16:19], a[96:99], v[44:47]
    s_waitcnt vmcnt(35) lgkmcnt(4)
    v_exp_f32 v75, v75
    v_mfma_f32_16x16x32_bf16 v[48:51], a[32:35], a[64:67], v[92:95]
    s_barrier
    ds_read_b64_tr_b16 a[16:17], v12 offset:32768
    v_mfma_f32_16x16x32_bf16 v[48:51], a[36:39], a[72:75], v[48:51]
    ds_read_b64_tr_b16 a[18:19], v12 offset:34816
    s_add_u32 m0, s67, 49152
    v_mfma_f32_16x16x32_bf16 v[48:51], a[40:43], a[80:83], v[48:51]
    ds_read_b64_tr_b16 a[20:21], v13 offset:32768
    buffer_load_dwordx4 a[228:231], v2, s[56:59], s69 offen offset:0 sc1
    v_mfma_f32_16x16x32_bf16 v[48:51], a[44:47], a[88:91], v[48:51]
    ds_read_b64_tr_b16 a[22:23], v13 offset:34816
    v_cvt_pk_bf16_f32 v91, v74, v75
    v_mfma_f32_16x16x32_bf16 v[56:59], a[44:47], a[92:95], v[96:99]
    ds_read_b64_tr_b16 a[24:25], v14 offset:32768
    v_add_f32 v100, v100, v60
    v_mfma_f32_16x16x32_bf16 v[56:59], a[40:43], a[84:87], v[56:59]
    ds_read_b64_tr_b16 a[26:27], v14 offset:34816
    v_add_f32 v100, v100, v61
    v_mfma_f32_16x16x32_bf16 v[56:59], a[36:39], a[76:79], v[56:59]
    ds_read_b64_tr_b16 a[28:29], v15 offset:32768
    s_add_u32 s68, s73, 114688
    v_mfma_f32_16x16x32_bf16 v[56:59], a[32:35], a[68:71], v[56:59]
    ds_read_b64_tr_b16 a[30:31], v15 offset:34816
    s_waitcnt lgkmcnt(8)
    v_mfma_f32_16x16x32_bf16 v[56:59], a[0:3], a[100:103], v[56:59]
    ds_read_b64_tr_b16 a[32:33], v12 offset:36864
    buffer_load_dwordx4 a[244:247], v2, s[56:59], s69 offen offset:2048 sc1
    v_mfma_f32_16x16x32_bf16 v[56:59], a[4:7], a[108:111], v[56:59]
    ds_read_b64_tr_b16 a[34:35], v12 offset:38912
    v_add_f32 v100, v100, v62
    v_mfma_f32_16x16x32_bf16 v[56:59], a[8:11], a[116:119], v[56:59]
    ds_read_b64_tr_b16 a[36:37], v13 offset:36864
    v_add_f32 v100, v100, v63
    v_mfma_f32_16x16x32_bf16 v[56:59], a[12:15], a[124:127], v[56:59]
    ds_read_b64_tr_b16 a[38:39], v13 offset:38912
    buffer_load_dwordx4 v32, s[48:51], s68 offen offset:0 sc1 lds
    v_mfma_f32_16x16x32_bf16 v[48:51], a[12:15], a[120:123], v[48:51]
    ds_read_b64_tr_b16 a[40:41], v14 offset:36864
    v_add_f32 v100, v100, v64
    v_mfma_f32_16x16x32_bf16 v[48:51], a[8:11], a[112:115], v[48:51]
    ds_read_b64_tr_b16 a[42:43], v14 offset:38912
    v_add_f32 v100, v100, v65
    v_mfma_f32_16x16x32_bf16 v[48:51], a[4:7], a[104:107], v[48:51]
    ds_read_b64_tr_b16 a[44:45], v15 offset:36864
    v_add_f32 v100, v100, v66
    v_mfma_f32_16x16x32_bf16 v[48:51], a[0:3], a[96:99], v[48:51]
    ds_read_b64_tr_b16 a[46:47], v15 offset:38912
    s_waitcnt lgkmcnt(8)
    v_mfma_f32_16x16x32_bf16 v[128:131], a[16:19], v[84:87], v[128:131]
    ds_read_b64_tr_b16 a[0:1], v12 offset:40960
    buffer_load_dwordx4 v33, s[48:51], s68 offen offset:1024 sc1 lds
    v_mfma_f32_16x16x32_bf16 v[136:139], a[16:19], v[88:91], v[136:139]
    ds_read_b64_tr_b16 a[2:3], v12 offset:43008
    s_add_u32 s69, s100, 12288
    v_mfma_f32_16x16x32_bf16 v[140:143], a[20:23], v[88:91], v[140:143]
    ds_read_b64_tr_b16 a[4:5], v13 offset:40960
    v_add_f32 v100, v100, v67
    v_mfma_f32_16x16x32_bf16 v[132:135], a[20:23], v[84:87], v[132:135]
    ds_read_b64_tr_b16 a[6:7], v13 offset:43008
    v_add_f32 v101, v101, v68
    v_mfma_f32_16x16x32_bf16 v[144:147], a[24:27], v[84:87], v[144:147]
    ds_read_b64_tr_b16 a[8:9], v14 offset:40960
    v_add_f32 v101, v101, v69
    v_mfma_f32_16x16x32_bf16 v[152:155], a[24:27], v[88:91], v[152:155]
    ds_read_b64_tr_b16 a[10:11], v14 offset:43008
    buffer_load_dwordx4 v34, s[48:51], s68 offen offset:2048 sc1 lds
    v_mfma_f32_16x16x32_bf16 v[156:159], a[28:31], v[88:91], v[156:159]
    ds_read_b64_tr_b16 a[12:13], v15 offset:40960
    v_add_f32 v101, v101, v70
    v_mfma_f32_16x16x32_bf16 v[148:151], a[28:31], v[84:87], v[148:151]
    ds_read_b64_tr_b16 a[14:15], v15 offset:43008
    s_waitcnt lgkmcnt(8)
    v_mfma_f32_16x16x32_bf16 v[160:163], a[32:35], v[84:87], v[160:163]
    ds_read_b64_tr_b16 a[16:17], v12 offset:45056
    v_add_f32 v101, v101, v71
    v_mfma_f32_16x16x32_bf16 v[168:171], a[32:35], v[88:91], v[168:171]
    ds_read_b64_tr_b16 a[18:19], v12 offset:47104
    v_add_f32 v101, v101, v72
    v_mfma_f32_16x16x32_bf16 v[172:175], a[36:39], v[88:91], v[172:175]
    ds_read_b64_tr_b16 a[20:21], v13 offset:45056
    buffer_load_dwordx4 v35, s[48:51], s68 offen offset:3072 sc1 lds
    v_mfma_f32_16x16x32_bf16 v[164:167], a[36:39], v[84:87], v[164:167]
    ds_read_b64_tr_b16 a[22:23], v13 offset:47104
    s_add_u32 m0, s67, 65536
    v_mfma_f32_16x16x32_bf16 v[176:179], a[40:43], v[84:87], v[176:179]
    ds_read_b64_tr_b16 a[24:25], v14 offset:45056
    buffer_load_dwordx4 a[232:235], v2, s[56:59], s69 offen offset:0 sc1
    v_mfma_f32_16x16x32_bf16 v[184:187], a[40:43], v[88:91], v[184:187]
    ds_read_b64_tr_b16 a[26:27], v14 offset:47104
    v_add_f32 v101, v101, v73
    v_mfma_f32_16x16x32_bf16 v[188:191], a[44:47], v[88:91], v[188:191]
    ds_read_b64_tr_b16 a[28:29], v15 offset:45056
    buffer_load_dwordx4 v32, s[48:51], s74 offen offset:0 sc1 lds
    v_mfma_f32_16x16x32_bf16 v[180:183], a[44:47], v[84:87], v[180:183]
    ds_read_b64_tr_b16 a[30:31], v15 offset:47104
    s_waitcnt lgkmcnt(8)
    v_mfma_f32_16x16x32_bf16 v[192:195], a[0:3], v[84:87], v[192:195]
    ds_read_b128 a[32:35], v22 offset:49152
    v_add_f32 v101, v101, v74
    v_mfma_f32_16x16x32_bf16 v[200:203], a[0:3], v[88:91], v[200:203]
    v_exp_f32 v44, v44
    v_mfma_f32_16x16x32_bf16 v[204:207], a[4:7], v[88:91], v[204:207]
    ds_read_b128 a[36:39], v23 offset:49152
    buffer_load_dwordx4 v33, s[48:51], s74 offen offset:1024 sc1 lds
    v_mfma_f32_16x16x32_bf16 v[196:199], a[4:7], v[84:87], v[196:199]
    buffer_load_dwordx4 a[248:251], v2, s[56:59], s69 offen offset:2048 sc1
    v_exp_f32 v45, v45
    v_mfma_f32_16x16x32_bf16 v[208:211], a[8:11], v[84:87], v[208:211]
    ds_read_b128 a[40:43], v22 offset:53248
    v_add_f32 v101, v101, v75
    v_mfma_f32_16x16x32_bf16 v[216:219], a[8:11], v[88:91], v[216:219]
    v_exp_f32 v46, v46
    v_mfma_f32_16x16x32_bf16 v[220:223], a[12:15], v[88:91], v[220:223]
    ds_read_b128 a[44:47], v23 offset:53248
    buffer_load_dwordx4 v34, s[48:51], s74 offen offset:2048 sc1 lds
    v_mfma_f32_16x16x32_bf16 v[212:215], a[12:15], v[84:87], v[212:215]
    s_waitcnt lgkmcnt(4)
    v_exp_f32 v47, v47
    v_mfma_f32_16x16x32_bf16 v[224:227], a[16:19], v[84:87], v[224:227]
    ds_read_b128 a[0:3], v22 offset:57344
    v_cvt_pk_bf16_f32 v76, v44, v45
    v_mfma_f32_16x16x32_bf16 v[232:235], a[16:19], v[88:91], v[232:235]
    v_exp_f32 v48, v48
    v_mfma_f32_16x16x32_bf16 v[236:239], a[20:23], v[88:91], v[236:239]
    ds_read_b128 a[4:7], v23 offset:57344
    buffer_load_dwordx4 v35, s[48:51], s74 offen offset:3072 sc1 lds
    v_mfma_f32_16x16x32_bf16 v[228:231], a[20:23], v[84:87], v[228:231]
    v_exp_f32 v49, v49
    v_mfma_f32_16x16x32_bf16 v[240:243], a[24:27], v[84:87], v[240:243]
    ds_read_b128 a[8:11], v22 offset:61440
    s_add_u32 s69, s101, 12288
    v_mfma_f32_16x16x32_bf16 v[248:251], a[24:27], v[88:91], v[248:251]
    v_exp_f32 v50, v50
    v_mfma_f32_16x16x32_bf16 v[252:255], a[28:31], v[88:91], v[252:255]
    ds_read_b128 a[12:15], v23 offset:61440
    v_cvt_pk_bf16_f32 v77, v46, v47
    v_mfma_f32_16x16x32_bf16 v[244:247], a[28:31], v[84:87], v[244:247]
    s_waitcnt lgkmcnt(4)
    v_exp_f32 v51, v51
    v_mfma_f32_16x16x32_bf16 v[60:63], a[32:35], a[64:67], v[92:95]
    ds_read_b128 a[16:19], v22 offset:51200
    v_cvt_pk_bf16_f32 v78, v48, v49
L_pg8:
    s_cbranch_execz L_main
    v_mfma_f32_16x16x32_bf16 v[60:63], a[36:39], a[72:75], v[60:63]
    v_exp_f32 v52, v52
    v_mfma_f32_16x16x32_bf16 v[60:63], a[40:43], a[80:83], v[60:63]
    ds_read_b128 a[20:23], v23 offset:51200
    v_cvt_pk_bf16_f32 v79, v50, v51
    v_mfma_f32_16x16x32_bf16 v[60:63], a[44:47], a[88:91], v[60:63]
    v_exp_f32 v53, v53
    v_mfma_f32_16x16x32_bf16 v[68:71], a[44:47], a[92:95], v[96:99]
    ds_read_b128 a[24:27], v22 offset:55296
    v_cvt_pk_bf16_f32 v80, v52, v53
    v_mfma_f32_16x16x32_bf16 v[68:71], a[40:43], a[84:87], v[68:71]
    buffer_load_dwordx4 a[236:239], v2, s[56:59], s69 offen offset:0 sc1
    v_exp_f32 v54, v54
    v_mfma_f32_16x16x32_bf16 v[68:71], a[36:39], a[76:79], v[68:71]
    ds_read_b128 a[28:31], v23 offset:55296
    v_add_f32 v100, v100, v44
    v_mfma_f32_16x16x32_bf16 v[68:71], a[32:35], a[68:71], v[68:71]
    s_waitcnt lgkmcnt(4)
    v_exp_f32 v55, v55
    v_mfma_f32_16x16x32_bf16 v[68:71], a[0:3], a[100:103], v[68:71]
    ds_read_b128 a[32:35], v22 offset:59392
    v_cvt_pk_bf16_f32 v81, v54, v55
    v_mfma_f32_16x16x32_bf16 v[68:71], a[4:7], a[108:111], v[68:71]
    v_exp_f32 v56, v56
    v_mfma_f32_16x16x32_bf16 v[68:71], a[8:11], a[116:119], v[68:71]
    ds_read_b128 a[36:39], v23 offset:59392
    v_add_f32 v100, v100, v45
    v_mfma_f32_16x16x32_bf16 v[68:71], a[12:15], a[124:127], v[68:71]
    v_exp_f32 v57, v57
    v_mfma_f32_16x16x32_bf16 v[60:63], a[12:15], a[120:123], v[60:63]
    ds_read_b128 a[40:43], v22 offset:63488
    v_cvt_pk_bf16_f32 v82, v56, v57
    v_mfma_f32_16x16x32_bf16 v[60:63], a[8:11], a[112:115], v[60:63]
    v_exp_f32 v58, v58
    v_mfma_f32_16x16x32_bf16 v[60:63], a[4:7], a[104:107], v[60:63]
    ds_read_b128 a[44:47], v23 offset:63488
    buffer_load_dwordx4 a[252:255], v2, s[56:59], s69 offen offset:2048 sc1
    v_mfma_f32_16x16x32_bf16 v[60:63], a[0:3], a[96:99], v[60:63]
    s_waitcnt vmcnt(35) lgkmcnt(4)
    v_exp_f32 v59, v59
    v_mfma_f32_16x16x32_bf16 v[64:67], a[16:19], a[64:67], v[92:95]
    s_barrier
    ds_read_b64_tr_b16 a[0:1], v16 offset:0
    v_mfma_f32_16x16x32_bf16 v[64:67], a[20:23], a[72:75], v[64:67]
    ds_read_b64_tr_b16 a[2:3], v16 offset:2048
    s_add_u32 m0, s67, 81920
    v_mfma_f32_16x16x32_bf16 v[64:67], a[24:27], a[80:83], v[64:67]
    ds_read_b64_tr_b16 a[4:5], v17 offset:0
    v_cvt_pk_bf16_f32 v83, v58, v59
    v_mfma_f32_16x16x32_bf16 v[64:67], a[28:31], a[88:91], v[64:67]
    ds_read_b64_tr_b16 a[6:7], v17 offset:2048
    v_add_f32 v100, v100, v46
    v_mfma_f32_16x16x32_bf16 v[72:75], a[28:31], a[92:95], v[96:99]
    ds_read_b64_tr_b16 a[8:9], v18 offset:0
    v_add_f32 v100, v100, v47
    v_mfma_f32_16x16x32_bf16 v[72:75], a[24:27], a[84:87], v[72:75]
    ds_read_b64_tr_b16 a[10:11], v18 offset:2048
    v_add_f32 v100, v100, v48
    v_mfma_f32_16x16x32_bf16 v[72:75], a[20:23], a[76:79], v[72:75]
    ds_read_b64_tr_b16 a[12:13], v19 offset:0
    s_add_u32 s68, s74, 114688
    v_mfma_f32_16x16x32_bf16 v[72:75], a[16:19], a[68:71], v[72:75]
    ds_read_b64_tr_b16 a[14:15], v19 offset:2048
    s_waitcnt lgkmcnt(8)
    v_mfma_f32_16x16x32_bf16 v[72:75], a[32:35], a[100:103], v[72:75]
    ds_read_b64_tr_b16 a[16:17], v16 offset:4096
    v_add_f32 v100, v100, v49
    v_mfma_f32_16x16x32_bf16 v[72:75], a[36:39], a[108:111], v[72:75]
    ds_read_b64_tr_b16 a[18:19], v16 offset:6144
    v_add_f32 v100, v100, v50
    v_mfma_f32_16x16x32_bf16 v[72:75], a[40:43], a[116:119], v[72:75]
    ds_read_b64_tr_b16 a[20:21], v17 offset:4096
    v_add_f32 v100, v100, v51
    v_mfma_f32_16x16x32_bf16 v[72:75], a[44:47], a[124:127], v[72:75]
    ds_read_b64_tr_b16 a[22:23], v17 offset:6144
    buffer_load_dwordx4 v32, s[48:51], s68 offen offset:0 sc1 lds
    v_mfma_f32_16x16x32_bf16 v[64:67], a[44:47], a[120:123], v[64:67]
    ds_read_b64_tr_b16 a[24:25], v18 offset:4096
    v_add_f32 v101, v101, v52
    v_mfma_f32_16x16x32_bf16 v[64:67], a[40:43], a[112:115], v[64:67]
    ds_read_b64_tr_b16 a[26:27], v18 offset:6144
    v_add_f32 v101, v101, v53
    v_mfma_f32_16x16x32_bf16 v[64:67], a[36:39], a[104:107], v[64:67]
    ds_read_b64_tr_b16 a[28:29], v19 offset:4096
    v_add_f32 v101, v101, v54
    v_mfma_f32_16x16x32_bf16 v[64:67], a[32:35], a[96:99], v[64:67]
    ds_read_b64_tr_b16 a[30:31], v19 offset:6144
    s_waitcnt lgkmcnt(8)
    v_mfma_f32_16x16x32_bf16 v[128:131], a[0:3], v[76:79], v[128:131]
    ds_read_b64_tr_b16 a[32:33], v16 offset:8192
    buffer_load_dwordx4 v33, s[48:51], s68 offen offset:1024 sc1 lds
    v_mfma_f32_16x16x32_bf16 v[136:139], a[0:3], v[80:83], v[136:139]
    ds_read_b64_tr_b16 a[34:35], v16 offset:10240
    v_add_f32 v101, v101, v55
    v_mfma_f32_16x16x32_bf16 v[140:143], a[4:7], v[80:83], v[140:143]
    ds_read_b64_tr_b16 a[36:37], v17 offset:8192
    v_add_f32 v101, v101, v56
    v_mfma_f32_16x16x32_bf16 v[132:135], a[4:7], v[76:79], v[132:135]
    ds_read_b64_tr_b16 a[38:39], v17 offset:10240
    v_add_f32 v101, v101, v57
    v_mfma_f32_16x16x32_bf16 v[144:147], a[8:11], v[76:79], v[144:147]
    ds_read_b64_tr_b16 a[40:41], v18 offset:8192
    v_add_f32 v101, v101, v58
    v_exp_f32 v60, v60
    v_exp_f32 v61, v61
    v_exp_f32 v62, v62
    v_exp_f32 v63, v63
    v_mfma_f32_16x16x32_bf16 v[152:155], a[8:11], v[80:83], v[152:155]
    ds_read_b64_tr_b16 a[42:43], v18 offset:10240
    buffer_load_dwordx4 v34, s[48:51], s68 offen offset:2048 sc1 lds
    v_mfma_f32_16x16x32_bf16 v[156:159], a[12:15], v[80:83], v[156:159]
    ds_read_b64_tr_b16 a[44:45], v19 offset:8192
    v_add_f32 v101, v101, v59
    v_mfma_f32_16x16x32_bf16 v[148:151], a[12:15], v[76:79], v[148:151]
    ds_read_b64_tr_b16 a[46:47], v19 offset:10240
    s_waitcnt lgkmcnt(8)
    v_mfma_f32_16x16x32_bf16 v[160:163], a[16:19], v[76:79], v[160:163]
    ds_read_b64_tr_b16 a[0:1], v16 offset:12288
    v_cvt_pk_bf16_f32 v84, v60, v61
    v_mfma_f32_16x16x32_bf16 v[168:171], a[16:19], v[80:83], v[168:171]
    ds_read_b64_tr_b16 a[2:3], v16 offset:14336
    v_exp_f32 v64, v64
    v_exp_f32 v65, v65
    v_cvt_pk_bf16_f32 v85, v62, v63
    v_mfma_f32_16x16x32_bf16 v[172:175], a[20:23], v[80:83], v[172:175]
    ds_read_b64_tr_b16 a[4:5], v17 offset:12288
    buffer_load_dwordx4 v35, s[48:51], s68 offen offset:3072 sc1 lds
    v_mfma_f32_16x16x32_bf16 v[164:167], a[20:23], v[76:79], v[164:167]
    ds_read_b64_tr_b16 a[6:7], v17 offset:14336
    s_add_u32 m0, s67, 98304
    v_mfma_f32_16x16x32_bf16 v[176:179], a[24:27], v[76:79], v[176:179]
    ds_read_b64_tr_b16 a[8:9], v18 offset:12288
    v_exp_f32 v66, v66
    v_mfma_f32_16x16x32_bf16 v[184:187], a[24:27], v[80:83], v[184:187]
    ds_read_b64_tr_b16 a[10:11], v18 offset:14336
    v_exp_f32 v67, v67
    v_cvt_pk_bf16_f32 v86, v64, v65
    v_mfma_f32_16x16x32_bf16 v[188:191], a[28:31], v[80:83], v[188:191]
    ds_read_b64_tr_b16 a[12:13], v19 offset:12288
    buffer_load_dwordx4 v32, s[48:51], s75 offen offset:0 sc1 lds
    v_mfma_f32_16x16x32_bf16 v[180:183], a[28:31], v[76:79], v[180:183]
    ds_read_b64_tr_b16 a[14:15], v19 offset:14336
    s_waitcnt lgkmcnt(8)
    v_mfma_f32_16x16x32_bf16 v[192:195], a[32:35], v[76:79], v[192:195]
    ds_read_b64_tr_b16 a[16:17], v16 offset:16384
    v_exp_f32 v68, v68
    v_mfma_f32_16x16x32_bf16 v[200:203], a[32:35], v[80:83], v[200:203]
    ds_read_b64_tr_b16 a[18:19], v16 offset:18432
    v_exp_f32 v69, v69
    v_cvt_pk_bf16_f32 v87, v66, v67
    v_mfma_f32_16x16x32_bf16 v[204:207], a[36:39], v[80:83], v[204:207]
    ds_read_b64_tr_b16 a[20:21], v17 offset:16384
    buffer_load_dwordx4 v33, s[48:51], s75 offen offset:1024 sc1 lds
    v_mfma_f32_16x16x32_bf16 v[196:199], a[36:39], v[76:79], v[196:199]
    ds_read_b64_tr_b16 a[22:23], v17 offset:18432
    v_exp_f32 v70, v70
    v_mfma_f32_16x16x32_bf16 v[208:211], a[40:43], v[76:79], v[208:211]
    ds_read_b64_tr_b16 a[24:25], v18 offset:16384
    v_exp_f32 v71, v71
    v_mfma_f32_16x16x32_bf16 v[216:219], a[40:43], v[80:83], v[216:219]
    ds_read_b64_tr_b16 a[26:27], v18 offset:18432
    v_cvt_pk_bf16_f32 v88, v68, v69
    v_exp_f32 v72, v72
    v_exp_f32 v73, v73
    v_mfma_f32_16x16x32_bf16 v[220:223], a[44:47], v[80:83], v[220:223]
    ds_read_b64_tr_b16 a[28:29], v19 offset:16384
    buffer_load_dwordx4 v34, s[48:51], s75 offen offset:2048 sc1 lds
    v_mfma_f32_16x16x32_bf16 v[212:215], a[44:47], v[76:79], v[212:215]
    ds_read_b64_tr_b16 a[30:31], v19 offset:18432
    s_waitcnt lgkmcnt(8)
    v_mfma_f32_16x16x32_bf16 v[224:227], a[0:3], v[76:79], v[224:227]
    ds_read_b64_tr_b16 a[32:33], v16 offset:20480
    v_cvt_pk_bf16_f32 v89, v70, v71
    v_mfma_f32_16x16x32_bf16 v[232:235], a[0:3], v[80:83], v[232:235]
    ds_read_b64_tr_b16 a[34:35], v16 offset:22528
    v_exp_f32 v74, v74
    v_exp_f32 v75, v75
    v_mfma_f32_16x16x32_bf16 v[236:239], a[4:7], v[80:83], v[236:239]
    ds_read_b64_tr_b16 a[36:37], v17 offset:20480
    buffer_load_dwordx4 v35, s[48:51], s75 offen offset:3072 sc1 lds
    v_mfma_f32_16x16x32_bf16 v[228:231], a[4:7], v[76:79], v[228:231]
    ds_read_b64_tr_b16 a[38:39], v17 offset:22528
    v_cvt_pk_bf16_f32 v90, v72, v73
    v_mfma_f32_16x16x32_bf16 v[240:243], a[8:11], v[76:79], v[240:243]
    ds_read_b64_tr_b16 a[40:41], v18 offset:20480
    v_cvt_pk_bf16_f32 v91, v74, v75
    v_add_f32 v100, v100, v60
    v_mfma_f32_16x16x32_bf16 v[248:251], a[8:11], v[80:83], v[248:251]
    ds_read_b64_tr_b16 a[42:43], v18 offset:22528
    v_add_f32 v101, v101, v68
    v_mfma_f32_16x16x32_bf16 v[252:255], a[12:15], v[80:83], v[252:255]
    ds_read_b64_tr_b16 a[44:45], v19 offset:20480
    v_add_f32 v100, v100, v61
    v_add_f32 v101, v101, v69
    v_mfma_f32_16x16x32_bf16 v[244:247], a[12:15], v[76:79], v[244:247]
    ds_read_b64_tr_b16 a[46:47], v19 offset:22528
    s_waitcnt lgkmcnt(8)
    v_mfma_f32_16x16x32_bf16 v[128:131], a[16:19], v[84:87], v[128:131]
    ds_read_b64_tr_b16 a[0:1], v16 offset:24576
    v_add_f32 v100, v100, v62
    v_mfma_f32_16x16x32_bf16 v[136:139], a[16:19], v[88:91], v[136:139]
    ds_read_b64_tr_b16 a[2:3], v16 offset:26624
    v_add_f32 v101, v101, v70
    v_mfma_f32_16x16x32_bf16 v[140:143], a[20:23], v[88:91], v[140:143]
    ds_read_b64_tr_b16 a[4:5], v17 offset:24576
    v_add_f32 v100, v100, v63
    v_mfma_f32_16x16x32_bf16 v[132:135], a[20:23], v[84:87], v[132:135]
    ds_read_b64_tr_b16 a[6:7], v17 offset:26624
    v_add_f32 v101, v101, v71
    v_mfma_f32_16x16x32_bf16 v[144:147], a[24:27], v[84:87], v[144:147]
    ds_read_b64_tr_b16 a[8:9], v18 offset:24576
    v_add_f32 v100, v100, v64
    v_mfma_f32_16x16x32_bf16 v[152:155], a[24:27], v[88:91], v[152:155]
    ds_read_b64_tr_b16 a[10:11], v18 offset:26624
    v_add_f32 v101, v101, v72
    v_mfma_f32_16x16x32_bf16 v[156:159], a[28:31], v[88:91], v[156:159]
    ds_read_b64_tr_b16 a[12:13], v19 offset:24576
    v_add_f32 v100, v100, v65
    v_mfma_f32_16x16x32_bf16 v[148:151], a[28:31], v[84:87], v[148:151]
    ds_read_b64_tr_b16 a[14:15], v19 offset:26624
    s_waitcnt lgkmcnt(8)
    v_mfma_f32_16x16x32_bf16 v[160:163], a[32:35], v[84:87], v[160:163]
    ds_read_b64_tr_b16 a[16:17], v16 offset:28672
    v_add_f32 v101, v101, v73
    v_mfma_f32_16x16x32_bf16 v[168:171], a[32:35], v[88:91], v[168:171]
    ds_read_b64_tr_b16 a[18:19], v16 offset:30720
    v_add_f32 v100, v100, v66
    v_mfma_f32_16x16x32_bf16 v[172:175], a[36:39], v[88:91], v[172:175]
    ds_read_b64_tr_b16 a[20:21], v17 offset:28672
    v_add_f32 v101, v101, v74
    v_mfma_f32_16x16x32_bf16 v[164:167], a[36:39], v[84:87], v[164:167]
    ds_read_b64_tr_b16 a[22:23], v17 offset:30720
    v_add_f32 v100, v100, v67
    v_mfma_f32_16x16x32_bf16 v[176:179], a[40:43], v[84:87], v[176:179]
    ds_read_b64_tr_b16 a[24:25], v18 offset:28672
    v_add_f32 v101, v101, v75
    v_mov_b32 v106, v100
    v_mfma_f32_16x16x32_bf16 v[184:187], a[40:43], v[88:91], v[184:187]
    ds_read_b64_tr_b16 a[26:27], v18 offset:30720
    v_mov_b32 v107, v101
    v_mfma_f32_16x16x32_bf16 v[188:191], a[44:47], v[88:91], v[188:191]
    ds_read_b64_tr_b16 a[28:29], v19 offset:28672
    v_permlane32_swap_b32 v100, v106
    v_permlane32_swap_b32 v101, v107
    v_add_f32 v100, v100, v106
    v_add_f32 v101, v101, v107
    v_mfma_f32_16x16x32_bf16 v[180:183], a[44:47], v[84:87], v[180:183]
    ds_read_b64_tr_b16 a[30:31], v19 offset:30720
    s_waitcnt vmcnt(29) lgkmcnt(8)
    v_mfma_f32_16x16x32_bf16 v[192:195], a[0:3], v[84:87], v[192:195]
    s_barrier
    ds_read_b64_tr_b16 a[32:33], v8 offset:0
    v_mfma_f32_16x16x32_bf16 v[200:203], a[0:3], v[88:91], v[200:203]
    ds_read_b64_tr_b16 a[34:35], v8 offset:2048
    s_add_u32 m0, s67, 114688
    v_mfma_f32_16x16x32_bf16 v[204:207], a[4:7], v[88:91], v[204:207]
    ds_read_b64_tr_b16 a[36:37], v8 offset:4096
    v_mov_b32 v106, v100
    v_mfma_f32_16x16x32_bf16 v[196:199], a[4:7], v[84:87], v[196:199]
    ds_read_b64_tr_b16 a[38:39], v8 offset:6144
    v_mov_b32 v107, v101
    v_mfma_f32_16x16x32_bf16 v[208:211], a[8:11], v[84:87], v[208:211]
    ds_read_b64_tr_b16 a[40:41], v8 offset:8192
    v_permlane16_swap_b32 v100, v106
    v_mfma_f32_16x16x32_bf16 v[216:219], a[8:11], v[88:91], v[216:219]
    ds_read_b64_tr_b16 a[42:43], v8 offset:10240
    v_permlane16_swap_b32 v101, v107
    v_add_f32 v100, v100, v106
    v_mfma_f32_16x16x32_bf16 v[220:223], a[12:15], v[88:91], v[220:223]
    ds_read_b64_tr_b16 a[44:45], v8 offset:12288
    s_add_u32 s68, s75, 114688
    v_mfma_f32_16x16x32_bf16 v[212:215], a[12:15], v[84:87], v[212:215]
    ds_read_b64_tr_b16 a[46:47], v8 offset:14336
    s_waitcnt lgkmcnt(8)
    v_mfma_f32_16x16x32_bf16 v[224:227], a[16:19], v[84:87], v[224:227]
    ds_read_b64_tr_b16 a[0:1], v8 offset:16384
    v_add_f32 v101, v101, v107
    v_mfma_f32_16x16x32_bf16 v[232:235], a[16:19], v[88:91], v[232:235]
    ds_read_b64_tr_b16 a[2:3], v8 offset:18432
    v_rcp_f32 v126, v100
    v_mfma_f32_16x16x32_bf16 v[236:239], a[20:23], v[88:91], v[236:239]
    ds_read_b64_tr_b16 a[4:5], v8 offset:20480
    v_rcp_f32 v127, v101
    v_add_f32 v106, v100, v101
    v_mfma_f32_16x16x32_bf16 v[228:231], a[20:23], v[84:87], v[228:231]
    ds_read_b64_tr_b16 a[6:7], v8 offset:22528
    buffer_load_dwordx4 v32, s[48:51], s68 offen offset:0 sc1 lds
    v_mfma_f32_16x16x32_bf16 v[240:243], a[24:27], v[84:87], v[240:243]
    ds_read_b64_tr_b16 a[8:9], v8 offset:24576
    s_mov_b32 s69, 0x4b800000
    v_mfma_f32_16x16x32_bf16 v[248:251], a[24:27], v[88:91], v[248:251]
    ds_read_b64_tr_b16 a[10:11], v8 offset:26624
    v_cmp_ngt_f32 vcc, s69, v106
    v_mfma_f32_16x16x32_bf16 v[252:255], a[28:31], v[88:91], v[252:255]
    ds_read_b64_tr_b16 a[12:13], v8 offset:28672
    v_mfma_f32_16x16x32_bf16 v[244:247], a[28:31], v[84:87], v[244:247]
    ds_read_b64_tr_b16 a[14:15], v8 offset:30720
    s_waitcnt lgkmcnt(8)
    s_cbranch_vccnz L_exact
L_exact_ret:
    s_add_u32 s69, s98, 16384
    v_pk_mul_f32 v[128:129], v[128:129], v[126:127] op_sel:[0,0] op_sel_hi:[1,0]
    v_pk_mul_f32 v[130:131], v[130:131], v[126:127] op_sel:[0,0] op_sel_hi:[1,0]
    v_pk_mul_f32 v[132:133], v[132:133], v[126:127] op_sel:[0,0] op_sel_hi:[1,0]
    v_pk_mul_f32 v[134:135], v[134:135], v[126:127] op_sel:[0,0] op_sel_hi:[1,0]
    v_pk_mul_f32 v[136:137], v[136:137], v[126:127] op_sel:[0,1] op_sel_hi:[1,1]
    buffer_load_dwordx4 a[64:67], v2, s[56:59], s69 offen offset:0 sc1
    v_pk_mul_f32 v[138:139], v[138:139], v[126:127] op_sel:[0,1] op_sel_hi:[1,1]
    v_pk_mul_f32 v[140:141], v[140:141], v[126:127] op_sel:[0,1] op_sel_hi:[1,1]
    v_pk_mul_f32 v[142:143], v[142:143], v[126:127] op_sel:[0,1] op_sel_hi:[1,1]
    v_cvt_pk_bf16_f32 v128, v128, v129
    v_cvt_pk_bf16_f32 v129, v130, v131
    buffer_load_dwordx4 a[80:83], v2, s[56:59], s69 offen offset:2048 sc1
    v_cvt_pk_bf16_f32 v130, v132, v133
    v_cvt_pk_bf16_f32 v131, v134, v135
    v_cvt_pk_bf16_f32 v136, v136, v137
    v_cvt_pk_bf16_f32 v137, v138, v139
    v_cvt_pk_bf16_f32 v138, v140, v141
    s_add_u32 s69, s99, 16384
    v_cvt_pk_bf16_f32 v139, v142, v143
    v_pk_mul_f32 v[144:145], v[144:145], v[126:127] op_sel:[0,0] op_sel_hi:[1,0]
    v_pk_mul_f32 v[146:147], v[146:147], v[126:127] op_sel:[0,0] op_sel_hi:[1,0]
    v_pk_mul_f32 v[148:149], v[148:149], v[126:127] op_sel:[0,0] op_sel_hi:[1,0]
    v_pk_mul_f32 v[150:151], v[150:151], v[126:127] op_sel:[0,0] op_sel_hi:[1,0]
    buffer_load_dwordx4 a[68:71], v2, s[56:59], s69 offen offset:0 sc1
    v_pk_mul_f32 v[152:153], v[152:153], v[126:127] op_sel:[0,1] op_sel_hi:[1,1]
    v_pk_mul_f32 v[154:155], v[154:155], v[126:127] op_sel:[0,1] op_sel_hi:[1,1]
    v_pk_mul_f32 v[156:157], v[156:157], v[126:127] op_sel:[0,1] op_sel_hi:[1,1]
    v_pk_mul_f32 v[158:159], v[158:159], v[126:127] op_sel:[0,1] op_sel_hi:[1,1]
    v_cvt_pk_bf16_f32 v144, v144, v145
    buffer_load_dwordx4 a[84:87], v2, s[56:59], s69 offen offset:2048 sc1
    v_cvt_pk_bf16_f32 v145, v146, v147
    v_cvt_pk_bf16_f32 v146, v148, v149
    v_cvt_pk_bf16_f32 v147, v150, v151
    v_cvt_pk_bf16_f32 v152, v152, v153
    v_cvt_pk_bf16_f32 v153, v154, v155
    s_add_u32 s69, s100, 16384
    v_cvt_pk_bf16_f32 v154, v156, v157
    v_cvt_pk_bf16_f32 v155, v158, v159
    v_pk_mul_f32 v[160:161], v[160:161], v[126:127] op_sel:[0,0] op_sel_hi:[1,0]
    v_pk_mul_f32 v[162:163], v[162:163], v[126:127] op_sel:[0,0] op_sel_hi:[1,0]
    v_pk_mul_f32 v[164:165], v[164:165], v[126:127] op_sel:[0,0] op_sel_hi:[1,0]
    buffer_load_dwordx4 a[72:75], v2, s[56:59], s69 offen offset:0 sc1
    v_pk_mul_f32 v[166:167], v[166:167], v[126:127] op_sel:[0,0] op_sel_hi:[1,0]
    v_pk_mul_f32 v[168:169], v[168:169], v[126:127] op_sel:[0,1] op_sel_hi:[1,1]
    v_pk_mul_f32 v[170:171], v[170:171], v[126:127] op_sel:[0,1] op_sel_hi:[1,1]
    v_pk_mul_f32 v[172:173], v[172:173], v[126:127] op_sel:[0,1] op_sel_hi:[1,1]
    v_pk_mul_f32 v[174:175], v[174:175], v[126:127] op_sel:[0,1] op_sel_hi:[1,1]
    buffer_load_dwordx4 a[88:91], v2, s[56:59], s69 offen offset:2048 sc1
    v_cvt_pk_bf16_f32 v160, v160, v161
    v_cvt_pk_bf16_f32 v161, v162, v163
    v_cvt_pk_bf16_f32 v162, v164, v165
    v_cvt_pk_bf16_f32 v163, v166, v167
    v_cvt_pk_bf16_f32 v168, v168, v169
    s_add_u32 s69, s101, 16384
    v_cvt_pk_bf16_f32 v169, v170, v171
    v_cvt_pk_bf16_f32 v170, v172, v173
    v_cvt_pk_bf16_f32 v171, v174, v175
    v_pk_mul_f32 v[176:177], v[176:177], v[126:127] op_sel:[0,0] op_sel_hi:[1,0]
    v_pk_mul_f32 v[178:179], v[178:179], v[126:127] op_sel:[0,0] op_sel_hi:[1,0]
    buffer_load_dwordx4 a[76:79], v2, s[56:59], s69 offen offset:0 sc1
    v_pk_mul_f32 v[180:181], v[180:181], v[126:127] op_sel:[0,0] op_sel_hi:[1,0]
    v_pk_mul_f32 v[182:183], v[182:183], v[126:127] op_sel:[0,0] op_sel_hi:[1,0]
    v_pk_mul_f32 v[184:185], v[184:185], v[126:127] op_sel:[0,1] op_sel_hi:[1,1]
    v_pk_mul_f32 v[186:187], v[186:187], v[126:127] op_sel:[0,1] op_sel_hi:[1,1]
    v_pk_mul_f32 v[188:189], v[188:189], v[126:127] op_sel:[0,1] op_sel_hi:[1,1]
    buffer_load_dwordx4 a[92:95], v2, s[56:59], s69 offen offset:2048 sc1
    v_pk_mul_f32 v[190:191], v[190:191], v[126:127] op_sel:[0,1] op_sel_hi:[1,1]
    v_cvt_pk_bf16_f32 v176, v176, v177
    v_cvt_pk_bf16_f32 v177, v178, v179
    v_cvt_pk_bf16_f32 v178, v180, v181
    v_cvt_pk_bf16_f32 v179, v182, v183
    s_add_u32 s69, s98, 20480
    v_cvt_pk_bf16_f32 v184, v184, v185
    v_cvt_pk_bf16_f32 v185, v186, v187
    v_cvt_pk_bf16_f32 v186, v188, v189
    v_cvt_pk_bf16_f32 v187, v190, v191
    v_pk_mul_f32 v[192:193], v[192:193], v[126:127] op_sel:[0,0] op_sel_hi:[1,0]
    buffer_load_dwordx4 a[96:99], v2, s[56:59], s69 offen offset:0 sc1
    v_pk_mul_f32 v[194:195], v[194:195], v[126:127] op_sel:[0,0] op_sel_hi:[1,0]
    v_pk_mul_f32 v[196:197], v[196:197], v[126:127] op_sel:[0,0] op_sel_hi:[1,0]
    v_pk_mul_f32 v[198:199], v[198:199], v[126:127] op_sel:[0,0] op_sel_hi:[1,0]
    v_pk_mul_f32 v[200:201], v[200:201], v[126:127] op_sel:[0,1] op_sel_hi:[1,1]
    v_pk_mul_f32 v[202:203], v[202:203], v[126:127] op_sel:[0,1] op_sel_hi:[1,1]
    buffer_load_dwordx4 a[112:115], v2, s[56:59], s69 offen offset:2048 sc1
    v_pk_mul_f32 v[204:205], v[204:205], v[126:127] op_sel:[0,1] op_sel_hi:[1,1]
    v_pk_mul_f32 v[206:207], v[206:207], v[126:127] op_sel:[0,1] op_sel_hi:[1,1]
    v_cvt_pk_bf16_f32 v192, v192, v193
    v_cvt_pk_bf16_f32 v193, v194, v195
    v_cvt_pk_bf16_f32 v194, v196, v197
    s_add_u32 s69, s99, 20480
    v_cvt_pk_bf16_f32 v195, v198, v199
    v_cvt_pk_bf16_f32 v200, v200, v201
    v_cvt_pk_bf16_f32 v201, v202, v203
    v_cvt_pk_bf16_f32 v202, v204, v205
    v_cvt_pk_bf16_f32 v203, v206, v207
    buffer_load_dwordx4 a[100:103], v2, s[56:59], s69 offen offset:0 sc1
    v_pk_mul_f32 v[208:209], v[208:209], v[126:127] op_sel:[0,0] op_sel_hi:[1,0]
    v_pk_mul_f32 v[210:211], v[210:211], v[126:127] op_sel:[0,0] op_sel_hi:[1,0]
    v_pk_mul_f32 v[212:213], v[212:213], v[126:127] op_sel:[0,0] op_sel_hi:[1,0]
    v_pk_mul_f32 v[214:215], v[214:215], v[126:127] op_sel:[0,0] op_sel_hi:[1,0]
    v_pk_mul_f32 v[216:217], v[216:217], v[126:127] op_sel:[0,1] op_sel_hi:[1,1]
    buffer_load_dwordx4 a[116:119], v2, s[56:59], s69 offen offset:2048 sc1
    v_pk_mul_f32 v[218:219], v[218:219], v[126:127] op_sel:[0,1] op_sel_hi:[1,1]
    v_pk_mul_f32 v[220:221], v[220:221], v[126:127] op_sel:[0,1] op_sel_hi:[1,1]
    v_pk_mul_f32 v[222:223], v[222:223], v[126:127] op_sel:[0,1] op_sel_hi:[1,1]
    v_cvt_pk_bf16_f32 v208, v208, v209
    v_cvt_pk_bf16_f32 v209, v210, v211
    s_add_u32 s69, s100, 20480
    v_cvt_pk_bf16_f32 v210, v212, v213
    v_cvt_pk_bf16_f32 v211, v214, v215
    v_cvt_pk_bf16_f32 v216, v216, v217
    v_cvt_pk_bf16_f32 v217, v218, v219
    v_cvt_pk_bf16_f32 v218, v220, v221
    buffer_load_dwordx4 a[104:107], v2, s[56:59], s69 offen offset:0 sc1
    v_cvt_pk_bf16_f32 v219, v222, v223
    v_pk_mul_f32 v[224:225], v[224:225], v[126:127] op_sel:[0,0] op_sel_hi:[1,0]
    v_pk_mul_f32 v[226:227], v[226:227], v[126:127] op_sel:[0,0] op_sel_hi:[1,0]
    v_pk_mul_f32 v[228:229], v[228:229], v[126:127] op_sel:[0,0] op_sel_hi:[1,0]
    v_pk_mul_f32 v[230:231], v[230:231], v[126:127] op_sel:[0,0] op_sel_hi:[1,0]
    buffer_load_dwordx4 a[120:123], v2, s[56:59], s69 offen offset:2048 sc1
    v_pk_mul_f32 v[232:233], v[232:233], v[126:127] op_sel:[0,1] op_sel_hi:[1,1]
    v_pk_mul_f32 v[234:235], v[234:235], v[126:127] op_sel:[0,1] op_sel_hi:[1,1]
    v_pk_mul_f32 v[236:237], v[236:237], v[126:127] op_sel:[0,1] op_sel_hi:[1,1]
    v_pk_mul_f32 v[238:239], v[238:239], v[126:127] op_sel:[0,1] op_sel_hi:[1,1]
    v_cvt_pk_bf16_f32 v224, v224, v225
    s_add_u32 s69, s101, 20480
    v_cvt_pk_bf16_f32 v225, v226, v227
    v_cvt_pk_bf16_f32 v226, v228, v229
    v_cvt_pk_bf16_f32 v227, v230, v231
    v_cvt_pk_bf16_f32 v232, v232, v233
    v_cvt_pk_bf16_f32 v233, v234, v235
    buffer_load_dwordx4 a[108:111], v2, s[56:59], s69 offen offset:0 sc1
    v_cvt_pk_bf16_f32 v234, v236, v237
    v_cvt_pk_bf16_f32 v235, v238, v239
    v_pk_mul_f32 v[240:241], v[240:241], v[126:127] op_sel:[0,0] op_sel_hi:[1,0]
    v_pk_mul_f32 v[242:243], v[242:243], v[126:127] op_sel:[0,0] op_sel_hi:[1,0]
    v_pk_mul_f32 v[244:245], v[244:245], v[126:127] op_sel:[0,0] op_sel_hi:[1,0]
    buffer_load_dwordx4 a[124:127], v2, s[56:59], s69 offen offset:2048 sc1
    v_pk_mul_f32 v[246:247], v[246:247], v[126:127] op_sel:[0,0] op_sel_hi:[1,0]
    v_pk_mul_f32 v[248:249], v[248:249], v[126:127] op_sel:[0,1] op_sel_hi:[1,1]
    v_pk_mul_f32 v[250:251], v[250:251], v[126:127] op_sel:[0,1] op_sel_hi:[1,1]
    v_pk_mul_f32 v[252:253], v[252:253], v[126:127] op_sel:[0,1] op_sel_hi:[1,1]
    v_pk_mul_f32 v[254:255], v[254:255], v[126:127] op_sel:[0,1] op_sel_hi:[1,1]
    v_cvt_pk_bf16_f32 v240, v240, v241
    v_cvt_pk_bf16_f32 v241, v242, v243
    v_cvt_pk_bf16_f32 v242, v244, v245
    v_cvt_pk_bf16_f32 v243, v246, v247
    v_cvt_pk_bf16_f32 v248, v248, v249
    v_cvt_pk_bf16_f32 v249, v250, v251
    v_cvt_pk_bf16_f32 v250, v252, v253
    v_cvt_pk_bf16_f32 v251, v254, v255
    v_mfma_f32_16x16x32_bf16 v[196:199], a[32:35], v[128:131], 0
    ds_read_b64_tr_b16 a[16:17], v9 offset:0
    buffer_load_dwordx4 v33, s[48:51], s68 offen offset:1024 sc1 lds
    v_mfma_f32_16x16x32_bf16 v[196:199], a[36:39], v[144:147], v[196:199]
    ds_read_b64_tr_b16 a[18:19], v9 offset:2048
    v_mfma_f32_16x16x32_bf16 v[196:199], a[40:43], v[160:163], v[196:199]
    ds_read_b64_tr_b16 a[20:21], v9 offset:4096
    s_add_u32 s69, s98, 24576
    v_mfma_f32_16x16x32_bf16 v[196:199], a[44:47], v[176:179], v[196:199]
    ds_read_b64_tr_b16 a[22:23], v9 offset:6144
    v_mfma_f32_16x16x32_bf16 v[212:215], a[44:47], v[184:187], 0
    ds_read_b64_tr_b16 a[24:25], v9 offset:8192
    buffer_load_dwordx4 v[132:135], v2, s[56:59], s69 offen offset:0 sc1
    v_mfma_f32_16x16x32_bf16 v[212:215], a[40:43], v[168:171], v[212:215]
    ds_read_b64_tr_b16 a[26:27], v9 offset:10240
    buffer_load_dwordx4 v34, s[48:51], s68 offen offset:2048 sc1 lds
    v_mfma_f32_16x16x32_bf16 v[212:215], a[36:39], v[152:155], v[212:215]
    ds_read_b64_tr_b16 a[28:29], v9 offset:12288
    buffer_load_dwordx4 v[164:167], v2, s[56:59], s69 offen offset:2048 sc1
    v_mfma_f32_16x16x32_bf16 v[212:215], a[32:35], v[136:139], v[212:215]
    ds_read_b64_tr_b16 a[30:31], v9 offset:14336
    s_waitcnt lgkmcnt(8)
    v_mfma_f32_16x16x32_bf16 v[212:215], a[0:3], v[200:203], v[212:215]
    ds_read_b64_tr_b16 a[32:33], v9 offset:16384
    v_mfma_f32_16x16x32_bf16 v[212:215], a[4:7], v[216:219], v[212:215]
    ds_read_b64_tr_b16 a[34:35], v9 offset:18432
    s_add_u32 s69, s99, 24576
    v_mfma_f32_16x16x32_bf16 v[212:215], a[8:11], v[232:235], v[212:215]
    ds_read_b64_tr_b16 a[36:37], v9 offset:20480
    buffer_load_dwordx4 v35, s[48:51], s68 offen offset:3072 sc1 lds
    v_mfma_f32_16x16x32_bf16 v[212:215], a[12:15], v[248:251], v[212:215]
    ds_read_b64_tr_b16 a[38:39], v9 offset:22528
    s_add_u32 m0, s67, 131072
    v_mfma_f32_16x16x32_bf16 v[196:199], a[12:15], v[240:243], v[196:199]
    ds_read_b64_tr_b16 a[40:41], v9 offset:24576
    buffer_load_dwordx4 v[140:143], v2, s[56:59], s69 offen offset:0 sc1
    v_mfma_f32_16x16x32_bf16 v[196:199], a[8:11], v[224:227], v[196:199]
    ds_read_b64_tr_b16 a[42:43], v9 offset:26624
    buffer_load_dwordx4 v[172:175], v2, s[56:59], s69 offen offset:2048 sc1
    v_mfma_f32_16x16x32_bf16 v[196:199], a[4:7], v[208:211], v[196:199]
    ds_read_b64_tr_b16 a[44:45], v9 offset:28672
    buffer_load_dwordx4 v32, s[48:51], s76 offen offset:0 sc1 lds
    v_mfma_f32_16x16x32_bf16 v[196:199], a[0:3], v[192:195], v[196:199]
    ds_read_b64_tr_b16 a[46:47], v9 offset:30720
    s_waitcnt lgkmcnt(8)
    v_mfma_f32_16x16x32_bf16 v[204:207], a[16:19], v[128:131], 0
    ds_read_b64_tr_b16 a[0:1], v10 offset:0
    s_add_u32 s69, s100, 24576
    v_mfma_f32_16x16x32_bf16 v[204:207], a[20:23], v[144:147], v[204:207]
    ds_read_b64_tr_b16 a[2:3], v10 offset:2048
    v_mfma_f32_16x16x32_bf16 v[204:207], a[24:27], v[160:163], v[204:207]
    ds_read_b64_tr_b16 a[4:5], v10 offset:4096
    buffer_load_dwordx4 v33, s[48:51], s76 offen offset:1024 sc1 lds
    buffer_load_dwordx4 v[148:151], v2, s[56:59], s69 offen offset:0 sc1
    v_mfma_f32_16x16x32_bf16 v[204:207], a[28:31], v[176:179], v[204:207]
    ds_read_b64_tr_b16 a[6:7], v10 offset:6144
    v_cvt_pk_bf16_f32 v196, v196, v197
    v_mfma_f32_16x16x32_bf16 v[220:223], a[28:31], v[184:187], 0
    ds_read_b64_tr_b16 a[8:9], v10 offset:8192
    v_cvt_pk_bf16_f32 v197, v198, v199
    buffer_load_dwordx4 v[180:183], v2, s[56:59], s69 offen offset:2048 sc1
    v_mfma_f32_16x16x32_bf16 v[220:223], a[24:27], v[168:171], v[220:223]
    ds_read_b64_tr_b16 a[10:11], v10 offset:10240
    v_cvt_pk_bf16_f32 v212, v212, v213
    v_mfma_f32_16x16x32_bf16 v[220:223], a[20:23], v[152:155], v[220:223]
    ds_read_b64_tr_b16 a[12:13], v10 offset:12288
    buffer_load_dwordx4 v34, s[48:51], s76 offen offset:2048 sc1 lds
    v_mfma_f32_16x16x32_bf16 v[220:223], a[16:19], v[136:139], v[220:223]
    ds_read_b64_tr_b16 a[14:15], v10 offset:14336
    s_waitcnt lgkmcnt(8)
    s_add_u32 s69, s101, 24576
    v_mfma_f32_16x16x32_bf16 v[220:223], a[32:35], v[200:203], v[220:223]
    ds_read_b64_tr_b16 a[16:17], v10 offset:16384
    v_cvt_pk_bf16_f32 v213, v214, v215
    v_mfma_f32_16x16x32_bf16 v[220:223], a[36:39], v[216:219], v[220:223]
    ds_read_b64_tr_b16 a[18:19], v10 offset:18432
    buffer_load_dwordx4 v[156:159], v2, s[56:59], s69 offen offset:0 sc1
    v_mfma_f32_16x16x32_bf16 v[220:223], a[40:43], v[232:235], v[220:223]
    ds_read_b64_tr_b16 a[20:21], v10 offset:20480
    buffer_load_dwordx4 v35, s[48:51], s76 offen offset:3072 sc1 lds
    v_mfma_f32_16x16x32_bf16 v[220:223], a[44:47], v[248:251], v[220:223]
    ds_read_b64_tr_b16 a[22:23], v10 offset:22528
    buffer_load_dwordx4 v[188:191], v2, s[56:59], s69 offen offset:2048 sc1
    v_mfma_f32_16x16x32_bf16 v[204:207], a[44:47], v[240:243], v[204:207]
    ds_read_b64_tr_b16 a[24:25], v10 offset:24576
    v_mfma_f32_16x16x32_bf16 v[204:207], a[40:43], v[224:227], v[204:207]
    ds_read_b64_tr_b16 a[26:27], v10 offset:26624
    v_mfma_f32_16x16x32_bf16 v[204:207], a[36:39], v[208:211], v[204:207]
    ds_read_b64_tr_b16 a[28:29], v10 offset:28672
    v_mfma_f32_16x16x32_bf16 v[204:207], a[32:35], v[192:195], v[204:207]
    ds_read_b64_tr_b16 a[30:31], v10 offset:30720
    s_waitcnt lgkmcnt(8)
    v_mfma_f32_16x16x32_bf16 v[228:231], a[0:3], v[128:131], 0
    ds_read_b64_tr_b16 a[32:33], v11 offset:0
    v_mfma_f32_16x16x32_bf16 v[228:231], a[4:7], v[144:147], v[228:231]
    ds_read_b64_tr_b16 a[34:35], v11 offset:2048
    v_mfma_f32_16x16x32_bf16 v[228:231], a[8:11], v[160:163], v[228:231]
    ds_read_b64_tr_b16 a[36:37], v11 offset:4096
    v_mfma_f32_16x16x32_bf16 v[228:231], a[12:15], v[176:179], v[228:231]
    ds_read_b64_tr_b16 a[38:39], v11 offset:6144
    v_cvt_pk_bf16_f32 v198, v204, v205
    v_mfma_f32_16x16x32_bf16 v[244:247], a[12:15], v[184:187], 0
    ds_read_b64_tr_b16 a[40:41], v11 offset:8192
    v_cvt_pk_bf16_f32 v199, v206, v207
    v_mfma_f32_16x16x32_bf16 v[244:247], a[8:11], v[168:171], v[244:247]
    ds_read_b64_tr_b16 a[42:43], v11 offset:10240
    buffer_store_dwordx4 v[196:199], v1, s[56:59], s79 offen sc1
    v_mfma_f32_16x16x32_bf16 v[244:247], a[4:7], v[152:155], v[244:247]
    ds_read_b64_tr_b16 a[44:45], v11 offset:12288
    v_cvt_pk_bf16_f32 v214, v220, v221
    v_mfma_f32_16x16x32_bf16 v[244:247], a[0:3], v[136:139], v[244:247]
    ds_read_b64_tr_b16 a[46:47], v11 offset:14336
    s_waitcnt lgkmcnt(8)
    v_mfma_f32_16x16x32_bf16 v[244:247], a[16:19], v[200:203], v[244:247]
    ds_read_b64_tr_b16 a[0:1], v11 offset:16384
    v_cvt_pk_bf16_f32 v215, v222, v223
    v_mfma_f32_16x16x32_bf16 v[244:247], a[20:23], v[216:219], v[244:247]
    ds_read_b64_tr_b16 a[2:3], v11 offset:18432
    s_add_u32 s79, s79, 16384
    v_mfma_f32_16x16x32_bf16 v[244:247], a[24:27], v[232:235], v[244:247]
    ds_read_b64_tr_b16 a[4:5], v11 offset:20480
    buffer_store_dwordx4 v[212:215], v1, s[56:59], s79 offen sc1
    v_mfma_f32_16x16x32_bf16 v[244:247], a[28:31], v[248:251], v[244:247]
    ds_read_b64_tr_b16 a[6:7], v11 offset:22528
    v_mfma_f32_16x16x32_bf16 v[228:231], a[28:31], v[240:243], v[228:231]
    ds_read_b64_tr_b16 a[8:9], v11 offset:24576
    v_mfma_f32_16x16x32_bf16 v[228:231], a[24:27], v[224:227], v[228:231]
    ds_read_b64_tr_b16 a[10:11], v11 offset:26624
    v_mfma_f32_16x16x32_bf16 v[228:231], a[20:23], v[208:211], v[228:231]
    ds_read_b64_tr_b16 a[12:13], v11 offset:28672
    v_mfma_f32_16x16x32_bf16 v[228:231], a[16:19], v[192:195], v[228:231]
    ds_read_b64_tr_b16 a[14:15], v11 offset:30720
    s_waitcnt vmcnt(50) lgkmcnt(8)
    v_mfma_f32_16x16x32_bf16 v[236:239], a[32:35], v[128:131], 0
    s_barrier
    ds_read_b64_tr_b16 a[16:17], v8 offset:32768
    v_mfma_f32_16x16x32_bf16 v[236:239], a[36:39], v[144:147], v[236:239]
    ds_read_b64_tr_b16 a[18:19], v8 offset:34816
    s_add_u32 m0, s67, 147456
    v_mfma_f32_16x16x32_bf16 v[236:239], a[40:43], v[160:163], v[236:239]
    ds_read_b64_tr_b16 a[20:21], v8 offset:36864
    v_mfma_f32_16x16x32_bf16 v[236:239], a[44:47], v[176:179], v[236:239]
    ds_read_b64_tr_b16 a[22:23], v8 offset:38912
    v_cvt_pk_bf16_f32 v228, v228, v229
    v_mfma_f32_16x16x32_bf16 v[252:255], a[44:47], v[184:187], 0
    ds_read_b64_tr_b16 a[24:25], v8 offset:40960
    v_cvt_pk_bf16_f32 v229, v230, v231
    v_mfma_f32_16x16x32_bf16 v[252:255], a[40:43], v[168:171], v[252:255]
    ds_read_b64_tr_b16 a[26:27], v8 offset:43008
    v_cvt_pk_bf16_f32 v244, v244, v245
    v_mfma_f32_16x16x32_bf16 v[252:255], a[36:39], v[152:155], v[252:255]
    ds_read_b64_tr_b16 a[28:29], v8 offset:45056
    s_add_u32 s68, s76, 114688
    v_mfma_f32_16x16x32_bf16 v[252:255], a[32:35], v[136:139], v[252:255]
    ds_read_b64_tr_b16 a[30:31], v8 offset:47104
    s_waitcnt lgkmcnt(8)
    v_mfma_f32_16x16x32_bf16 v[252:255], a[0:3], v[200:203], v[252:255]
    ds_read_b64_tr_b16 a[32:33], v8 offset:49152
    v_cvt_pk_bf16_f32 v245, v246, v247
    v_mfma_f32_16x16x32_bf16 v[252:255], a[4:7], v[216:219], v[252:255]
    ds_read_b64_tr_b16 a[34:35], v8 offset:51200
    v_mfma_f32_16x16x32_bf16 v[252:255], a[8:11], v[232:235], v[252:255]
    ds_read_b64_tr_b16 a[36:37], v8 offset:53248
    v_mfma_f32_16x16x32_bf16 v[252:255], a[12:15], v[248:251], v[252:255]
    ds_read_b64_tr_b16 a[38:39], v8 offset:55296
    buffer_load_dwordx4 v32, s[48:51], s68 offen offset:0 sc1 lds
    v_mfma_f32_16x16x32_bf16 v[236:239], a[12:15], v[240:243], v[236:239]
    ds_read_b64_tr_b16 a[40:41], v8 offset:57344
    v_mfma_f32_16x16x32_bf16 v[236:239], a[8:11], v[224:227], v[236:239]
    ds_read_b64_tr_b16 a[42:43], v8 offset:59392
    v_mfma_f32_16x16x32_bf16 v[236:239], a[4:7], v[208:211], v[236:239]
    ds_read_b64_tr_b16 a[44:45], v8 offset:61440
    v_mfma_f32_16x16x32_bf16 v[236:239], a[0:3], v[192:195], v[236:239]
    ds_read_b64_tr_b16 a[46:47], v8 offset:63488
    s_waitcnt lgkmcnt(8)
    v_mfma_f32_16x16x32_bf16 v[196:199], a[16:19], v[128:131], 0
    ds_read_b64_tr_b16 a[0:1], v9 offset:32768
    buffer_load_dwordx4 v33, s[48:51], s68 offen offset:1024 sc1 lds
    v_mfma_f32_16x16x32_bf16 v[196:199], a[20:23], v[144:147], v[196:199]
    ds_read_b64_tr_b16 a[2:3], v9 offset:34816
    v_mfma_f32_16x16x32_bf16 v[196:199], a[24:27], v[160:163], v[196:199]
    ds_read_b64_tr_b16 a[4:5], v9 offset:36864
    v_mfma_f32_16x16x32_bf16 v[196:199], a[28:31], v[176:179], v[196:199]
    ds_read_b64_tr_b16 a[6:7], v9 offset:38912
    v_cvt_pk_bf16_f32 v230, v236, v237
    v_mfma_f32_16x16x32_bf16 v[212:215], a[28:31], v[184:187], 0
    ds_read_b64_tr_b16 a[8:9], v9 offset:40960
    v_cvt_pk_bf16_f32 v231, v238, v239
    v_mfma_f32_16x16x32_bf16 v[212:215], a[24:27], v[168:171], v[212:215]
    ds_read_b64_tr_b16 a[10:11], v9 offset:43008
    buffer_load_dwordx4 v34, s[48:51], s68 offen offset:2048 sc1 lds
    v_mfma_f32_16x16x32_bf16 v[212:215], a[20:23], v[152:155], v[212:215]
    ds_read_b64_tr_b16 a[12:13], v9 offset:45056
    s_add_u32 s79, s79, 16384
    v_mfma_f32_16x16x32_bf16 v[212:215], a[16:19], v[136:139], v[212:215]
    ds_read_b64_tr_b16 a[14:15], v9 offset:47104
    s_waitcnt lgkmcnt(8)
    v_mfma_f32_16x16x32_bf16 v[212:215], a[32:35], v[200:203], v[212:215]
    ds_read_b64_tr_b16 a[16:17], v9 offset:49152
    buffer_store_dwordx4 v[228:231], v1, s[56:59], s79 offen sc1
    v_mfma_f32_16x16x32_bf16 v[212:215], a[36:39], v[216:219], v[212:215]
    ds_read_b64_tr_b16 a[18:19], v9 offset:51200
    v_cvt_pk_bf16_f32 v246, v252, v253
    v_mfma_f32_16x16x32_bf16 v[212:215], a[40:43], v[232:235], v[212:215]
    ds_read_b64_tr_b16 a[20:21], v9 offset:53248
    buffer_load_dwordx4 v35, s[48:51], s68 offen offset:3072 sc1 lds
    v_mfma_f32_16x16x32_bf16 v[212:215], a[44:47], v[248:251], v[212:215]
    ds_read_b64_tr_b16 a[22:23], v9 offset:55296
    v_cvt_pk_bf16_f32 v247, v254, v255
    v_mfma_f32_16x16x32_bf16 v[196:199], a[44:47], v[240:243], v[196:199]
    ds_read_b64_tr_b16 a[24:25], v9 offset:57344
    s_add_u32 s79, s79, 16384
    v_mfma_f32_16x16x32_bf16 v[196:199], a[40:43], v[224:227], v[196:199]
    ds_read_b64_tr_b16 a[26:27], v9 offset:59392
    buffer_store_dwordx4 v[244:247], v1, s[56:59], s79 offen sc1
    v_mfma_f32_16x16x32_bf16 v[196:199], a[36:39], v[208:211], v[196:199]
    ds_read_b64_tr_b16 a[28:29], v9 offset:61440
    v_mfma_f32_16x16x32_bf16 v[196:199], a[32:35], v[192:195], v[196:199]
    ds_read_b64_tr_b16 a[30:31], v9 offset:63488
    s_waitcnt lgkmcnt(8)
    v_mfma_f32_16x16x32_bf16 v[204:207], a[0:3], v[128:131], 0
    ds_read_b64_tr_b16 a[32:33], v10 offset:32768
    v_mfma_f32_16x16x32_bf16 v[204:207], a[4:7], v[144:147], v[204:207]
    ds_read_b64_tr_b16 a[34:35], v10 offset:34816
    v_mfma_f32_16x16x32_bf16 v[204:207], a[8:11], v[160:163], v[204:207]
    ds_read_b64_tr_b16 a[36:37], v10 offset:36864
    v_mfma_f32_16x16x32_bf16 v[204:207], a[12:15], v[176:179], v[204:207]
    ds_read_b64_tr_b16 a[38:39], v10 offset:38912
    v_cvt_pk_bf16_f32 v196, v196, v197
    v_mfma_f32_16x16x32_bf16 v[220:223], a[12:15], v[184:187], 0
    ds_read_b64_tr_b16 a[40:41], v10 offset:40960
    v_cvt_pk_bf16_f32 v197, v198, v199
    v_mfma_f32_16x16x32_bf16 v[220:223], a[8:11], v[168:171], v[220:223]
    ds_read_b64_tr_b16 a[42:43], v10 offset:43008
    v_cvt_pk_bf16_f32 v212, v212, v213
    v_mfma_f32_16x16x32_bf16 v[220:223], a[4:7], v[152:155], v[220:223]
    ds_read_b64_tr_b16 a[44:45], v10 offset:45056
    v_cvt_pk_bf16_f32 v213, v214, v215
    v_mfma_f32_16x16x32_bf16 v[220:223], a[0:3], v[136:139], v[220:223]
    ds_read_b64_tr_b16 a[46:47], v10 offset:47104
    s_waitcnt lgkmcnt(8)
    v_mfma_f32_16x16x32_bf16 v[220:223], a[16:19], v[200:203], v[220:223]
    ds_read_b64_tr_b16 a[0:1], v10 offset:49152
    v_mfma_f32_16x16x32_bf16 v[220:223], a[20:23], v[216:219], v[220:223]
    ds_read_b64_tr_b16 a[2:3], v10 offset:51200
    v_mfma_f32_16x16x32_bf16 v[220:223], a[24:27], v[232:235], v[220:223]
    ds_read_b64_tr_b16 a[4:5], v10 offset:53248
    v_mfma_f32_16x16x32_bf16 v[220:223], a[28:31], v[248:251], v[220:223]
    ds_read_b64_tr_b16 a[6:7], v10 offset:55296
    v_mfma_f32_16x16x32_bf16 v[204:207], a[28:31], v[240:243], v[204:207]
    ds_read_b64_tr_b16 a[8:9], v10 offset:57344
    v_mfma_f32_16x16x32_bf16 v[204:207], a[24:27], v[224:227], v[204:207]
    ds_read_b64_tr_b16 a[10:11], v10 offset:59392
    v_mfma_f32_16x16x32_bf16 v[204:207], a[20:23], v[208:211], v[204:207]
    ds_read_b64_tr_b16 a[12:13], v10 offset:61440
    v_mfma_f32_16x16x32_bf16 v[204:207], a[16:19], v[192:195], v[204:207]
    ds_read_b64_tr_b16 a[14:15], v10 offset:63488
    s_waitcnt lgkmcnt(8)
    v_mfma_f32_16x16x32_bf16 v[228:231], a[32:35], v[128:131], 0
    ds_read_b64_tr_b16 a[16:17], v11 offset:32768
    v_mfma_f32_16x16x32_bf16 v[228:231], a[36:39], v[144:147], v[228:231]
    ds_read_b64_tr_b16 a[18:19], v11 offset:34816
    v_mfma_f32_16x16x32_bf16 v[228:231], a[40:43], v[160:163], v[228:231]
    ds_read_b64_tr_b16 a[20:21], v11 offset:36864
    v_mfma_f32_16x16x32_bf16 v[228:231], a[44:47], v[176:179], v[228:231]
    ds_read_b64_tr_b16 a[22:23], v11 offset:38912
    v_cvt_pk_bf16_f32 v198, v204, v205
    v_mfma_f32_16x16x32_bf16 v[244:247], a[44:47], v[184:187], 0
    ds_read_b64_tr_b16 a[24:25], v11 offset:40960
    v_cvt_pk_bf16_f32 v199, v206, v207
    v_mfma_f32_16x16x32_bf16 v[244:247], a[40:43], v[168:171], v[244:247]
    ds_read_b64_tr_b16 a[26:27], v11 offset:43008
    buffer_store_dwordx4 v[196:199], v1, s[56:59], s80 offen sc1
    v_mfma_f32_16x16x32_bf16 v[244:247], a[36:39], v[152:155], v[244:247]
    ds_read_b64_tr_b16 a[28:29], v11 offset:45056
    v_cvt_pk_bf16_f32 v214, v220, v221
    v_mfma_f32_16x16x32_bf16 v[244:247], a[32:35], v[136:139], v[244:247]
    ds_read_b64_tr_b16 a[30:31], v11 offset:47104
    s_waitcnt lgkmcnt(8)
    v_mfma_f32_16x16x32_bf16 v[244:247], a[0:3], v[200:203], v[244:247]
    ds_read_b64_tr_b16 a[32:33], v11 offset:49152
    v_cvt_pk_bf16_f32 v215, v222, v223
    v_mfma_f32_16x16x32_bf16 v[244:247], a[4:7], v[216:219], v[244:247]
    ds_read_b64_tr_b16 a[34:35], v11 offset:51200
    s_add_u32 s80, s80, 16384
    v_mfma_f32_16x16x32_bf16 v[244:247], a[8:11], v[232:235], v[244:247]
    ds_read_b64_tr_b16 a[36:37], v11 offset:53248
    buffer_store_dwordx4 v[212:215], v1, s[56:59], s80 offen sc1
    v_mfma_f32_16x16x32_bf16 v[244:247], a[12:15], v[248:251], v[244:247]
    ds_read_b64_tr_b16 a[38:39], v11 offset:55296
    v_and_b32 v123, 15, v0
    v_mfma_f32_16x16x32_bf16 v[228:231], a[12:15], v[240:243], v[228:231]
    ds_read_b64_tr_b16 a[40:41], v11 offset:57344
    v_mfma_f32_16x16x32_bf16 v[228:231], a[8:11], v[224:227], v[228:231]
    ds_read_b64_tr_b16 a[42:43], v11 offset:59392
    v_mfma_f32_16x16x32_bf16 v[228:231], a[4:7], v[208:211], v[228:231]
    ds_read_b64_tr_b16 a[44:45], v11 offset:61440
    v_mfma_f32_16x16x32_bf16 v[228:231], a[0:3], v[192:195], v[228:231]
    ds_read_b64_tr_b16 a[46:47], v11 offset:63488
    s_waitcnt vmcnt(46) lgkmcnt(8)
    v_mfma_f32_16x16x32_bf16 v[236:239], a[16:19], v[128:131], 0
    s_barrier
    ds_read_b64_tr_b16 a[0:1], v12 offset:0
    v_mfma_f32_16x16x32_bf16 v[236:239], a[20:23], v[144:147], v[236:239]
    ds_read_b64_tr_b16 a[2:3], v12 offset:2048
    s_add_u32 m0, s67, 0
    v_mfma_f32_16x16x32_bf16 v[236:239], a[24:27], v[160:163], v[236:239]
    ds_read_b64_tr_b16 a[4:5], v12 offset:4096
    v_mfma_f32_16x16x32_bf16 v[236:239], a[28:31], v[176:179], v[236:239]
    ds_read_b64_tr_b16 a[6:7], v12 offset:6144
    v_cvt_pk_bf16_f32 v228, v228, v229
    v_mfma_f32_16x16x32_bf16 v[252:255], a[28:31], v[184:187], 0
    ds_read_b64_tr_b16 a[8:9], v12 offset:8192
    v_cvt_pk_bf16_f32 v229, v230, v231
    v_mfma_f32_16x16x32_bf16 v[252:255], a[24:27], v[168:171], v[252:255]
    ds_read_b64_tr_b16 a[10:11], v12 offset:10240
    v_cvt_pk_bf16_f32 v244, v244, v245
    v_mfma_f32_16x16x32_bf16 v[252:255], a[20:23], v[152:155], v[252:255]
    ds_read_b64_tr_b16 a[12:13], v12 offset:12288
    v_cvt_pk_bf16_f32 v245, v246, v247
    v_mfma_f32_16x16x32_bf16 v[252:255], a[16:19], v[136:139], v[252:255]
    ds_read_b64_tr_b16 a[14:15], v12 offset:14336
    s_waitcnt lgkmcnt(8)
    v_mfma_f32_16x16x32_bf16 v[252:255], a[32:35], v[200:203], v[252:255]
    ds_read_b64_tr_b16 a[16:17], v12 offset:16384
    buffer_load_dwordx4 v32, s[48:51], s77 offen offset:0 sc1 lds
    v_mfma_f32_16x16x32_bf16 v[252:255], a[36:39], v[216:219], v[252:255]
    ds_read_b64_tr_b16 a[18:19], v12 offset:18432
    v_mfma_f32_16x16x32_bf16 v[252:255], a[40:43], v[232:235], v[252:255]
    ds_read_b64_tr_b16 a[20:21], v12 offset:20480
    v_mfma_f32_16x16x32_bf16 v[252:255], a[44:47], v[248:251], v[252:255]
    ds_read_b64_tr_b16 a[22:23], v12 offset:22528
    v_mfma_f32_16x16x32_bf16 v[236:239], a[44:47], v[240:243], v[236:239]
    ds_read_b64_tr_b16 a[24:25], v12 offset:24576
    v_mfma_f32_16x16x32_bf16 v[236:239], a[40:43], v[224:227], v[236:239]
    ds_read_b64_tr_b16 a[26:27], v12 offset:26624
    buffer_load_dwordx4 v33, s[48:51], s77 offen offset:1024 sc1 lds
    v_mfma_f32_16x16x32_bf16 v[236:239], a[36:39], v[208:211], v[236:239]
    ds_read_b64_tr_b16 a[28:29], v12 offset:28672
    v_mfma_f32_16x16x32_bf16 v[236:239], a[32:35], v[192:195], v[236:239]
    ds_read_b64_tr_b16 a[30:31], v12 offset:30720
    s_waitcnt lgkmcnt(8)
    v_mfma_f32_16x16x32_bf16 v[196:199], a[0:3], v[128:131], 0
    ds_read_b64_tr_b16 a[32:33], v13 offset:0
    v_mfma_f32_16x16x32_bf16 v[196:199], a[4:7], v[144:147], v[196:199]
    ds_read_b64_tr_b16 a[34:35], v13 offset:2048
    v_mfma_f32_16x16x32_bf16 v[196:199], a[8:11], v[160:163], v[196:199]
    ds_read_b64_tr_b16 a[36:37], v13 offset:4096
    v_mfma_f32_16x16x32_bf16 v[196:199], a[12:15], v[176:179], v[196:199]
    ds_read_b64_tr_b16 a[38:39], v13 offset:6144
    buffer_load_dwordx4 v34, s[48:51], s77 offen offset:2048 sc1 lds
    v_mfma_f32_16x16x32_bf16 v[212:215], a[12:15], v[184:187], 0
    ds_read_b64_tr_b16 a[40:41], v13 offset:8192
    v_cvt_pk_bf16_f32 v230, v236, v237
    v_mfma_f32_16x16x32_bf16 v[212:215], a[8:11], v[168:171], v[212:215]
    ds_read_b64_tr_b16 a[42:43], v13 offset:10240
    v_cvt_pk_bf16_f32 v231, v238, v239
    v_mfma_f32_16x16x32_bf16 v[212:215], a[4:7], v[152:155], v[212:215]
    ds_read_b64_tr_b16 a[44:45], v13 offset:12288
    s_add_u32 s80, s80, 16384
    v_mfma_f32_16x16x32_bf16 v[212:215], a[0:3], v[136:139], v[212:215]
    ds_read_b64_tr_b16 a[46:47], v13 offset:14336
    s_waitcnt lgkmcnt(8)
    v_mfma_f32_16x16x32_bf16 v[212:215], a[16:19], v[200:203], v[212:215]
    ds_read_b64_tr_b16 a[0:1], v13 offset:16384
    buffer_store_dwordx4 v[228:231], v1, s[56:59], s80 offen sc1
    v_mfma_f32_16x16x32_bf16 v[212:215], a[20:23], v[216:219], v[212:215]
    ds_read_b64_tr_b16 a[2:3], v13 offset:18432
    buffer_load_dwordx4 v35, s[48:51], s77 offen offset:3072 sc1 lds
    v_mfma_f32_16x16x32_bf16 v[212:215], a[24:27], v[232:235], v[212:215]
    ds_read_b64_tr_b16 a[4:5], v13 offset:20480
    s_add_u32 m0, s67, 16384
    v_mfma_f32_16x16x32_bf16 v[212:215], a[28:31], v[248:251], v[212:215]
    ds_read_b64_tr_b16 a[6:7], v13 offset:22528
    v_cvt_pk_bf16_f32 v246, v252, v253
    v_mfma_f32_16x16x32_bf16 v[196:199], a[28:31], v[240:243], v[196:199]
    ds_read_b64_tr_b16 a[8:9], v13 offset:24576
    s_add_u32 s68, s77, 114688
    v_mfma_f32_16x16x32_bf16 v[196:199], a[24:27], v[224:227], v[196:199]
    ds_read_b64_tr_b16 a[10:11], v13 offset:26624
    v_cvt_pk_bf16_f32 v247, v254, v255
    v_mfma_f32_16x16x32_bf16 v[196:199], a[20:23], v[208:211], v[196:199]
    ds_read_b64_tr_b16 a[12:13], v13 offset:28672
    s_add_u32 s80, s80, 16384
    v_mfma_f32_16x16x32_bf16 v[196:199], a[16:19], v[192:195], v[196:199]
    ds_read_b64_tr_b16 a[14:15], v13 offset:30720
    s_waitcnt lgkmcnt(8)
    v_mfma_f32_16x16x32_bf16 v[204:207], a[32:35], v[128:131], 0
    ds_read_b64_tr_b16 a[16:17], v14 offset:0
    buffer_load_dwordx4 v32, s[48:51], s68 offen offset:0 sc1 lds
    v_mfma_f32_16x16x32_bf16 v[204:207], a[36:39], v[144:147], v[204:207]
    ds_read_b64_tr_b16 a[18:19], v14 offset:2048
    buffer_store_dwordx4 v[244:247], v1, s[56:59], s80 offen sc1
    v_mfma_f32_16x16x32_bf16 v[204:207], a[40:43], v[160:163], v[204:207]
    ds_read_b64_tr_b16 a[20:21], v14 offset:4096
    v_mfma_f32_16x16x32_bf16 v[204:207], a[44:47], v[176:179], v[204:207]
    ds_read_b64_tr_b16 a[22:23], v14 offset:6144
    buffer_load_dwordx4 v33, s[48:51], s68 offen offset:1024 sc1 lds
    v_mfma_f32_16x16x32_bf16 v[220:223], a[44:47], v[184:187], 0
    ds_read_b64_tr_b16 a[24:25], v14 offset:8192
    v_cvt_pk_bf16_f32 v196, v196, v197
    v_mfma_f32_16x16x32_bf16 v[220:223], a[40:43], v[168:171], v[220:223]
    ds_read_b64_tr_b16 a[26:27], v14 offset:10240
    v_cvt_pk_bf16_f32 v197, v198, v199
    v_mfma_f32_16x16x32_bf16 v[220:223], a[36:39], v[152:155], v[220:223]
    ds_read_b64_tr_b16 a[28:29], v14 offset:12288
    buffer_load_dwordx4 v34, s[48:51], s68 offen offset:2048 sc1 lds
    v_mfma_f32_16x16x32_bf16 v[220:223], a[32:35], v[136:139], v[220:223]
    ds_read_b64_tr_b16 a[30:31], v14 offset:14336
    s_waitcnt lgkmcnt(8)
    v_mfma_f32_16x16x32_bf16 v[220:223], a[0:3], v[200:203], v[220:223]
    ds_read_b64_tr_b16 a[32:33], v14 offset:16384
    v_cvt_pk_bf16_f32 v212, v212, v213
    v_mfma_f32_16x16x32_bf16 v[220:223], a[4:7], v[216:219], v[220:223]
    ds_read_b64_tr_b16 a[34:35], v14 offset:18432
    buffer_load_dwordx4 v35, s[48:51], s68 offen offset:3072 sc1 lds
    v_mfma_f32_16x16x32_bf16 v[220:223], a[8:11], v[232:235], v[220:223]
    ds_read_b64_tr_b16 a[36:37], v14 offset:20480
    v_cvt_pk_bf16_f32 v213, v214, v215
    v_mfma_f32_16x16x32_bf16 v[220:223], a[12:15], v[248:251], v[220:223]
    ds_read_b64_tr_b16 a[38:39], v14 offset:22528
    v_mfma_f32_16x16x32_bf16 v[204:207], a[12:15], v[240:243], v[204:207]
    ds_read_b64_tr_b16 a[40:41], v14 offset:24576
    v_mfma_f32_16x16x32_bf16 v[204:207], a[8:11], v[224:227], v[204:207]
    ds_read_b64_tr_b16 a[42:43], v14 offset:26624
    v_mfma_f32_16x16x32_bf16 v[204:207], a[4:7], v[208:211], v[204:207]
    ds_read_b64_tr_b16 a[44:45], v14 offset:28672
    v_mfma_f32_16x16x32_bf16 v[204:207], a[0:3], v[192:195], v[204:207]
    ds_read_b64_tr_b16 a[46:47], v14 offset:30720
    s_waitcnt lgkmcnt(8)
    v_mfma_f32_16x16x32_bf16 v[228:231], a[16:19], v[128:131], 0
    ds_read_b64_tr_b16 a[0:1], v15 offset:0
    v_mfma_f32_16x16x32_bf16 v[228:231], a[20:23], v[144:147], v[228:231]
    ds_read_b64_tr_b16 a[2:3], v15 offset:2048
    v_mfma_f32_16x16x32_bf16 v[228:231], a[24:27], v[160:163], v[228:231]
    ds_read_b64_tr_b16 a[4:5], v15 offset:4096
    v_mfma_f32_16x16x32_bf16 v[228:231], a[28:31], v[176:179], v[228:231]
    ds_read_b64_tr_b16 a[6:7], v15 offset:6144
    v_cvt_pk_bf16_f32 v198, v204, v205
    v_mfma_f32_16x16x32_bf16 v[244:247], a[28:31], v[184:187], 0
    ds_read_b64_tr_b16 a[8:9], v15 offset:8192
    v_cvt_pk_bf16_f32 v199, v206, v207
    v_mfma_f32_16x16x32_bf16 v[244:247], a[24:27], v[168:171], v[244:247]
    ds_read_b64_tr_b16 a[10:11], v15 offset:10240
    buffer_store_dwordx4 v[196:199], v1, s[56:59], s81 offen sc1
    v_mfma_f32_16x16x32_bf16 v[244:247], a[20:23], v[152:155], v[244:247]
    ds_read_b64_tr_b16 a[12:13], v15 offset:12288
    v_cvt_pk_bf16_f32 v214, v220, v221
    v_mfma_f32_16x16x32_bf16 v[244:247], a[16:19], v[136:139], v[244:247]
    ds_read_b64_tr_b16 a[14:15], v15 offset:14336
    s_waitcnt lgkmcnt(8)
    v_mfma_f32_16x16x32_bf16 v[244:247], a[32:35], v[200:203], v[244:247]
    ds_read_b64_tr_b16 a[16:17], v15 offset:16384
    v_cvt_pk_bf16_f32 v215, v222, v223
    v_mfma_f32_16x16x32_bf16 v[244:247], a[36:39], v[216:219], v[244:247]
    ds_read_b64_tr_b16 a[18:19], v15 offset:18432
    s_add_u32 s81, s81, 16384
    v_mfma_f32_16x16x32_bf16 v[244:247], a[40:43], v[232:235], v[244:247]
    ds_read_b64_tr_b16 a[20:21], v15 offset:20480
    buffer_store_dwordx4 v[212:215], v1, s[56:59], s81 offen sc1
    v_mfma_f32_16x16x32_bf16 v[244:247], a[44:47], v[248:251], v[244:247]
    ds_read_b64_tr_b16 a[22:23], v15 offset:22528
    v_mfma_f32_16x16x32_bf16 v[228:231], a[44:47], v[240:243], v[228:231]
    ds_read_b64_tr_b16 a[24:25], v15 offset:24576
    v_mfma_f32_16x16x32_bf16 v[228:231], a[40:43], v[224:227], v[228:231]
    ds_read_b64_tr_b16 a[26:27], v15 offset:26624
    v_mfma_f32_16x16x32_bf16 v[228:231], a[36:39], v[208:211], v[228:231]
    ds_read_b64_tr_b16 a[28:29], v15 offset:28672
    v_mfma_f32_16x16x32_bf16 v[228:231], a[32:35], v[192:195], v[228:231]
    ds_read_b64_tr_b16 a[30:31], v15 offset:30720
    s_waitcnt vmcnt(32) lgkmcnt(8)
    v_mfma_f32_16x16x32_bf16 v[236:239], a[0:3], v[128:131], 0
    s_barrier
    ds_read_b64_tr_b16 a[32:33], v12 offset:32768
    v_mfma_f32_16x16x32_bf16 v[236:239], a[4:7], v[144:147], v[236:239]
    ds_read_b64_tr_b16 a[34:35], v12 offset:34816
    s_add_u32 m0, s67, 32768
    v_mfma_f32_16x16x32_bf16 v[236:239], a[8:11], v[160:163], v[236:239]
    ds_read_b64_tr_b16 a[36:37], v12 offset:36864
    v_mfma_f32_16x16x32_bf16 v[236:239], a[12:15], v[176:179], v[236:239]
    ds_read_b64_tr_b16 a[38:39], v12 offset:38912
    v_cvt_pk_bf16_f32 v228, v228, v229
    v_mfma_f32_16x16x32_bf16 v[252:255], a[12:15], v[184:187], 0
    ds_read_b64_tr_b16 a[40:41], v12 offset:40960
    v_cvt_pk_bf16_f32 v229, v230, v231
    v_mfma_f32_16x16x32_bf16 v[252:255], a[8:11], v[168:171], v[252:255]
    ds_read_b64_tr_b16 a[42:43], v12 offset:43008
    v_cvt_pk_bf16_f32 v244, v244, v245
    v_mfma_f32_16x16x32_bf16 v[252:255], a[4:7], v[152:155], v[252:255]
    ds_read_b64_tr_b16 a[44:45], v12 offset:45056
    v_cvt_pk_bf16_f32 v245, v246, v247
    v_mfma_f32_16x16x32_bf16 v[252:255], a[0:3], v[136:139], v[252:255]
    ds_read_b64_tr_b16 a[46:47], v12 offset:47104
    s_waitcnt lgkmcnt(8)
    v_mfma_f32_16x16x32_bf16 v[252:255], a[16:19], v[200:203], v[252:255]
    ds_read_b64_tr_b16 a[0:1], v12 offset:49152
    buffer_load_dwordx4 v32, s[48:51], s78 offen offset:0 sc1 lds
    v_mfma_f32_16x16x32_bf16 v[252:255], a[20:23], v[216:219], v[252:255]
    ds_read_b64_tr_b16 a[2:3], v12 offset:51200
    v_mfma_f32_16x16x32_bf16 v[252:255], a[24:27], v[232:235], v[252:255]
    ds_read_b64_tr_b16 a[4:5], v12 offset:53248
    v_mfma_f32_16x16x32_bf16 v[252:255], a[28:31], v[248:251], v[252:255]
    ds_read_b64_tr_b16 a[6:7], v12 offset:55296
    v_mfma_f32_16x16x32_bf16 v[236:239], a[28:31], v[240:243], v[236:239]
    ds_read_b64_tr_b16 a[8:9], v12 offset:57344
    v_mfma_f32_16x16x32_bf16 v[236:239], a[24:27], v[224:227], v[236:239]
    ds_read_b64_tr_b16 a[10:11], v12 offset:59392
    buffer_load_dwordx4 v33, s[48:51], s78 offen offset:1024 sc1 lds
    v_mfma_f32_16x16x32_bf16 v[236:239], a[20:23], v[208:211], v[236:239]
    ds_read_b64_tr_b16 a[12:13], v12 offset:61440
    v_mfma_f32_16x16x32_bf16 v[236:239], a[16:19], v[192:195], v[236:239]
    ds_read_b64_tr_b16 a[14:15], v12 offset:63488
    s_waitcnt lgkmcnt(8)
    v_mfma_f32_16x16x32_bf16 v[196:199], a[32:35], v[128:131], 0
    ds_read_b64_tr_b16 a[16:17], v13 offset:32768
    v_mfma_f32_16x16x32_bf16 v[196:199], a[36:39], v[144:147], v[196:199]
    ds_read_b64_tr_b16 a[18:19], v13 offset:34816
    v_mfma_f32_16x16x32_bf16 v[196:199], a[40:43], v[160:163], v[196:199]
    ds_read_b64_tr_b16 a[20:21], v13 offset:36864
    v_mfma_f32_16x16x32_bf16 v[196:199], a[44:47], v[176:179], v[196:199]
    ds_read_b64_tr_b16 a[22:23], v13 offset:38912
    buffer_load_dwordx4 v34, s[48:51], s78 offen offset:2048 sc1 lds
    v_mfma_f32_16x16x32_bf16 v[212:215], a[44:47], v[184:187], 0
    ds_read_b64_tr_b16 a[24:25], v13 offset:40960
    v_cvt_pk_bf16_f32 v230, v236, v237
    v_mfma_f32_16x16x32_bf16 v[212:215], a[40:43], v[168:171], v[212:215]
    ds_read_b64_tr_b16 a[26:27], v13 offset:43008
    v_cvt_pk_bf16_f32 v231, v238, v239
    v_mfma_f32_16x16x32_bf16 v[212:215], a[36:39], v[152:155], v[212:215]
    ds_read_b64_tr_b16 a[28:29], v13 offset:45056
    s_add_u32 s81, s81, 16384
    v_mfma_f32_16x16x32_bf16 v[212:215], a[32:35], v[136:139], v[212:215]
    ds_read_b64_tr_b16 a[30:31], v13 offset:47104
    s_waitcnt lgkmcnt(8)
    v_mfma_f32_16x16x32_bf16 v[212:215], a[0:3], v[200:203], v[212:215]
    ds_read_b64_tr_b16 a[32:33], v13 offset:49152
    buffer_store_dwordx4 v[228:231], v1, s[56:59], s81 offen sc1
    v_mfma_f32_16x16x32_bf16 v[212:215], a[4:7], v[216:219], v[212:215]
    ds_read_b64_tr_b16 a[34:35], v13 offset:51200
    buffer_load_dwordx4 v35, s[48:51], s78 offen offset:3072 sc1 lds
    v_mfma_f32_16x16x32_bf16 v[212:215], a[8:11], v[232:235], v[212:215]
    ds_read_b64_tr_b16 a[36:37], v13 offset:53248
    s_add_u32 m0, s67, 49152
    v_mfma_f32_16x16x32_bf16 v[212:215], a[12:15], v[248:251], v[212:215]
    ds_read_b64_tr_b16 a[38:39], v13 offset:55296
    v_cvt_pk_bf16_f32 v246, v252, v253
    v_mfma_f32_16x16x32_bf16 v[196:199], a[12:15], v[240:243], v[196:199]
    ds_read_b64_tr_b16 a[40:41], v13 offset:57344
    s_add_u32 s68, s78, 114688
    v_mfma_f32_16x16x32_bf16 v[196:199], a[8:11], v[224:227], v[196:199]
    ds_read_b64_tr_b16 a[42:43], v13 offset:59392
    v_cvt_pk_bf16_f32 v247, v254, v255
    v_mfma_f32_16x16x32_bf16 v[196:199], a[4:7], v[208:211], v[196:199]
    ds_read_b64_tr_b16 a[44:45], v13 offset:61440
    s_add_u32 s81, s81, 16384
    v_mfma_f32_16x16x32_bf16 v[196:199], a[0:3], v[192:195], v[196:199]
    ds_read_b64_tr_b16 a[46:47], v13 offset:63488
    s_waitcnt lgkmcnt(8)
    v_mfma_f32_16x16x32_bf16 v[204:207], a[16:19], v[128:131], 0
    ds_read_b64_tr_b16 a[0:1], v14 offset:32768
    buffer_load_dwordx4 v32, s[48:51], s68 offen offset:0 sc1 lds
    v_mfma_f32_16x16x32_bf16 v[204:207], a[20:23], v[144:147], v[204:207]
    ds_read_b64_tr_b16 a[2:3], v14 offset:34816
    buffer_store_dwordx4 v[244:247], v1, s[56:59], s81 offen sc1
    v_mfma_f32_16x16x32_bf16 v[204:207], a[24:27], v[160:163], v[204:207]
    ds_read_b64_tr_b16 a[4:5], v14 offset:36864
    v_mfma_f32_16x16x32_bf16 v[204:207], a[28:31], v[176:179], v[204:207]
    ds_read_b64_tr_b16 a[6:7], v14 offset:38912
    buffer_load_dwordx4 v33, s[48:51], s68 offen offset:1024 sc1 lds
    v_mfma_f32_16x16x32_bf16 v[220:223], a[28:31], v[184:187], 0
    ds_read_b64_tr_b16 a[8:9], v14 offset:40960
    v_cvt_pk_bf16_f32 v196, v196, v197
    v_mfma_f32_16x16x32_bf16 v[220:223], a[24:27], v[168:171], v[220:223]
    ds_read_b64_tr_b16 a[10:11], v14 offset:43008
    v_cvt_pk_bf16_f32 v197, v198, v199
    v_mfma_f32_16x16x32_bf16 v[220:223], a[20:23], v[152:155], v[220:223]
    ds_read_b64_tr_b16 a[12:13], v14 offset:45056
    buffer_load_dwordx4 v34, s[48:51], s68 offen offset:2048 sc1 lds
    v_mfma_f32_16x16x32_bf16 v[220:223], a[16:19], v[136:139], v[220:223]
    ds_read_b64_tr_b16 a[14:15], v14 offset:47104
    s_waitcnt lgkmcnt(8)
    v_mfma_f32_16x16x32_bf16 v[220:223], a[32:35], v[200:203], v[220:223]
    ds_read_b64_tr_b16 a[16:17], v14 offset:49152
    v_cvt_pk_bf16_f32 v212, v212, v213
    v_mfma_f32_16x16x32_bf16 v[220:223], a[36:39], v[216:219], v[220:223]
    ds_read_b64_tr_b16 a[18:19], v14 offset:51200
    buffer_load_dwordx4 v35, s[48:51], s68 offen offset:3072 sc1 lds
    v_mfma_f32_16x16x32_bf16 v[220:223], a[40:43], v[232:235], v[220:223]
    ds_read_b64_tr_b16 a[20:21], v14 offset:53248
    v_cvt_pk_bf16_f32 v213, v214, v215
    v_mfma_f32_16x16x32_bf16 v[220:223], a[44:47], v[248:251], v[220:223]
    ds_read_b64_tr_b16 a[22:23], v14 offset:55296
    v_mfma_f32_16x16x32_bf16 v[204:207], a[44:47], v[240:243], v[204:207]
    ds_read_b64_tr_b16 a[24:25], v14 offset:57344
    v_mfma_f32_16x16x32_bf16 v[204:207], a[40:43], v[224:227], v[204:207]
    ds_read_b64_tr_b16 a[26:27], v14 offset:59392
    v_mfma_f32_16x16x32_bf16 v[204:207], a[36:39], v[208:211], v[204:207]
    ds_read_b64_tr_b16 a[28:29], v14 offset:61440
    v_mfma_f32_16x16x32_bf16 v[204:207], a[32:35], v[192:195], v[204:207]
    ds_read_b64_tr_b16 a[30:31], v14 offset:63488
    s_waitcnt lgkmcnt(8)
    v_mfma_f32_16x16x32_bf16 v[228:231], a[0:3], v[128:131], 0
    ds_read_b64_tr_b16 a[32:33], v15 offset:32768
    v_mfma_f32_16x16x32_bf16 v[228:231], a[4:7], v[144:147], v[228:231]
    ds_read_b64_tr_b16 a[34:35], v15 offset:34816
    v_mfma_f32_16x16x32_bf16 v[228:231], a[8:11], v[160:163], v[228:231]
    ds_read_b64_tr_b16 a[36:37], v15 offset:36864
    v_mfma_f32_16x16x32_bf16 v[228:231], a[12:15], v[176:179], v[228:231]
    ds_read_b64_tr_b16 a[38:39], v15 offset:38912
    v_cvt_pk_bf16_f32 v198, v204, v205
    v_mfma_f32_16x16x32_bf16 v[244:247], a[12:15], v[184:187], 0
    ds_read_b64_tr_b16 a[40:41], v15 offset:40960
    v_cvt_pk_bf16_f32 v199, v206, v207
    v_mfma_f32_16x16x32_bf16 v[244:247], a[8:11], v[168:171], v[244:247]
    ds_read_b64_tr_b16 a[42:43], v15 offset:43008
    buffer_store_dwordx4 v[196:199], v1, s[56:59], s82 offen sc1
    v_mfma_f32_16x16x32_bf16 v[244:247], a[4:7], v[152:155], v[244:247]
    ds_read_b64_tr_b16 a[44:45], v15 offset:45056
    v_cvt_pk_bf16_f32 v214, v220, v221
    v_mfma_f32_16x16x32_bf16 v[244:247], a[0:3], v[136:139], v[244:247]
    ds_read_b64_tr_b16 a[46:47], v15 offset:47104
    s_waitcnt lgkmcnt(8)
    v_mfma_f32_16x16x32_bf16 v[244:247], a[16:19], v[200:203], v[244:247]
    ds_read_b64_tr_b16 a[0:1], v15 offset:49152
    v_cvt_pk_bf16_f32 v215, v222, v223
    v_mfma_f32_16x16x32_bf16 v[244:247], a[20:23], v[216:219], v[244:247]
    ds_read_b64_tr_b16 a[2:3], v15 offset:51200
    s_add_u32 s82, s82, 16384
    v_mfma_f32_16x16x32_bf16 v[244:247], a[24:27], v[232:235], v[244:247]
    ds_read_b64_tr_b16 a[4:5], v15 offset:53248
    buffer_store_dwordx4 v[212:215], v1, s[56:59], s82 offen sc1
    v_mfma_f32_16x16x32_bf16 v[244:247], a[28:31], v[248:251], v[244:247]
    ds_read_b64_tr_b16 a[6:7], v15 offset:55296
    v_mfma_f32_16x16x32_bf16 v[228:231], a[28:31], v[240:243], v[228:231]
    ds_read_b64_tr_b16 a[8:9], v15 offset:57344
    v_mfma_f32_16x16x32_bf16 v[228:231], a[24:27], v[224:227], v[228:231]
    ds_read_b64_tr_b16 a[10:11], v15 offset:59392
    v_mfma_f32_16x16x32_bf16 v[228:231], a[20:23], v[208:211], v[228:231]
    ds_read_b64_tr_b16 a[12:13], v15 offset:61440
    v_mfma_f32_16x16x32_bf16 v[228:231], a[16:19], v[192:195], v[228:231]
    ds_read_b64_tr_b16 a[14:15], v15 offset:63488
    s_waitcnt vmcnt(27) lgkmcnt(8)
    v_mfma_f32_16x16x32_bf16 v[236:239], a[32:35], v[128:131], 0
    s_barrier
    ds_read_b64_tr_b16 a[16:17], v16 offset:0
    s_waitcnt vmcnt(5)
    buffer_store_byte v29, v28, s[56:59], s90 offen offset:0 sc1
    v_mfma_f32_16x16x32_bf16 v[236:239], a[36:39], v[144:147], v[236:239]
    ds_read_b64_tr_b16 a[18:19], v16 offset:2048
    v_accvgpr_read_b32 v36, a52
    v_mfma_f32_16x16x32_bf16 v[236:239], a[40:43], v[160:163], v[236:239]
    ds_read_b64_tr_b16 a[20:21], v16 offset:4096
    v_mfma_f32_16x16x32_bf16 v[236:239], a[44:47], v[176:179], v[236:239]
    ds_read_b64_tr_b16 a[22:23], v16 offset:6144
    v_cvt_pk_bf16_f32 v228, v228, v229
    v_mfma_f32_16x16x32_bf16 v[252:255], a[44:47], v[184:187], 0
    ds_read_b64_tr_b16 a[24:25], v16 offset:8192
    v_accvgpr_read_b32 v37, a53
    v_mfma_f32_16x16x32_bf16 v[252:255], a[40:43], v[168:171], v[252:255]
    ds_read_b64_tr_b16 a[26:27], v16 offset:10240
    v_cvt_pk_bf16_f32 v229, v230, v231
    v_mfma_f32_16x16x32_bf16 v[252:255], a[36:39], v[152:155], v[252:255]
    ds_read_b64_tr_b16 a[28:29], v16 offset:12288
    v_cvt_pk_bf16_f32 v244, v244, v245
    v_mfma_f32_16x16x32_bf16 v[252:255], a[32:35], v[136:139], v[252:255]
    ds_read_b64_tr_b16 a[30:31], v16 offset:14336
    s_waitcnt lgkmcnt(8)
    v_mfma_f32_16x16x32_bf16 v[252:255], a[0:3], v[200:203], v[252:255]
    ds_read_b64_tr_b16 a[32:33], v16 offset:16384
    v_accvgpr_read_b32 v38, a54
    v_mfma_f32_16x16x32_bf16 v[252:255], a[4:7], v[216:219], v[252:255]
    ds_read_b64_tr_b16 a[34:35], v16 offset:18432
    v_cvt_pk_bf16_f32 v245, v246, v247
    v_mfma_f32_16x16x32_bf16 v[252:255], a[8:11], v[232:235], v[252:255]
    ds_read_b64_tr_b16 a[36:37], v16 offset:20480
    v_mfma_f32_16x16x32_bf16 v[252:255], a[12:15], v[248:251], v[252:255]
    ds_read_b64_tr_b16 a[38:39], v16 offset:22528
    v_accvgpr_read_b32 v39, a55
    v_mfma_f32_16x16x32_bf16 v[236:239], a[12:15], v[240:243], v[236:239]
    ds_read_b64_tr_b16 a[40:41], v16 offset:24576
    v_mfma_f32_16x16x32_bf16 v[236:239], a[8:11], v[224:227], v[236:239]
    ds_read_b64_tr_b16 a[42:43], v16 offset:26624
    v_mfma_f32_16x16x32_bf16 v[236:239], a[4:7], v[208:211], v[236:239]
    ds_read_b64_tr_b16 a[44:45], v16 offset:28672
    s_add_u32 m0, s67, 65536
    v_mfma_f32_16x16x32_bf16 v[236:239], a[0:3], v[192:195], v[236:239]
    ds_read_b64_tr_b16 a[46:47], v16 offset:30720
    s_waitcnt lgkmcnt(8)
    v_mfma_f32_16x16x32_bf16 v[196:199], a[16:19], v[128:131], 0
    ds_read_b64_tr_b16 a[0:1], v17 offset:0
    v_mfma_f32_16x16x32_bf16 v[196:199], a[20:23], v[144:147], v[196:199]
    ds_read_b64_tr_b16 a[2:3], v17 offset:2048
    buffer_load_dwordx4 v36, s[52:55], 0 offen offset:0 sc1 lds
    v_mfma_f32_16x16x32_bf16 v[196:199], a[24:27], v[160:163], v[196:199]
    ds_read_b64_tr_b16 a[4:5], v17 offset:4096
    v_mfma_f32_16x16x32_bf16 v[196:199], a[28:31], v[176:179], v[196:199]
    ds_read_b64_tr_b16 a[6:7], v17 offset:6144
    v_cvt_pk_bf16_f32 v230, v236, v237
    v_mfma_f32_16x16x32_bf16 v[212:215], a[28:31], v[184:187], 0
    ds_read_b64_tr_b16 a[8:9], v17 offset:8192
    v_cvt_pk_bf16_f32 v231, v238, v239
    v_mfma_f32_16x16x32_bf16 v[212:215], a[24:27], v[168:171], v[212:215]
    ds_read_b64_tr_b16 a[10:11], v17 offset:10240
    buffer_load_dwordx4 v37, s[52:55], 0 offen offset:1024 sc1 lds
    v_mfma_f32_16x16x32_bf16 v[212:215], a[20:23], v[152:155], v[212:215]
    ds_read_b64_tr_b16 a[12:13], v17 offset:12288
    s_add_u32 s82, s82, 16384
    v_mfma_f32_16x16x32_bf16 v[212:215], a[16:19], v[136:139], v[212:215]
    ds_read_b64_tr_b16 a[14:15], v17 offset:14336
    s_waitcnt lgkmcnt(8)
    v_mfma_f32_16x16x32_bf16 v[212:215], a[32:35], v[200:203], v[212:215]
    ds_read_b64_tr_b16 a[16:17], v17 offset:16384
    buffer_load_dwordx4 v38, s[52:55], 0 offen offset:2048 sc1 lds
    v_mfma_f32_16x16x32_bf16 v[212:215], a[36:39], v[216:219], v[212:215]
    ds_read_b64_tr_b16 a[18:19], v17 offset:18432
    buffer_store_dwordx4 v[228:231], v1, s[56:59], s82 offen sc1
    v_mfma_f32_16x16x32_bf16 v[212:215], a[40:43], v[232:235], v[212:215]
    ds_read_b64_tr_b16 a[20:21], v17 offset:20480
    v_cvt_pk_bf16_f32 v246, v252, v253
    v_mfma_f32_16x16x32_bf16 v[212:215], a[44:47], v[248:251], v[212:215]
    ds_read_b64_tr_b16 a[22:23], v17 offset:22528
    buffer_load_dwordx4 v39, s[52:55], 0 offen offset:3072 sc1 lds
    v_mfma_f32_16x16x32_bf16 v[196:199], a[44:47], v[240:243], v[196:199]
    ds_read_b64_tr_b16 a[24:25], v17 offset:24576
    s_add_u32 m0, s67, 81920
    v_mfma_f32_16x16x32_bf16 v[196:199], a[40:43], v[224:227], v[196:199]
    ds_read_b64_tr_b16 a[26:27], v17 offset:26624
    v_cvt_pk_bf16_f32 v247, v254, v255
    v_mfma_f32_16x16x32_bf16 v[196:199], a[36:39], v[208:211], v[196:199]
    ds_read_b64_tr_b16 a[28:29], v17 offset:28672
    s_mov_b32 s68, 28672
    v_mfma_f32_16x16x32_bf16 v[196:199], a[32:35], v[192:195], v[196:199]
    ds_read_b64_tr_b16 a[30:31], v17 offset:30720
    s_waitcnt lgkmcnt(8)
    v_mfma_f32_16x16x32_bf16 v[204:207], a[0:3], v[128:131], 0
    ds_read_b64_tr_b16 a[32:33], v18 offset:0
    s_add_u32 s82, s82, 16384
    v_mfma_f32_16x16x32_bf16 v[204:207], a[4:7], v[144:147], v[204:207]
    ds_read_b64_tr_b16 a[34:35], v18 offset:2048
    buffer_load_dwordx4 v36, s[52:55], s68 offen offset:0 sc1 lds
    v_mfma_f32_16x16x32_bf16 v[204:207], a[8:11], v[160:163], v[204:207]
    ds_read_b64_tr_b16 a[36:37], v18 offset:4096
    buffer_store_dwordx4 v[244:247], v1, s[56:59], s82 offen sc1
    v_mfma_f32_16x16x32_bf16 v[204:207], a[12:15], v[176:179], v[204:207]
    ds_read_b64_tr_b16 a[38:39], v18 offset:6144
    v_cvt_pk_bf16_f32 v196, v196, v197
    v_mfma_f32_16x16x32_bf16 v[220:223], a[12:15], v[184:187], 0
    ds_read_b64_tr_b16 a[40:41], v18 offset:8192
    v_cvt_pk_bf16_f32 v197, v198, v199
    v_mfma_f32_16x16x32_bf16 v[220:223], a[8:11], v[168:171], v[220:223]
    ds_read_b64_tr_b16 a[42:43], v18 offset:10240
    buffer_load_dwordx4 v37, s[52:55], s68 offen offset:1024 sc1 lds
    v_mfma_f32_16x16x32_bf16 v[220:223], a[4:7], v[152:155], v[220:223]
    ds_read_b64_tr_b16 a[44:45], v18 offset:12288
    v_cvt_pk_bf16_f32 v212, v212, v213
    v_mfma_f32_16x16x32_bf16 v[220:223], a[0:3], v[136:139], v[220:223]
    ds_read_b64_tr_b16 a[46:47], v18 offset:14336
    s_waitcnt lgkmcnt(8)
    v_mfma_f32_16x16x32_bf16 v[220:223], a[16:19], v[200:203], v[220:223]
    ds_read_b64_tr_b16 a[0:1], v18 offset:16384
    buffer_load_dwordx4 v38, s[52:55], s68 offen offset:2048 sc1 lds
    v_mfma_f32_16x16x32_bf16 v[220:223], a[20:23], v[216:219], v[220:223]
    ds_read_b64_tr_b16 a[2:3], v18 offset:18432
    v_cvt_pk_bf16_f32 v213, v214, v215
    v_mfma_f32_16x16x32_bf16 v[220:223], a[24:27], v[232:235], v[220:223]
    ds_read_b64_tr_b16 a[4:5], v18 offset:20480
    v_mfma_f32_16x16x32_bf16 v[220:223], a[28:31], v[248:251], v[220:223]
    ds_read_b64_tr_b16 a[6:7], v18 offset:22528
    buffer_load_dwordx4 v39, s[52:55], s68 offen offset:3072 sc1 lds
    v_mfma_f32_16x16x32_bf16 v[204:207], a[28:31], v[240:243], v[204:207]
    ds_read_b64_tr_b16 a[8:9], v18 offset:24576
    v_mfma_f32_16x16x32_bf16 v[204:207], a[24:27], v[224:227], v[204:207]
    ds_read_b64_tr_b16 a[10:11], v18 offset:26624
    v_mfma_f32_16x16x32_bf16 v[204:207], a[20:23], v[208:211], v[204:207]
    ds_read_b64_tr_b16 a[12:13], v18 offset:28672
    v_mfma_f32_16x16x32_bf16 v[204:207], a[16:19], v[192:195], v[204:207]
    ds_read_b64_tr_b16 a[14:15], v18 offset:30720
    s_waitcnt lgkmcnt(8)
    v_mfma_f32_16x16x32_bf16 v[228:231], a[32:35], v[128:131], 0
    ds_read_b64_tr_b16 a[16:17], v19 offset:0
    v_mfma_f32_16x16x32_bf16 v[228:231], a[36:39], v[144:147], v[228:231]
    ds_read_b64_tr_b16 a[18:19], v19 offset:2048
    v_mfma_f32_16x16x32_bf16 v[228:231], a[40:43], v[160:163], v[228:231]
    ds_read_b64_tr_b16 a[20:21], v19 offset:4096
    v_mfma_f32_16x16x32_bf16 v[228:231], a[44:47], v[176:179], v[228:231]
    ds_read_b64_tr_b16 a[22:23], v19 offset:6144
    v_cvt_pk_bf16_f32 v198, v204, v205
    v_mfma_f32_16x16x32_bf16 v[244:247], a[44:47], v[184:187], 0
    ds_read_b64_tr_b16 a[24:25], v19 offset:8192
    v_cvt_pk_bf16_f32 v199, v206, v207
    v_mfma_f32_16x16x32_bf16 v[244:247], a[40:43], v[168:171], v[244:247]
    ds_read_b64_tr_b16 a[26:27], v19 offset:10240
    buffer_store_dwordx4 v[196:199], v1, s[56:59], s83 offen sc1
    v_mfma_f32_16x16x32_bf16 v[244:247], a[36:39], v[152:155], v[244:247]
    ds_read_b64_tr_b16 a[28:29], v19 offset:12288
    v_cvt_pk_bf16_f32 v214, v220, v221
    v_mfma_f32_16x16x32_bf16 v[244:247], a[32:35], v[136:139], v[244:247]
    ds_read_b64_tr_b16 a[30:31], v19 offset:14336
    s_waitcnt lgkmcnt(8)
    v_mfma_f32_16x16x32_bf16 v[244:247], a[0:3], v[200:203], v[244:247]
    ds_read_b64_tr_b16 a[32:33], v19 offset:16384
    v_cvt_pk_bf16_f32 v215, v222, v223
    v_mfma_f32_16x16x32_bf16 v[244:247], a[4:7], v[216:219], v[244:247]
    ds_read_b64_tr_b16 a[34:35], v19 offset:18432
    s_add_u32 s83, s83, 16384
    v_mfma_f32_16x16x32_bf16 v[244:247], a[8:11], v[232:235], v[244:247]
    ds_read_b64_tr_b16 a[36:37], v19 offset:20480
    buffer_store_dwordx4 v[212:215], v1, s[56:59], s83 offen sc1
    v_mfma_f32_16x16x32_bf16 v[244:247], a[12:15], v[248:251], v[244:247]
    ds_read_b64_tr_b16 a[38:39], v19 offset:22528
    v_mfma_f32_16x16x32_bf16 v[228:231], a[12:15], v[240:243], v[228:231]
    ds_read_b64_tr_b16 a[40:41], v19 offset:24576
    v_mfma_f32_16x16x32_bf16 v[228:231], a[8:11], v[224:227], v[228:231]
    ds_read_b64_tr_b16 a[42:43], v19 offset:26624
    v_mfma_f32_16x16x32_bf16 v[228:231], a[4:7], v[208:211], v[228:231]
    ds_read_b64_tr_b16 a[44:45], v19 offset:28672
    v_mfma_f32_16x16x32_bf16 v[228:231], a[0:3], v[192:195], v[228:231]
    ds_read_b64_tr_b16 a[46:47], v19 offset:30720
    s_waitcnt lgkmcnt(8)
    v_mfma_f32_16x16x32_bf16 v[236:239], a[16:19], v[128:131], 0
    s_barrier
    ds_read_b64_tr_b16 a[0:1], v8 offset:0
    v_mfma_f32_16x16x32_bf16 v[236:239], a[20:23], v[144:147], v[236:239]
    ds_read_b64_tr_b16 a[2:3], v8 offset:2048
    s_add_u32 m0, s67, 98304
    v_mfma_f32_16x16x32_bf16 v[236:239], a[24:27], v[160:163], v[236:239]
    ds_read_b64_tr_b16 a[4:5], v8 offset:4096
    v_mfma_f32_16x16x32_bf16 v[236:239], a[28:31], v[176:179], v[236:239]
    ds_read_b64_tr_b16 a[6:7], v8 offset:6144
    v_cvt_pk_bf16_f32 v228, v228, v229
    v_mfma_f32_16x16x32_bf16 v[252:255], a[28:31], v[184:187], 0
    ds_read_b64_tr_b16 a[8:9], v8 offset:8192
    v_cvt_pk_bf16_f32 v229, v230, v231
    v_mfma_f32_16x16x32_bf16 v[252:255], a[24:27], v[168:171], v[252:255]
    ds_read_b64_tr_b16 a[10:11], v8 offset:10240
    v_cvt_pk_bf16_f32 v244, v244, v245
    v_mfma_f32_16x16x32_bf16 v[252:255], a[20:23], v[152:155], v[252:255]
    ds_read_b64_tr_b16 a[12:13], v8 offset:12288
    s_mov_b32 s68, 57344
    v_mfma_f32_16x16x32_bf16 v[252:255], a[16:19], v[136:139], v[252:255]
    ds_read_b64_tr_b16 a[14:15], v8 offset:14336
    s_waitcnt lgkmcnt(8)
    v_mfma_f32_16x16x32_bf16 v[252:255], a[32:35], v[200:203], v[252:255]
    ds_read_b64_tr_b16 a[16:17], v8 offset:16384
    v_cvt_pk_bf16_f32 v245, v246, v247
    v_mfma_f32_16x16x32_bf16 v[252:255], a[36:39], v[216:219], v[252:255]
    ds_read_b64_tr_b16 a[18:19], v8 offset:18432
    v_mfma_f32_16x16x32_bf16 v[252:255], a[40:43], v[232:235], v[252:255]
    ds_read_b64_tr_b16 a[20:21], v8 offset:20480
    v_mfma_f32_16x16x32_bf16 v[252:255], a[44:47], v[248:251], v[252:255]
    ds_read_b64_tr_b16 a[22:23], v8 offset:22528
    buffer_load_dwordx4 v36, s[52:55], s68 offen offset:0 sc1 lds
    v_mfma_f32_16x16x32_bf16 v[236:239], a[44:47], v[240:243], v[236:239]
    ds_read_b64_tr_b16 a[24:25], v8 offset:24576
    v_mfma_f32_16x16x32_bf16 v[236:239], a[40:43], v[224:227], v[236:239]
    ds_read_b64_tr_b16 a[26:27], v8 offset:26624
    v_mfma_f32_16x16x32_bf16 v[236:239], a[36:39], v[208:211], v[236:239]
    ds_read_b64_tr_b16 a[28:29], v8 offset:28672
    v_mfma_f32_16x16x32_bf16 v[236:239], a[32:35], v[192:195], v[236:239]
    ds_read_b64_tr_b16 a[30:31], v8 offset:30720
    s_waitcnt lgkmcnt(8)
    v_mfma_f32_16x16x32_bf16 v[196:199], a[0:3], v[128:131], 0
    ds_read_b64_tr_b16 a[32:33], v9 offset:0
    buffer_load_dwordx4 v37, s[52:55], s68 offen offset:1024 sc1 lds
    v_mfma_f32_16x16x32_bf16 v[196:199], a[4:7], v[144:147], v[196:199]
    ds_read_b64_tr_b16 a[34:35], v9 offset:2048
    v_mfma_f32_16x16x32_bf16 v[196:199], a[8:11], v[160:163], v[196:199]
    ds_read_b64_tr_b16 a[36:37], v9 offset:4096
    v_mfma_f32_16x16x32_bf16 v[196:199], a[12:15], v[176:179], v[196:199]
    ds_read_b64_tr_b16 a[38:39], v9 offset:6144
    v_cvt_pk_bf16_f32 v230, v236, v237
    v_mfma_f32_16x16x32_bf16 v[212:215], a[12:15], v[184:187], 0
    ds_read_b64_tr_b16 a[40:41], v9 offset:8192
    v_cvt_pk_bf16_f32 v231, v238, v239
    v_mfma_f32_16x16x32_bf16 v[212:215], a[8:11], v[168:171], v[212:215]
    ds_read_b64_tr_b16 a[42:43], v9 offset:10240
    buffer_load_dwordx4 v38, s[52:55], s68 offen offset:2048 sc1 lds
    v_mfma_f32_16x16x32_bf16 v[212:215], a[4:7], v[152:155], v[212:215]
    ds_read_b64_tr_b16 a[44:45], v9 offset:12288
    s_add_u32 s83, s83, 16384
    v_mfma_f32_16x16x32_bf16 v[212:215], a[0:3], v[136:139], v[212:215]
    ds_read_b64_tr_b16 a[46:47], v9 offset:14336
    s_waitcnt lgkmcnt(8)
    v_mfma_f32_16x16x32_bf16 v[212:215], a[16:19], v[200:203], v[212:215]
    ds_read_b64_tr_b16 a[0:1], v9 offset:16384
    buffer_store_dwordx4 v[228:231], v1, s[56:59], s83 offen sc1
    v_mfma_f32_16x16x32_bf16 v[212:215], a[20:23], v[216:219], v[212:215]
    ds_read_b64_tr_b16 a[2:3], v9 offset:18432
    v_cvt_pk_bf16_f32 v246, v252, v253
    v_mfma_f32_16x16x32_bf16 v[212:215], a[24:27], v[232:235], v[212:215]
    ds_read_b64_tr_b16 a[4:5], v9 offset:20480
    buffer_load_dwordx4 v39, s[52:55], s68 offen offset:3072 sc1 lds
    v_mfma_f32_16x16x32_bf16 v[212:215], a[28:31], v[248:251], v[212:215]
    ds_read_b64_tr_b16 a[6:7], v9 offset:22528
    s_add_u32 m0, s67, 114688
    v_mfma_f32_16x16x32_bf16 v[196:199], a[28:31], v[240:243], v[196:199]
    ds_read_b64_tr_b16 a[8:9], v9 offset:24576
    v_cvt_pk_bf16_f32 v247, v254, v255
    v_mfma_f32_16x16x32_bf16 v[196:199], a[24:27], v[224:227], v[196:199]
    ds_read_b64_tr_b16 a[10:11], v9 offset:26624
    s_mov_b32 s68, 86016
    v_mfma_f32_16x16x32_bf16 v[196:199], a[20:23], v[208:211], v[196:199]
    ds_read_b64_tr_b16 a[12:13], v9 offset:28672
    s_add_u32 s83, s83, 16384
    v_mfma_f32_16x16x32_bf16 v[196:199], a[16:19], v[192:195], v[196:199]
    ds_read_b64_tr_b16 a[14:15], v9 offset:30720
    s_waitcnt lgkmcnt(8)
    v_mfma_f32_16x16x32_bf16 v[204:207], a[32:35], v[128:131], 0
    ds_read_b64_tr_b16 a[16:17], v10 offset:0
    buffer_load_dwordx4 v36, s[52:55], s68 offen offset:0 sc1 lds
    v_mfma_f32_16x16x32_bf16 v[204:207], a[36:39], v[144:147], v[204:207]
    ds_read_b64_tr_b16 a[18:19], v10 offset:2048
    buffer_store_dwordx4 v[244:247], v1, s[56:59], s83 offen sc1
    v_mfma_f32_16x16x32_bf16 v[204:207], a[40:43], v[160:163], v[204:207]
    ds_read_b64_tr_b16 a[20:21], v10 offset:4096
    v_mfma_f32_16x16x32_bf16 v[204:207], a[44:47], v[176:179], v[204:207]
    ds_read_b64_tr_b16 a[22:23], v10 offset:6144
    v_cvt_pk_bf16_f32 v196, v196, v197
    v_mfma_f32_16x16x32_bf16 v[220:223], a[44:47], v[184:187], 0
    ds_read_b64_tr_b16 a[24:25], v10 offset:8192
    buffer_load_dwordx4 v37, s[52:55], s68 offen offset:1024 sc1 lds
    v_mfma_f32_16x16x32_bf16 v[220:223], a[40:43], v[168:171], v[220:223]
    ds_read_b64_tr_b16 a[26:27], v10 offset:10240
    v_cvt_pk_bf16_f32 v197, v198, v199
    v_mfma_f32_16x16x32_bf16 v[220:223], a[36:39], v[152:155], v[220:223]
    ds_read_b64_tr_b16 a[28:29], v10 offset:12288
    v_cvt_pk_bf16_f32 v212, v212, v213
    v_mfma_f32_16x16x32_bf16 v[220:223], a[32:35], v[136:139], v[220:223]
    ds_read_b64_tr_b16 a[30:31], v10 offset:14336
    s_waitcnt lgkmcnt(8)
    v_mfma_f32_16x16x32_bf16 v[220:223], a[0:3], v[200:203], v[220:223]
    ds_read_b64_tr_b16 a[32:33], v10 offset:16384
    buffer_load_dwordx4 v38, s[52:55], s68 offen offset:2048 sc1 lds
    v_mfma_f32_16x16x32_bf16 v[220:223], a[4:7], v[216:219], v[220:223]
    ds_read_b64_tr_b16 a[34:35], v10 offset:18432
    v_cvt_pk_bf16_f32 v213, v214, v215
    v_mfma_f32_16x16x32_bf16 v[220:223], a[8:11], v[232:235], v[220:223]
    ds_read_b64_tr_b16 a[36:37], v10 offset:20480
    buffer_load_dwordx4 v39, s[52:55], s68 offen offset:3072 sc1 lds
    v_mfma_f32_16x16x32_bf16 v[220:223], a[12:15], v[248:251], v[220:223]
    ds_read_b64_tr_b16 a[38:39], v10 offset:22528
    v_mfma_f32_16x16x32_bf16 v[204:207], a[12:15], v[240:243], v[204:207]
    ds_read_b64_tr_b16 a[40:41], v10 offset:24576
    v_mfma_f32_16x16x32_bf16 v[204:207], a[8:11], v[224:227], v[204:207]
    ds_read_b64_tr_b16 a[42:43], v10 offset:26624
    v_mfma_f32_16x16x32_bf16 v[204:207], a[4:7], v[208:211], v[204:207]
    ds_read_b64_tr_b16 a[44:45], v10 offset:28672
    v_mfma_f32_16x16x32_bf16 v[204:207], a[0:3], v[192:195], v[204:207]
    ds_read_b64_tr_b16 a[46:47], v10 offset:30720
    s_waitcnt lgkmcnt(8)
    v_mfma_f32_16x16x32_bf16 v[228:231], a[16:19], v[128:131], 0
    ds_read_b64_tr_b16 a[0:1], v11 offset:0
    v_mfma_f32_16x16x32_bf16 v[228:231], a[20:23], v[144:147], v[228:231]
    ds_read_b64_tr_b16 a[2:3], v11 offset:2048
    v_mfma_f32_16x16x32_bf16 v[228:231], a[24:27], v[160:163], v[228:231]
    ds_read_b64_tr_b16 a[4:5], v11 offset:4096
    v_mfma_f32_16x16x32_bf16 v[228:231], a[28:31], v[176:179], v[228:231]
    ds_read_b64_tr_b16 a[6:7], v11 offset:6144
    v_cvt_pk_bf16_f32 v198, v204, v205
    v_mfma_f32_16x16x32_bf16 v[244:247], a[28:31], v[184:187], 0
    ds_read_b64_tr_b16 a[8:9], v11 offset:8192
    v_cvt_pk_bf16_f32 v199, v206, v207
    v_mfma_f32_16x16x32_bf16 v[244:247], a[24:27], v[168:171], v[244:247]
    ds_read_b64_tr_b16 a[10:11], v11 offset:10240
    buffer_store_dwordx4 v[196:199], v1, s[56:59], s84 offen sc1
    v_mfma_f32_16x16x32_bf16 v[244:247], a[20:23], v[152:155], v[244:247]
    ds_read_b64_tr_b16 a[12:13], v11 offset:12288
    v_cvt_pk_bf16_f32 v214, v220, v221
    v_mfma_f32_16x16x32_bf16 v[244:247], a[16:19], v[136:139], v[244:247]
    ds_read_b64_tr_b16 a[14:15], v11 offset:14336
    s_waitcnt lgkmcnt(8)
    v_mfma_f32_16x16x32_bf16 v[244:247], a[32:35], v[200:203], v[244:247]
    ds_read_b64_tr_b16 a[16:17], v11 offset:16384
    v_cvt_pk_bf16_f32 v215, v222, v223
    v_mfma_f32_16x16x32_bf16 v[244:247], a[36:39], v[216:219], v[244:247]
    ds_read_b64_tr_b16 a[18:19], v11 offset:18432
    s_add_u32 s84, s84, 16384
    v_mfma_f32_16x16x32_bf16 v[244:247], a[40:43], v[232:235], v[244:247]
    ds_read_b64_tr_b16 a[20:21], v11 offset:20480
    buffer_store_dwordx4 v[212:215], v1, s[56:59], s84 offen sc1
    v_mfma_f32_16x16x32_bf16 v[244:247], a[44:47], v[248:251], v[244:247]
    ds_read_b64_tr_b16 a[22:23], v11 offset:22528
    v_mfma_f32_16x16x32_bf16 v[228:231], a[44:47], v[240:243], v[228:231]
    ds_read_b64_tr_b16 a[24:25], v11 offset:24576
    v_mfma_f32_16x16x32_bf16 v[228:231], a[40:43], v[224:227], v[228:231]
    ds_read_b64_tr_b16 a[26:27], v11 offset:26624
    v_mfma_f32_16x16x32_bf16 v[228:231], a[36:39], v[208:211], v[228:231]
    ds_read_b64_tr_b16 a[28:29], v11 offset:28672
    v_mfma_f32_16x16x32_bf16 v[228:231], a[32:35], v[192:195], v[228:231]
    ds_read_b64_tr_b16 a[30:31], v11 offset:30720
    s_waitcnt vmcnt(27) lgkmcnt(8)
    v_mfma_f32_16x16x32_bf16 v[236:239], a[0:3], v[128:131], 0
    s_barrier
    ds_read_b64_tr_b16 a[32:33], v8 offset:32768
    v_mfma_f32_16x16x32_bf16 v[236:239], a[4:7], v[144:147], v[236:239]
    ds_read_b64_tr_b16 a[34:35], v8 offset:34816
    s_add_u32 m0, s67, 131072
    v_mfma_f32_16x16x32_bf16 v[236:239], a[8:11], v[160:163], v[236:239]
    ds_read_b64_tr_b16 a[36:37], v8 offset:36864
    v_mfma_f32_16x16x32_bf16 v[236:239], a[12:15], v[176:179], v[236:239]
    ds_read_b64_tr_b16 a[38:39], v8 offset:38912
    v_cvt_pk_bf16_f32 v228, v228, v229
    v_mfma_f32_16x16x32_bf16 v[252:255], a[12:15], v[184:187], 0
    ds_read_b64_tr_b16 a[40:41], v8 offset:40960
    v_cvt_pk_bf16_f32 v229, v230, v231
    s_waitcnt vmcnt(5)
    buffer_store_byte v29, v28, s[56:59], s90 offen offset:128 sc1
    v_mfma_f32_16x16x32_bf16 v[252:255], a[8:11], v[168:171], v[252:255]
    ds_read_b64_tr_b16 a[42:43], v8 offset:43008
    v_cvt_pk_bf16_f32 v244, v244, v245
    s_buffer_load_dwordx4 s[32:35], s[56:59], s91 glc
    v_mfma_f32_16x16x32_bf16 v[252:255], a[4:7], v[152:155], v[252:255]
    ds_read_b64_tr_b16 a[44:45], v8 offset:45056
    s_mov_b32 s68, 114688
    v_mfma_f32_16x16x32_bf16 v[252:255], a[0:3], v[136:139], v[252:255]
    ds_read_b64_tr_b16 a[46:47], v8 offset:47104
    s_waitcnt lgkmcnt(8)
    v_mfma_f32_16x16x32_bf16 v[252:255], a[16:19], v[200:203], v[252:255]
    ds_read_b64_tr_b16 a[0:1], v8 offset:49152
    v_cvt_pk_bf16_f32 v245, v246, v247
    v_mfma_f32_16x16x32_bf16 v[252:255], a[20:23], v[216:219], v[252:255]
    ds_read_b64_tr_b16 a[2:3], v8 offset:51200
    v_mfma_f32_16x16x32_bf16 v[252:255], a[24:27], v[232:235], v[252:255]
    ds_read_b64_tr_b16 a[4:5], v8 offset:53248
    v_mfma_f32_16x16x32_bf16 v[252:255], a[28:31], v[248:251], v[252:255]
    ds_read_b64_tr_b16 a[6:7], v8 offset:55296
    buffer_load_dwordx4 v36, s[52:55], s68 offen offset:0 sc1 lds
    v_mfma_f32_16x16x32_bf16 v[236:239], a[28:31], v[240:243], v[236:239]
    ds_read_b64_tr_b16 a[8:9], v8 offset:57344
    v_mfma_f32_16x16x32_bf16 v[236:239], a[24:27], v[224:227], v[236:239]
    ds_read_b64_tr_b16 a[10:11], v8 offset:59392
    v_mfma_f32_16x16x32_bf16 v[236:239], a[20:23], v[208:211], v[236:239]
    ds_read_b64_tr_b16 a[12:13], v8 offset:61440
    v_mfma_f32_16x16x32_bf16 v[236:239], a[16:19], v[192:195], v[236:239]
    ds_read_b64_tr_b16 a[14:15], v8 offset:63488
    s_waitcnt lgkmcnt(8)
    v_mfma_f32_16x16x32_bf16 v[196:199], a[32:35], v[128:131], 0
    ds_read_b64_tr_b16 a[16:17], v9 offset:32768
    buffer_load_dwordx4 v37, s[52:55], s68 offen offset:1024 sc1 lds
    v_mfma_f32_16x16x32_bf16 v[196:199], a[36:39], v[144:147], v[196:199]
    ds_read_b64_tr_b16 a[18:19], v9 offset:34816
    v_mfma_f32_16x16x32_bf16 v[196:199], a[40:43], v[160:163], v[196:199]
    ds_read_b64_tr_b16 a[20:21], v9 offset:36864
    v_mfma_f32_16x16x32_bf16 v[196:199], a[44:47], v[176:179], v[196:199]
    ds_read_b64_tr_b16 a[22:23], v9 offset:38912
    v_cvt_pk_bf16_f32 v230, v236, v237
    v_mfma_f32_16x16x32_bf16 v[212:215], a[44:47], v[184:187], 0
    ds_read_b64_tr_b16 a[24:25], v9 offset:40960
    v_cvt_pk_bf16_f32 v231, v238, v239
    v_mfma_f32_16x16x32_bf16 v[212:215], a[40:43], v[168:171], v[212:215]
    ds_read_b64_tr_b16 a[26:27], v9 offset:43008
    buffer_load_dwordx4 v38, s[52:55], s68 offen offset:2048 sc1 lds
    v_mfma_f32_16x16x32_bf16 v[212:215], a[36:39], v[152:155], v[212:215]
    ds_read_b64_tr_b16 a[28:29], v9 offset:45056
    s_add_u32 s84, s84, 16384
    v_mfma_f32_16x16x32_bf16 v[212:215], a[32:35], v[136:139], v[212:215]
    ds_read_b64_tr_b16 a[30:31], v9 offset:47104
    s_waitcnt lgkmcnt(8)
    v_mfma_f32_16x16x32_bf16 v[212:215], a[0:3], v[200:203], v[212:215]
    ds_read_b64_tr_b16 a[32:33], v9 offset:49152
    buffer_store_dwordx4 v[228:231], v1, s[56:59], s84 offen sc1
    v_mfma_f32_16x16x32_bf16 v[212:215], a[4:7], v[216:219], v[212:215]
    ds_read_b64_tr_b16 a[34:35], v9 offset:51200
    v_cvt_pk_bf16_f32 v246, v252, v253
    v_mfma_f32_16x16x32_bf16 v[212:215], a[8:11], v[232:235], v[212:215]
    ds_read_b64_tr_b16 a[36:37], v9 offset:53248
    buffer_load_dwordx4 v39, s[52:55], s68 offen offset:3072 sc1 lds
    v_mfma_f32_16x16x32_bf16 v[212:215], a[12:15], v[248:251], v[212:215]
    ds_read_b64_tr_b16 a[38:39], v9 offset:55296
    s_add_u32 m0, s67, 147456
    v_mfma_f32_16x16x32_bf16 v[196:199], a[12:15], v[240:243], v[196:199]
    ds_read_b64_tr_b16 a[40:41], v9 offset:57344
    v_cvt_pk_bf16_f32 v247, v254, v255
    v_mfma_f32_16x16x32_bf16 v[196:199], a[8:11], v[224:227], v[196:199]
    ds_read_b64_tr_b16 a[42:43], v9 offset:59392
    s_mov_b32 s68, 143360
    v_mfma_f32_16x16x32_bf16 v[196:199], a[4:7], v[208:211], v[196:199]
    ds_read_b64_tr_b16 a[44:45], v9 offset:61440
    s_add_u32 s84, s84, 16384
    v_mfma_f32_16x16x32_bf16 v[196:199], a[0:3], v[192:195], v[196:199]
    ds_read_b64_tr_b16 a[46:47], v9 offset:63488
    s_waitcnt lgkmcnt(8)
    v_mfma_f32_16x16x32_bf16 v[204:207], a[16:19], v[128:131], 0
    ds_read_b64_tr_b16 a[0:1], v10 offset:32768
    buffer_load_dwordx4 v36, s[52:55], s68 offen offset:0 sc1 lds
    v_mfma_f32_16x16x32_bf16 v[204:207], a[20:23], v[144:147], v[204:207]
    ds_read_b64_tr_b16 a[2:3], v10 offset:34816
    buffer_store_dwordx4 v[244:247], v1, s[56:59], s84 offen sc1
    v_mfma_f32_16x16x32_bf16 v[204:207], a[24:27], v[160:163], v[204:207]
    ds_read_b64_tr_b16 a[4:5], v10 offset:36864
    v_mfma_f32_16x16x32_bf16 v[204:207], a[28:31], v[176:179], v[204:207]
    ds_read_b64_tr_b16 a[6:7], v10 offset:38912
    v_cvt_pk_bf16_f32 v196, v196, v197
    v_mfma_f32_16x16x32_bf16 v[220:223], a[28:31], v[184:187], 0
    ds_read_b64_tr_b16 a[8:9], v10 offset:40960
    buffer_load_dwordx4 v37, s[52:55], s68 offen offset:1024 sc1 lds
    v_mfma_f32_16x16x32_bf16 v[220:223], a[24:27], v[168:171], v[220:223]
    ds_read_b64_tr_b16 a[10:11], v10 offset:43008
    v_cvt_pk_bf16_f32 v197, v198, v199
    v_mfma_f32_16x16x32_bf16 v[220:223], a[20:23], v[152:155], v[220:223]
    ds_read_b64_tr_b16 a[12:13], v10 offset:45056
    v_cvt_pk_bf16_f32 v212, v212, v213
    v_mfma_f32_16x16x32_bf16 v[220:223], a[16:19], v[136:139], v[220:223]
    ds_read_b64_tr_b16 a[14:15], v10 offset:47104
    s_waitcnt lgkmcnt(8)
    v_mfma_f32_16x16x32_bf16 v[220:223], a[32:35], v[200:203], v[220:223]
    ds_read_b64_tr_b16 a[16:17], v10 offset:49152
    buffer_load_dwordx4 v38, s[52:55], s68 offen offset:2048 sc1 lds
    v_mfma_f32_16x16x32_bf16 v[220:223], a[36:39], v[216:219], v[220:223]
    ds_read_b64_tr_b16 a[18:19], v10 offset:51200
    v_cvt_pk_bf16_f32 v213, v214, v215
    v_mfma_f32_16x16x32_bf16 v[220:223], a[40:43], v[232:235], v[220:223]
    ds_read_b64_tr_b16 a[20:21], v10 offset:53248
    buffer_load_dwordx4 v39, s[52:55], s68 offen offset:3072 sc1 lds
    v_mfma_f32_16x16x32_bf16 v[220:223], a[44:47], v[248:251], v[220:223]
    ds_read_b64_tr_b16 a[22:23], v10 offset:55296
    v_mfma_f32_16x16x32_bf16 v[204:207], a[44:47], v[240:243], v[204:207]
    ds_read_b64_tr_b16 a[24:25], v10 offset:57344
    v_mfma_f32_16x16x32_bf16 v[204:207], a[40:43], v[224:227], v[204:207]
    ds_read_b64_tr_b16 a[26:27], v10 offset:59392
    v_mfma_f32_16x16x32_bf16 v[204:207], a[36:39], v[208:211], v[204:207]
    ds_read_b64_tr_b16 a[28:29], v10 offset:61440
    v_mfma_f32_16x16x32_bf16 v[204:207], a[32:35], v[192:195], v[204:207]
    ds_read_b64_tr_b16 a[30:31], v10 offset:63488
    s_waitcnt lgkmcnt(8)
    v_mfma_f32_16x16x32_bf16 v[228:231], a[0:3], v[128:131], 0
    ds_read_b64_tr_b16 a[32:33], v11 offset:32768
    v_mfma_f32_16x16x32_bf16 v[228:231], a[4:7], v[144:147], v[228:231]
    ds_read_b64_tr_b16 a[34:35], v11 offset:34816
    v_mfma_f32_16x16x32_bf16 v[228:231], a[8:11], v[160:163], v[228:231]
    ds_read_b64_tr_b16 a[36:37], v11 offset:36864
    v_mfma_f32_16x16x32_bf16 v[228:231], a[12:15], v[176:179], v[228:231]
    ds_read_b64_tr_b16 a[38:39], v11 offset:38912
    v_cvt_pk_bf16_f32 v198, v204, v205
    v_mfma_f32_16x16x32_bf16 v[244:247], a[12:15], v[184:187], 0
    ds_read_b64_tr_b16 a[40:41], v11 offset:40960
    v_cvt_pk_bf16_f32 v199, v206, v207
    v_mfma_f32_16x16x32_bf16 v[244:247], a[8:11], v[168:171], v[244:247]
    ds_read_b64_tr_b16 a[42:43], v11 offset:43008
    buffer_store_dwordx4 v[196:199], v1, s[56:59], s85 offen sc1
    v_mfma_f32_16x16x32_bf16 v[244:247], a[4:7], v[152:155], v[244:247]
    ds_read_b64_tr_b16 a[44:45], v11 offset:45056
    v_cvt_pk_bf16_f32 v214, v220, v221
    v_mfma_f32_16x16x32_bf16 v[244:247], a[0:3], v[136:139], v[244:247]
    ds_read_b64_tr_b16 a[46:47], v11 offset:47104
    s_waitcnt lgkmcnt(8)
    v_mfma_f32_16x16x32_bf16 v[244:247], a[16:19], v[200:203], v[244:247]
    ds_read_b64_tr_b16 a[0:1], v11 offset:49152
    v_cvt_pk_bf16_f32 v215, v222, v223
    v_mfma_f32_16x16x32_bf16 v[244:247], a[20:23], v[216:219], v[244:247]
    ds_read_b64_tr_b16 a[2:3], v11 offset:51200
    s_add_u32 s85, s85, 16384
    v_mfma_f32_16x16x32_bf16 v[244:247], a[24:27], v[232:235], v[244:247]
    ds_read_b64_tr_b16 a[4:5], v11 offset:53248
    buffer_store_dwordx4 v[212:215], v1, s[56:59], s85 offen sc1
    v_mfma_f32_16x16x32_bf16 v[244:247], a[28:31], v[248:251], v[244:247]
    ds_read_b64_tr_b16 a[6:7], v11 offset:55296
    v_mfma_f32_16x16x32_bf16 v[228:231], a[28:31], v[240:243], v[228:231]
    ds_read_b64_tr_b16 a[8:9], v11 offset:57344
    v_mfma_f32_16x16x32_bf16 v[228:231], a[24:27], v[224:227], v[228:231]
    ds_read_b64_tr_b16 a[10:11], v11 offset:59392
    v_mfma_f32_16x16x32_bf16 v[228:231], a[20:23], v[208:211], v[228:231]
    ds_read_b64_tr_b16 a[12:13], v11 offset:61440
    v_mfma_f32_16x16x32_bf16 v[228:231], a[16:19], v[192:195], v[228:231]
    ds_read_b64_tr_b16 a[14:15], v11 offset:63488
    s_waitcnt lgkmcnt(8)
    v_mfma_f32_16x16x32_bf16 v[236:239], a[32:35], v[128:131], 0
    s_barrier
    ds_read_b64_tr_b16 a[16:17], v112 offset:0
    v_mfma_f32_16x16x32_bf16 v[236:239], a[36:39], v[144:147], v[236:239]
    ds_read_b64_tr_b16 a[18:19], v112 offset:2048
    s_add_u32 m0, s67, 0
    v_mfma_f32_16x16x32_bf16 v[236:239], a[40:43], v[160:163], v[236:239]
    ds_read_b64_tr_b16 a[20:21], v113 offset:0
    s_mov_b32 s68, 172032
    v_mfma_f32_16x16x32_bf16 v[236:239], a[44:47], v[176:179], v[236:239]
    ds_read_b64_tr_b16 a[22:23], v113 offset:2048
    buffer_load_dwordx4 v36, s[52:55], s68 offen offset:0 sc1 lds
    v_mfma_f32_16x16x32_bf16 v[252:255], a[44:47], v[184:187], 0
    ds_read_b64_tr_b16 a[24:25], v114 offset:0
    v_cvt_pk_bf16_f32 v228, v228, v229
    v_cvt_pk_bf16_f32 v229, v230, v231
    v_mfma_f32_16x16x32_bf16 v[252:255], a[40:43], v[168:171], v[252:255]
    ds_read_b64_tr_b16 a[26:27], v114 offset:2048
    buffer_load_dwordx4 v37, s[52:55], s68 offen offset:1024 sc1 lds
    v_mfma_f32_16x16x32_bf16 v[252:255], a[36:39], v[152:155], v[252:255]
    ds_read_b64_tr_b16 a[28:29], v115 offset:0
    buffer_load_dwordx4 v38, s[52:55], s68 offen offset:2048 sc1 lds
    v_mfma_f32_16x16x32_bf16 v[252:255], a[32:35], v[136:139], v[252:255]
    ds_read_b64_tr_b16 a[30:31], v115 offset:2048
    s_waitcnt lgkmcnt(8)
    v_mfma_f32_16x16x32_bf16 v[252:255], a[0:3], v[200:203], v[252:255]
    ds_read_b64_tr_b16 a[32:33], v112 offset:16384
    buffer_load_dwordx4 v39, s[52:55], s68 offen offset:3072 sc1 lds
    s_add_u32 m0, s67, 16384
    v_mfma_f32_16x16x32_bf16 v[252:255], a[4:7], v[216:219], v[252:255]
    ds_read_b64_tr_b16 a[34:35], v112 offset:18432
    s_mov_b32 s68, 200704
    v_mfma_f32_16x16x32_bf16 v[252:255], a[8:11], v[232:235], v[252:255]
    ds_read_b64_tr_b16 a[36:37], v113 offset:16384
    buffer_load_dwordx4 v36, s[52:55], s68 offen offset:0 sc1 lds
    v_mfma_f32_16x16x32_bf16 v[252:255], a[12:15], v[248:251], v[252:255]
    ds_read_b64_tr_b16 a[38:39], v113 offset:18432
    v_cvt_pk_bf16_f32 v244, v244, v245
    v_mfma_f32_16x16x32_bf16 v[236:239], a[12:15], v[240:243], v[236:239]
    ds_read_b64_tr_b16 a[40:41], v114 offset:16384
    buffer_load_dwordx4 v37, s[52:55], s68 offen offset:1024 sc1 lds
    v_mfma_f32_16x16x32_bf16 v[236:239], a[8:11], v[224:227], v[236:239]
    ds_read_b64_tr_b16 a[42:43], v114 offset:18432
    buffer_load_dwordx4 v38, s[52:55], s68 offen offset:2048 sc1 lds
    v_mfma_f32_16x16x32_bf16 v[236:239], a[4:7], v[208:211], v[236:239]
    ds_read_b64_tr_b16 a[44:45], v115 offset:16384
    buffer_load_dwordx4 v39, s[52:55], s68 offen offset:3072 sc1 lds
    v_mfma_f32_16x16x32_bf16 v[236:239], a[0:3], v[192:195], v[236:239]
    ds_read_b64_tr_b16 a[46:47], v115 offset:18432
    s_waitcnt lgkmcnt(8)
    v_mfma_f32_16x16x32_bf16 v[44:47], a[16:19], a[128:131], 0
    ds_read_b64_tr_b16 a[0:1], v112 offset:32768
    v_cvt_pk_bf16_f32 v245, v246, v247
    v_mfma_f32_16x16x32_bf16 v[48:51], a[16:19], a[132:135], 0
    v_mfma_f32_16x16x32_bf16 v[52:55], a[16:19], a[136:139], 0
    ds_read_b64_tr_b16 a[2:3], v112 offset:34816
    v_mfma_f32_16x16x32_bf16 v[56:59], a[16:19], a[140:143], 0
    v_cvt_pk_bf16_f32 v230, v236, v237
    v_cvt_pk_bf16_f32 v231, v238, v239
    s_add_u32 s85, s85, 16384
    v_mfma_f32_16x16x32_bf16 v[72:75], a[20:23], a[140:143], 0
    s_barrier
    ds_read_b64_tr_b16 a[4:5], v113 offset:32768
    v_mfma_f32_16x16x32_bf16 v[68:71], a[20:23], a[136:139], 0
    s_add_u32 m0, s67, 32768
    buffer_store_dwordx4 v[228:231], v1, s[56:59], s85 offen sc1
    v_cvt_pk_bf16_f32 v246, v252, v253
    v_mfma_f32_16x16x32_bf16 v[64:67], a[20:23], a[132:135], 0
    ds_read_b64_tr_b16 a[6:7], v113 offset:34816
    s_mov_b32 s68, 229376
    v_mfma_f32_16x16x32_bf16 v[60:63], a[20:23], a[128:131], 0
    buffer_load_dwordx4 v36, s[52:55], s68 offen offset:0 sc1 lds
    v_cvt_pk_bf16_f32 v247, v254, v255
    v_mfma_f32_16x16x32_bf16 v[76:79], a[24:27], a[128:131], 0
    ds_read_b64_tr_b16 a[8:9], v114 offset:32768
    s_add_u32 s85, s85, 16384
    v_mfma_f32_16x16x32_bf16 v[80:83], a[24:27], a[132:135], 0
    buffer_load_dwordx4 v37, s[52:55], s68 offen offset:1024 sc1 lds
    buffer_store_dwordx4 v[244:247], v1, s[56:59], s85 offen sc1
    v_mfma_f32_16x16x32_bf16 v[84:87], a[24:27], a[136:139], 0
    ds_read_b64_tr_b16 a[10:11], v114 offset:34816
    buffer_load_dwordx4 v38, s[52:55], s68 offen offset:2048 sc1 lds
    v_mfma_f32_16x16x32_bf16 v[88:91], a[24:27], a[140:143], 0
    buffer_load_dwordx4 v39, s[52:55], s68 offen offset:3072 sc1 lds
    s_add_u32 m0, s67, 49152
    v_mfma_f32_16x16x32_bf16 v[104:107], a[28:31], a[140:143], 0
    ds_read_b64_tr_b16 a[12:13], v115 offset:32768
    s_mov_b32 s68, 258048
    v_mfma_f32_16x16x32_bf16 v[100:103], a[28:31], a[136:139], 0
    buffer_load_dwordx4 v36, s[52:55], s68 offen offset:0 sc1 lds
    v_mfma_f32_16x16x32_bf16 v[96:99], a[28:31], a[132:135], 0
    ds_read_b64_tr_b16 a[14:15], v115 offset:34816
    v_mfma_f32_16x16x32_bf16 v[92:95], a[28:31], a[128:131], 0
    s_waitcnt vmcnt(30) lgkmcnt(8)
    buffer_load_dwordx4 v37, s[52:55], s68 offen offset:1024 sc1 lds
    v_mfma_f32_16x16x32_bf16 v[44:47], a[32:35], a[144:147], v[44:47]
    ds_read_b64_tr_b16 a[16:17], v112 offset:49152
    buffer_load_dwordx4 v38, s[52:55], s68 offen offset:2048 sc1 lds
    v_mfma_f32_16x16x32_bf16 v[48:51], a[32:35], a[148:151], v[48:51]
    buffer_load_dwordx4 v39, s[52:55], s68 offen offset:3072 sc1 lds
    s_add_u32 m0, s67, 65536
    v_mfma_f32_16x16x32_bf16 v[52:55], a[32:35], a[152:155], v[52:55]
    ds_read_b64_tr_b16 a[18:19], v112 offset:51200
    s_mov_b32 s68, 286720
    v_mfma_f32_16x16x32_bf16 v[56:59], a[32:35], a[156:159], v[56:59]
    buffer_load_dwordx4 v36, s[52:55], s68 offen offset:0 sc1 lds
    v_mfma_f32_16x16x32_bf16 v[72:75], a[36:39], a[156:159], v[72:75]
    ds_read_b64_tr_b16 a[20:21], v113 offset:49152
    v_mfma_f32_16x16x32_bf16 v[68:71], a[36:39], a[152:155], v[68:71]
    buffer_load_dwordx4 v37, s[52:55], s68 offen offset:1024 sc1 lds
    v_mfma_f32_16x16x32_bf16 v[64:67], a[36:39], a[148:151], v[64:67]
    ds_read_b64_tr_b16 a[22:23], v113 offset:51200
    buffer_load_dwordx4 v38, s[52:55], s68 offen offset:2048 sc1 lds
    v_mfma_f32_16x16x32_bf16 v[60:63], a[36:39], a[144:147], v[60:63]
    buffer_load_dwordx4 v39, s[52:55], s68 offen offset:3072 sc1 lds
    v_mfma_f32_16x16x32_bf16 v[76:79], a[40:43], a[144:147], v[76:79]
    ds_read_b64_tr_b16 a[24:25], v114 offset:49152
    v_mfma_f32_16x16x32_bf16 v[80:83], a[40:43], a[148:151], v[80:83]
    v_mfma_f32_16x16x32_bf16 v[84:87], a[40:43], a[152:155], v[84:87]
    ds_read_b64_tr_b16 a[26:27], v114 offset:51200
    s_waitcnt vmcnt(10)
    buffer_store_byte v29, v28, s[56:59], s90 offen offset:256 sc1
    s_cmp_ge_u32 s97, 14
    s_cbranch_scc1 L_end
    s_waitcnt lgkmcnt(0)
    s_and_b64 s[32:33], s[32:33], s[34:35]
    s_and_b32 s32, s32, s33
    s_and_b32 s32, s32, 0x01010101
    s_cmp_eq_u32 s32, 0x01010101
    s_cselect_b32 s18, 0, 0x7f000000
    v_add_u32 v122, s18, v2
    v_mfma_f32_16x16x32_bf16 v[88:91], a[40:43], a[156:159], v[88:91]
    s_add_u32 s70, s89, 0
    v_mfma_f32_16x16x32_bf16 v[104:107], a[44:47], a[156:159], v[104:107]
    ds_read_b64_tr_b16 a[28:29], v115 offset:49152
    v_mfma_f32_16x16x32_bf16 v[100:103], a[44:47], a[152:155], v[100:103]
    v_mfma_f32_16x16x32_bf16 v[96:99], a[44:47], a[148:151], v[96:99]
    ds_read_b64_tr_b16 a[30:31], v115 offset:51200
    v_mfma_f32_16x16x32_bf16 v[92:95], a[44:47], a[144:147], v[92:95]
    buffer_load_dwordx4 v[128:131], v122, s[56:59], s70 offen offset:0 sc1
    v_mfma_f32_16x16x32_bf16 v[44:47], a[0:3], a[160:163], v[44:47]
    ds_read_b64_tr_b16 a[32:33], v116 offset:0
    s_add_u32 m0, s67, 81920
    v_mfma_f32_16x16x32_bf16 v[48:51], a[0:3], a[164:167], v[48:51]
    s_mov_b32 s68, 315392
    buffer_load_dwordx4 v[144:147], v122, s[56:59], s70 offen offset:1024 sc1
    v_mfma_f32_16x16x32_bf16 v[52:55], a[0:3], a[168:171], v[52:55]
    ds_read_b64_tr_b16 a[34:35], v116 offset:2048
    v_mfma_f32_16x16x32_bf16 v[56:59], a[0:3], a[172:175], v[56:59]
    buffer_load_dwordx4 v36, s[52:55], s68 offen offset:0 sc1 lds
    v_mfma_f32_16x16x32_bf16 v[72:75], a[4:7], a[172:175], v[72:75]
    ds_read_b64_tr_b16 a[36:37], v117 offset:0
    buffer_load_dwordx4 v37, s[52:55], s68 offen offset:1024 sc1 lds
    v_mfma_f32_16x16x32_bf16 v[68:71], a[4:7], a[168:171], v[68:71]
    buffer_load_dwordx4 v38, s[52:55], s68 offen offset:2048 sc1 lds
    s_add_u32 s70, s89, 32768
    v_mfma_f32_16x16x32_bf16 v[64:67], a[4:7], a[164:167], v[64:67]
    ds_read_b64_tr_b16 a[38:39], v117 offset:2048
    v_mfma_f32_16x16x32_bf16 v[60:63], a[4:7], a[160:163], v[60:63]
    buffer_load_dwordx4 v39, s[52:55], s68 offen offset:3072 sc1 lds
    v_mfma_f32_16x16x32_bf16 v[76:79], a[8:11], a[160:163], v[76:79]
    ds_read_b64_tr_b16 a[40:41], v118 offset:0
    v_mfma_f32_16x16x32_bf16 v[80:83], a[8:11], a[164:167], v[80:83]
    buffer_load_dwordx4 v[136:139], v122, s[56:59], s70 offen offset:0 sc1
    v_mfma_f32_16x16x32_bf16 v[84:87], a[8:11], a[168:171], v[84:87]
    ds_read_b64_tr_b16 a[42:43], v118 offset:2048
    v_mfma_f32_16x16x32_bf16 v[88:91], a[8:11], a[172:175], v[88:91]
    buffer_load_dwordx4 v[152:155], v122, s[56:59], s70 offen offset:1024 sc1
    v_mfma_f32_16x16x32_bf16 v[104:107], a[12:15], a[172:175], v[104:107]
    ds_read_b64_tr_b16 a[44:45], v119 offset:0
    v_mfma_f32_16x16x32_bf16 v[100:103], a[12:15], a[168:171], v[100:103]
    v_mfma_f32_16x16x32_bf16 v[96:99], a[12:15], a[164:167], v[96:99]
    ds_read_b64_tr_b16 a[46:47], v119 offset:2048
    v_mfma_f32_16x16x32_bf16 v[92:95], a[12:15], a[160:163], v[92:95]
    s_waitcnt lgkmcnt(8)
    s_add_u32 s70, s89, 2048
    v_mfma_f32_16x16x32_bf16 v[44:47], a[16:19], a[176:179], v[44:47]
    ds_read_b64_tr_b16 a[0:1], v116 offset:16384
    s_add_u32 m0, s67, 98304
    v_mfma_f32_16x16x32_bf16 v[48:51], a[16:19], a[180:183], v[48:51]
    s_mov_b32 s68, 344064
    v_mfma_f32_16x16x32_bf16 v[52:55], a[16:19], a[184:187], v[52:55]
    ds_read_b64_tr_b16 a[2:3], v116 offset:18432
    buffer_load_dwordx4 v[160:163], v122, s[56:59], s70 offen offset:0 sc1
    v_mfma_f32_16x16x32_bf16 v[56:59], a[16:19], a[188:191], v[56:59]
    buffer_load_dwordx4 v36, s[52:55], s68 offen offset:0 sc1 lds
    v_mfma_f32_16x16x32_bf16 v[72:75], a[20:23], a[188:191], v[72:75]
    ds_read_b64_tr_b16 a[4:5], v117 offset:16384
    buffer_load_dwordx4 v37, s[52:55], s68 offen offset:1024 sc1 lds
    v_mfma_f32_16x16x32_bf16 v[68:71], a[20:23], a[184:187], v[68:71]
    buffer_load_dwordx4 v38, s[52:55], s68 offen offset:2048 sc1 lds
    v_mfma_f32_16x16x32_bf16 v[64:67], a[20:23], a[180:183], v[64:67]
    ds_read_b64_tr_b16 a[6:7], v117 offset:18432
    buffer_load_dwordx4 v[176:179], v122, s[56:59], s70 offen offset:1024 sc1
    v_mfma_f32_16x16x32_bf16 v[60:63], a[20:23], a[176:179], v[60:63]
    buffer_load_dwordx4 v39, s[52:55], s68 offen offset:3072 sc1 lds
    v_mfma_f32_16x16x32_bf16 v[76:79], a[24:27], a[176:179], v[76:79]
    ds_read_b64_tr_b16 a[8:9], v118 offset:16384
    v_mfma_f32_16x16x32_bf16 v[80:83], a[24:27], a[180:183], v[80:83]
    s_add_u32 s70, s89, 34816
    v_mfma_f32_16x16x32_bf16 v[84:87], a[24:27], a[184:187], v[84:87]
    ds_read_b64_tr_b16 a[10:11], v118 offset:18432
    v_mfma_f32_16x16x32_bf16 v[88:91], a[24:27], a[188:191], v[88:91]
    v_mfma_f32_16x16x32_bf16 v[104:107], a[28:31], a[188:191], v[104:107]
    ds_read_b64_tr_b16 a[12:13], v119 offset:16384
    v_mfma_f32_16x16x32_bf16 v[100:103], a[28:31], a[184:187], v[100:103]
    buffer_load_dwordx4 v[168:171], v122, s[56:59], s70 offen offset:0 sc1
    v_mfma_f32_16x16x32_bf16 v[96:99], a[28:31], a[180:183], v[96:99]
    ds_read_b64_tr_b16 a[14:15], v119 offset:18432
    v_mfma_f32_16x16x32_bf16 v[92:95], a[28:31], a[176:179], v[92:95]
    s_waitcnt lgkmcnt(8)
    v_mfma_f32_16x16x32_bf16 v[44:47], a[32:35], a[192:195], v[44:47]
    ds_read_b64_tr_b16 a[16:17], v108 offset:0
    s_add_u32 m0, s67, 114688
    v_mfma_f32_16x16x32_bf16 v[48:51], a[32:35], a[196:199], v[48:51]
    s_mov_b32 s68, 372736
    buffer_load_dwordx4 v[184:187], v122, s[56:59], s70 offen offset:1024 sc1
    v_mfma_f32_16x16x32_bf16 v[52:55], a[32:35], a[200:203], v[52:55]
    ds_read_b64_tr_b16 a[18:19], v108 offset:2048
    v_mfma_f32_16x16x32_bf16 v[56:59], a[32:35], a[204:207], v[56:59]
    buffer_load_dwordx4 v36, s[52:55], s68 offen offset:0 sc1 lds
    s_add_u32 s70, s89, 4096
    v_mfma_f32_16x16x32_bf16 v[72:75], a[36:39], a[204:207], v[72:75]
    ds_read_b64_tr_b16 a[20:21], v109 offset:0
    buffer_load_dwordx4 v37, s[52:55], s68 offen offset:1024 sc1 lds
    buffer_load_ubyte v30, v123, s[56:59], s91 offen offset:128 sc1
    v_mfma_f32_16x16x32_bf16 v[68:71], a[36:39], a[200:203], v[68:71]
    buffer_load_dwordx4 v38, s[52:55], s68 offen offset:2048 sc1 lds
    v_mfma_f32_16x16x32_bf16 v[64:67], a[36:39], a[196:199], v[64:67]
    ds_read_b64_tr_b16 a[22:23], v109 offset:2048
    v_mfma_f32_16x16x32_bf16 v[60:63], a[36:39], a[192:195], v[60:63]
    buffer_load_dwordx4 v39, s[52:55], s68 offen offset:3072 sc1 lds
    v_mfma_f32_16x16x32_bf16 v[76:79], a[40:43], a[192:195], v[76:79]
    ds_read_b64_tr_b16 a[24:25], v110 offset:0
    v_mfma_f32_16x16x32_bf16 v[80:83], a[40:43], a[196:199], v[80:83]
    buffer_load_dwordx4 v[192:195], v122, s[56:59], s70 offen offset:0 sc1
    v_mfma_f32_16x16x32_bf16 v[84:87], a[40:43], a[200:203], v[84:87]
    ds_read_b64_tr_b16 a[26:27], v110 offset:2048
    v_mfma_f32_16x16x32_bf16 v[88:91], a[40:43], a[204:207], v[88:91]
    buffer_load_dwordx4 v[208:211], v122, s[56:59], s70 offen offset:1024 sc1
    v_mfma_f32_16x16x32_bf16 v[104:107], a[44:47], a[204:207], v[104:107]
    ds_read_b64_tr_b16 a[28:29], v111 offset:0
    v_mfma_f32_16x16x32_bf16 v[100:103], a[44:47], a[200:203], v[100:103]
    s_add_u32 s70, s89, 36864
    v_mfma_f32_16x16x32_bf16 v[96:99], a[44:47], a[196:199], v[96:99]
    ds_read_b64_tr_b16 a[30:31], v111 offset:2048
    v_mfma_f32_16x16x32_bf16 v[92:95], a[44:47], a[192:195], v[92:95]
    s_waitcnt lgkmcnt(8)
    v_mfma_f32_16x16x32_bf16 v[44:47], a[0:3], a[208:211], v[44:47]
    ds_read_b64_tr_b16 a[32:33], v108 offset:16384
    v_accvgpr_read_b32 v125, a56
    v_mfma_f32_16x16x32_bf16 v[48:51], a[0:3], a[212:215], v[48:51]
    buffer_load_dwordx4 v[200:203], v122, s[56:59], s70 offen offset:0 sc1
    s_add_u32 m0, s67, 131072
    v_mfma_f32_16x16x32_bf16 v[52:55], a[0:3], a[216:219], v[52:55]
    ds_read_b64_tr_b16 a[34:35], v108 offset:18432
    s_movk_i32 s12, 6144
    v_mfma_f32_16x16x32_bf16 v[56:59], a[0:3], a[220:223], v[56:59]
    s_movk_i32 s13, 7168
    buffer_load_dwordx4 v125, s[28:31], 0 offen lds
    v_mfma_f32_16x16x32_bf16 v[72:75], a[4:7], a[220:223], v[72:75]
    ds_read_b64_tr_b16 a[36:37], v109 offset:16384
    v_mfma_f32_16x16x32_bf16 v[68:71], a[4:7], a[216:219], v[68:71]
    buffer_load_dwordx4 v[216:219], v122, s[56:59], s70 offen offset:1024 sc1
    v_mfma_f32_16x16x32_bf16 v[64:67], a[4:7], a[212:215], v[64:67]
    ds_read_b64_tr_b16 a[38:39], v109 offset:18432
    v_mfma_f32_16x16x32_bf16 v[60:63], a[4:7], a[208:211], v[60:63]
    buffer_load_dwordx4 v125, s[28:31], s12 offen offset:1024 lds
    v_and_b32 v6, 15, v0
    v_mfma_f32_16x16x32_bf16 v[76:79], a[8:11], a[208:211], v[76:79]
    ds_read_b64_tr_b16 a[40:41], v110 offset:16384
    v_lshlrev_b32 v6, 7, v6
    v_mfma_f32_16x16x32_bf16 v[80:83], a[8:11], a[212:215], v[80:83]
    v_lshrrev_b32 v7, 4, v0
    v_lshl_add_u32 v6, v7, 3, v6
    v_mfma_f32_16x16x32_bf16 v[84:87], a[8:11], a[216:219], v[84:87]
    ds_read_b64_tr_b16 a[42:43], v110 offset:18432
    s_add_u32 s14, s67, 131072
    v_mfma_f32_16x16x32_bf16 v[88:91], a[8:11], a[220:223], v[88:91]
    v_add_u32 v6, s14, v6
    v_lshrrev_b32 v7, 3, v0
    v_mfma_f32_16x16x32_bf16 v[104:107], a[12:15], a[220:223], v[104:107]
    ds_read_b64_tr_b16 a[44:45], v111 offset:16384
    v_lshl_add_u32 v7, v7, 4, v1
    v_mfma_f32_16x16x32_bf16 v[100:103], a[12:15], a[216:219], v[100:103]
    v_add_u32 v7, s14, v7
    v_and_b32 v26, 15, v0
    v_mfma_f32_16x16x32_bf16 v[96:99], a[12:15], a[212:215], v[96:99]
    ds_read_b64_tr_b16 a[46:47], v111 offset:18432
    v_lshl_add_u32 v26, v26, 4, v6
    v_mfma_f32_16x16x32_bf16 v[92:95], a[12:15], a[208:211], v[92:95]
    s_waitcnt vmcnt(36) lgkmcnt(8)
    v_mfma_f32_16x16x32_bf16 v[44:47], a[16:19], a[224:227], v[44:47]
    ds_read_b64_tr_b16 a[0:1], v108 offset:32768
    v_mfma_f32_16x16x32_bf16 v[48:51], a[16:19], a[228:231], v[48:51]
    v_mfma_f32_16x16x32_bf16 v[52:55], a[16:19], a[232:235], v[52:55]
    ds_read_b64_tr_b16 a[2:3], v108 offset:34816
    v_mfma_f32_16x16x32_bf16 v[56:59], a[16:19], a[236:239], v[56:59]
    v_mfma_f32_16x16x32_bf16 v[72:75], a[20:23], a[236:239], v[72:75]
    ds_read_b64_tr_b16 a[4:5], v109 offset:32768
    v_mfma_f32_16x16x32_bf16 v[68:71], a[20:23], a[232:235], v[68:71]
    v_mfma_f32_16x16x32_bf16 v[64:67], a[20:23], a[228:231], v[64:67]
    ds_read_b64_tr_b16 a[6:7], v109 offset:34816
    v_mfma_f32_16x16x32_bf16 v[60:63], a[20:23], a[224:227], v[60:63]
    v_mfma_f32_16x16x32_bf16 v[76:79], a[24:27], a[224:227], v[76:79]
    ds_read_b64_tr_b16 a[8:9], v110 offset:32768
    v_mfma_f32_16x16x32_bf16 v[80:83], a[24:27], a[228:231], v[80:83]
    s_waitcnt vmcnt(8)
    v_cmp_ne_u32 vcc, 1, v30
    s_nop 0
    s_cbranch_vccnz L_spin1
L_spin1_ret:
    s_cmp_lg_u32 s18, 0
    s_cbranch_scc1 L_redo
L_redo_ret:
    v_mfma_f32_16x16x32_bf16 v[84:87], a[24:27], a[232:235], v[84:87]
    ds_read_b64_tr_b16 a[10:11], v110 offset:34816
    s_add_u32 s70, s89, 6144
    v_mfma_f32_16x16x32_bf16 v[88:91], a[24:27], a[236:239], v[88:91]
    v_mfma_f32_16x16x32_bf16 v[104:107], a[28:31], a[236:239], v[104:107]
    ds_read_b64_tr_b16 a[12:13], v111 offset:32768
    v_mfma_f32_16x16x32_bf16 v[100:103], a[28:31], a[232:235], v[100:103]
    buffer_load_dwordx4 v[224:227], v2, s[56:59], s70 offen offset:0 sc1
    v_mfma_f32_16x16x32_bf16 v[96:99], a[28:31], a[228:231], v[96:99]
    ds_read_b64_tr_b16 a[14:15], v111 offset:34816
    v_mfma_f32_16x16x32_bf16 v[92:95], a[28:31], a[224:227], v[92:95]
    s_waitcnt lgkmcnt(8)
    v_mfma_f32_16x16x32_bf16 v[44:47], a[32:35], a[240:243], v[44:47]
    ds_read_b64_tr_b16 a[16:17], v108 offset:49152
    v_mfma_f32_16x16x32_bf16 v[48:51], a[32:35], a[244:247], v[48:51]
    buffer_load_dwordx4 v[240:243], v2, s[56:59], s70 offen offset:1024 sc1
    v_mfma_f32_16x16x32_bf16 v[52:55], a[32:35], a[248:251], v[52:55]
    ds_read_b64_tr_b16 a[18:19], v108 offset:51200
    v_mfma_f32_16x16x32_bf16 v[56:59], a[32:35], a[252:255], v[56:59]
    v_mfma_f32_16x16x32_bf16 v[72:75], a[36:39], a[252:255], v[72:75]
    ds_read_b64_tr_b16 a[20:21], v109 offset:49152
    s_add_u32 s70, s89, 38912
    v_mfma_f32_16x16x32_bf16 v[68:71], a[36:39], a[248:251], v[68:71]
    v_mfma_f32_16x16x32_bf16 v[64:67], a[36:39], a[244:247], v[64:67]
    ds_read_b64_tr_b16 a[22:23], v109 offset:51200
    v_mfma_f32_16x16x32_bf16 v[60:63], a[36:39], a[240:243], v[60:63]
    v_mfma_f32_16x16x32_bf16 v[76:79], a[40:43], a[240:243], v[76:79]
    ds_read_b64_tr_b16 a[24:25], v110 offset:49152
    v_mfma_f32_16x16x32_bf16 v[80:83], a[40:43], a[244:247], v[80:83]
    buffer_load_dwordx4 v[232:235], v2, s[56:59], s70 offen offset:0 sc1
    v_mfma_f32_16x16x32_bf16 v[84:87], a[40:43], a[248:251], v[84:87]
    ds_read_b64_tr_b16 a[26:27], v110 offset:51200
    v_mfma_f32_16x16x32_bf16 v[88:91], a[40:43], a[252:255], v[88:91]
    buffer_load_dwordx4 v[248:251], v2, s[56:59], s70 offen offset:1024 sc1
    v_mfma_f32_16x16x32_bf16 v[104:107], a[44:47], a[252:255], v[104:107]
    ds_read_b64_tr_b16 a[28:29], v111 offset:49152
    v_mfma_f32_16x16x32_bf16 v[100:103], a[44:47], a[248:251], v[100:103]
    v_mfma_f32_16x16x32_bf16 v[96:99], a[44:47], a[244:247], v[96:99]
    ds_read_b64_tr_b16 a[30:31], v111 offset:51200
    v_mfma_f32_16x16x32_bf16 v[92:95], a[44:47], a[240:243], v[92:95]
    s_waitcnt lgkmcnt(8)
    s_add_u32 s70, s89, 8192
    v_mfma_f32_16x16x32_bf16 v[44:47], a[0:3], a[64:67], v[44:47]
    ds_read_b64_tr_b16 a[32:33], v112 offset:0
    v_mfma_f32_16x16x32_bf16 v[48:51], a[0:3], a[68:71], v[48:51]
    v_mfma_f32_16x16x32_bf16 v[52:55], a[0:3], a[72:75], v[52:55]
    ds_read_b64_tr_b16 a[34:35], v112 offset:2048
    v_mfma_f32_16x16x32_bf16 v[56:59], a[0:3], a[76:79], v[56:59]
    buffer_load_dwordx4 a[128:131], v2, s[56:59], s70 offen offset:0 sc1
    v_mfma_f32_16x16x32_bf16 v[72:75], a[4:7], a[76:79], v[72:75]
    ds_read_b64_tr_b16 a[36:37], v113 offset:0
    v_mfma_f32_16x16x32_bf16 v[68:71], a[4:7], a[72:75], v[68:71]
    v_mfma_f32_16x16x32_bf16 v[64:67], a[4:7], a[68:71], v[64:67]
    ds_read_b64_tr_b16 a[38:39], v113 offset:2048
    v_mfma_f32_16x16x32_bf16 v[60:63], a[4:7], a[64:67], v[60:63]
    buffer_load_dwordx4 a[136:139], v2, s[56:59], s70 offen offset:1024 sc1
    v_mfma_f32_16x16x32_bf16 v[76:79], a[8:11], a[64:67], v[76:79]
    ds_read_b64_tr_b16 a[40:41], v114 offset:0
    v_mfma_f32_16x16x32_bf16 v[80:83], a[8:11], a[68:71], v[80:83]
    s_add_u32 s70, s89, 40960
    v_mfma_f32_16x16x32_bf16 v[84:87], a[8:11], a[72:75], v[84:87]
    ds_read_b64_tr_b16 a[42:43], v114 offset:2048
    v_mfma_f32_16x16x32_bf16 v[88:91], a[8:11], a[76:79], v[88:91]
    v_mfma_f32_16x16x32_bf16 v[104:107], a[12:15], a[76:79], v[104:107]
    ds_read_b64_tr_b16 a[44:45], v115 offset:0
    v_mfma_f32_16x16x32_bf16 v[100:103], a[12:15], a[72:75], v[100:103]
    buffer_load_dwordx4 a[132:135], v2, s[56:59], s70 offen offset:0 sc1
    v_mfma_f32_16x16x32_bf16 v[96:99], a[12:15], a[68:71], v[96:99]
    ds_read_b64_tr_b16 a[46:47], v115 offset:2048
    v_mfma_f32_16x16x32_bf16 v[92:95], a[12:15], a[64:67], v[92:95]
    s_waitcnt lgkmcnt(8)
    v_mfma_f32_16x16x32_bf16 v[44:47], a[16:19], a[80:83], v[44:47]
    ds_read_b64_tr_b16 a[0:1], v112 offset:16384
    v_mfma_f32_16x16x32_bf16 v[48:51], a[16:19], a[84:87], v[48:51]
    buffer_load_dwordx4 a[140:143], v2, s[56:59], s70 offen offset:1024 sc1
    v_mfma_f32_16x16x32_bf16 v[52:55], a[16:19], a[88:91], v[52:55]
    ds_read_b64_tr_b16 a[2:3], v112 offset:18432
    s_add_u32 s71, s67, 147456
    v_mfma_f32_16x16x32_bf16 v[56:59], a[16:19], a[92:95], v[56:59]
    v_add_u32 v40, s71, v1
    s_sub_u32 s71, s67, 4096
    v_mfma_f32_16x16x32_bf16 v[72:75], a[20:23], a[92:95], v[72:75]
    ds_read_b64_tr_b16 a[4:5], v112 offset:32768
    s_and_b32 s71, s71, 0x3000
    v_mfma_f32_16x16x32_bf16 v[68:71], a[20:23], a[88:91], v[68:71]
    s_add_u32 s71, s71, 147456
    v_add_u32 v120, s71, v1
    s_add_u32 s71, s67, 0
    v_mfma_f32_16x16x32_bf16 v[64:67], a[20:23], a[84:87], v[64:67]
    ds_read_b64_tr_b16 a[6:7], v112 offset:34816
    v_add_u32 v41, s71, v1
    v_mfma_f32_16x16x32_bf16 v[60:63], a[20:23], a[80:83], v[60:63]
    s_waitcnt vmcnt(14)
    s_sub_u32 s71, s67, 8192
    s_and_b32 s71, s71, 0x3000
    v_mfma_f32_16x16x32_bf16 v[76:79], a[24:27], a[80:83], v[76:79]
    ds_read_b64_tr_b16 a[8:9], v112 offset:49152
    s_add_u32 s71, s71, 0
    v_mfma_f32_16x16x32_bf16 v[80:83], a[24:27], a[84:87], v[80:83]
    v_add_u32 v121, s71, v1
    s_add_u32 s71, s67, 16384
    v_mfma_f32_16x16x32_bf16 v[84:87], a[24:27], a[88:91], v[84:87]
    ds_read_b64_tr_b16 a[10:11], v112 offset:51200
    v_add_u32 v42, s71, v1
    v_mfma_f32_16x16x32_bf16 v[88:91], a[24:27], a[92:95], v[88:91]
    s_sub_u32 s71, s67, 12288
    s_and_b32 s71, s71, 0x3000
    s_add_u32 s71, s71, 16384
    v_mfma_f32_16x16x32_bf16 v[104:107], a[28:31], a[92:95], v[104:107]
    ds_read_b64_tr_b16 a[12:13], v113 offset:16384
    v_add_u32 v124, s71, v1
    v_mfma_f32_16x16x32_bf16 v[100:103], a[28:31], a[88:91], v[100:103]
    v_mfma_f32_16x16x32_bf16 v[96:99], a[28:31], a[84:87], v[96:99]
    ds_read_b64_tr_b16 a[14:15], v113 offset:18432
    v_mfma_f32_16x16x32_bf16 v[92:95], a[28:31], a[80:83], v[92:95]
    s_waitcnt lgkmcnt(8)
    v_mfma_f32_16x16x32_bf16 v[44:47], a[32:35], a[96:99], v[44:47]
    ds_read_b64_tr_b16 a[16:17], v113 offset:32768
    v_mfma_f32_16x16x32_bf16 v[48:51], a[32:35], a[100:103], v[48:51]
    v_mfma_f32_16x16x32_bf16 v[52:55], a[32:35], a[104:107], v[52:55]
    ds_read_b64_tr_b16 a[18:19], v113 offset:34816
    v_mfma_f32_16x16x32_bf16 v[56:59], a[32:35], a[108:111], v[56:59]
    v_mfma_f32_16x16x32_bf16 v[72:75], a[36:39], a[108:111], v[72:75]
    ds_read_b64_tr_b16 a[20:21], v113 offset:49152
    v_mfma_f32_16x16x32_bf16 v[68:71], a[36:39], a[104:107], v[68:71]
    v_mfma_f32_16x16x32_bf16 v[64:67], a[36:39], a[100:103], v[64:67]
    ds_read_b64_tr_b16 a[22:23], v113 offset:51200
    v_mfma_f32_16x16x32_bf16 v[60:63], a[36:39], a[96:99], v[60:63]
    v_mfma_f32_16x16x32_bf16 v[76:79], a[40:43], a[96:99], v[76:79]
    ds_read_b64_tr_b16 a[24:25], v114 offset:16384
    v_mfma_f32_16x16x32_bf16 v[80:83], a[40:43], a[100:103], v[80:83]
    v_mfma_f32_16x16x32_bf16 v[84:87], a[40:43], a[104:107], v[84:87]
    ds_read_b64_tr_b16 a[26:27], v114 offset:18432
    v_mfma_f32_16x16x32_bf16 v[88:91], a[40:43], a[108:111], v[88:91]
    v_mfma_f32_16x16x32_bf16 v[104:107], a[44:47], a[108:111], v[104:107]
    ds_read_b64_tr_b16 a[28:29], v114 offset:32768
    v_mfma_f32_16x16x32_bf16 v[100:103], a[44:47], a[104:107], v[100:103]
    v_mfma_f32_16x16x32_bf16 v[96:99], a[44:47], a[100:103], v[96:99]
    ds_read_b64_tr_b16 a[30:31], v114 offset:34816
    v_mfma_f32_16x16x32_bf16 v[92:95], a[44:47], a[96:99], v[92:95]
    s_waitcnt lgkmcnt(8)
    v_mfma_f32_16x16x32_bf16 v[44:47], a[0:3], a[112:115], v[44:47]
    ds_read_b64_tr_b16 a[32:33], v114 offset:49152
    v_mfma_f32_16x16x32_bf16 v[48:51], a[0:3], a[116:119], v[48:51]
    v_mfma_f32_16x16x32_bf16 v[52:55], a[0:3], a[120:123], v[52:55]
    ds_read_b64_tr_b16 a[34:35], v114 offset:51200
    v_mfma_f32_16x16x32_bf16 v[56:59], a[0:3], a[124:127], v[56:59]
    v_mfma_f32_16x16x32_bf16 v[56:59], a[4:7], v[156:159], v[56:59]
    ds_read_b64_tr_b16 a[36:37], v115 offset:16384
    s_waitcnt vmcnt(8)
    v_mfma_f32_16x16x32_bf16 v[52:55], a[4:7], v[148:151], v[52:55]
    ds_read_b64 v[32:33], v6 offset:0
    v_mfma_f32_16x16x32_bf16 v[48:51], a[4:7], v[140:143], v[48:51]
    ds_read_b64_tr_b16 a[38:39], v115 offset:18432
    v_mfma_f32_16x16x32_bf16 v[44:47], a[4:7], v[132:135], v[44:47]
    ds_read_b64 v[34:35], v6 offset:32
    v_mfma_f32_16x16x32_bf16 v[44:47], a[8:11], v[164:167], v[44:47]
    ds_read_b64_tr_b16 a[40:41], v115 offset:32768
    v_mfma_f32_16x16x32_bf16 v[48:51], a[8:11], v[172:175], v[48:51]
    ds_read_b64 v[36:37], v6 offset:64
    v_mfma_f32_16x16x32_bf16 v[52:55], a[8:11], v[180:183], v[52:55]
    ds_read_b64_tr_b16 a[42:43], v115 offset:34816
    v_mfma_f32_16x16x32_bf16 v[56:59], a[8:11], v[188:191], v[56:59]
    ds_read_b64 v[38:39], v6 offset:96
    v_mfma_f32_16x16x32_bf16 v[72:75], a[12:15], a[124:127], v[72:75]
    ds_read_b64_tr_b16 a[44:45], v115 offset:49152
    v_mfma_f32_16x16x32_bf16 v[68:71], a[12:15], a[120:123], v[68:71]
    v_mfma_f32_16x16x32_bf16 v[64:67], a[12:15], a[116:119], v[64:67]
    ds_read_b64_tr_b16 a[46:47], v115 offset:51200
    buffer_load_ubyte v30, v123, s[56:59], s91 offen offset:256 sc1
    v_mfma_f32_16x16x32_bf16 v[60:63], a[12:15], a[112:115], v[60:63]
    s_waitcnt lgkmcnt(12)
    v_mfma_f32_16x16x32_bf16 v[60:63], a[16:19], v[132:135], v[60:63]
    ds_write_b128 v40, v[48:51] offset:0
    v_mfma_f32_16x16x32_bf16 v[64:67], a[16:19], v[140:143], v[64:67]
    v_mov_b32 v108, 0
    v_mov_b32 v109, 0
    v_mfma_f32_16x16x32_bf16 v[68:71], a[16:19], v[148:151], v[68:71]
    v_mov_b32 v112, 0
    v_mov_b32 v113, 0
    v_mfma_f32_16x16x32_bf16 v[72:75], a[16:19], v[156:159], v[72:75]
    v_mov_b32 v3, 0x3f80
    v_mov_b32 v110, 0x3f800000
    ds_write_b128 v41, v[52:55] offset:0
    v_mfma_f32_16x16x32_bf16 v[72:75], a[20:23], v[188:191], v[72:75]
    s_or_b64 s[16:17], s[4:5], s[8:9]
    v_cndmask_b32 v3, v3, v110, s[16:17]
    v_cndmask_b32 v3, 0, v3, s[10:11]
    v_mfma_f32_16x16x32_bf16 v[68:71], a[20:23], v[180:183], v[68:71]
    v_cndmask_b32 v110, v3, 0, s[6:7]
    v_cndmask_b32 v111, 0, v3, s[6:7]
    v_mfma_f32_16x16x32_bf16 v[64:67], a[20:23], v[172:175], v[64:67]
    v_mov_b32 v24, 0xc1800000
    v_mov_b32 v25, 0x41317218
    s_waitcnt lgkmcnt(4)
    v_mfma_f32_16x16x32_bf16 v[60:63], a[20:23], v[164:167], v[60:63]
    ds_write_b128 v42, v[56:59] offset:0
    v_lshlrev_b32 v8, 16, v32
    v_mfma_f32_16x16x32_bf16 v[76:79], a[24:27], a[112:115], v[76:79]
    v_and_b32 v9, 0xffff0000, v32
    v_lshlrev_b32 v10, 16, v33
    v_mfma_f32_16x16x32_bf16 v[80:83], a[24:27], a[116:119], v[80:83]
    v_and_b32 v11, 0xffff0000, v33
    v_lshlrev_b32 v12, 16, v34
    v_mfma_f32_16x16x32_bf16 v[84:87], a[24:27], a[120:123], v[84:87]
    v_and_b32 v13, 0xffff0000, v34
    v_lshlrev_b32 v14, 16, v35
    v_mfma_f32_16x16x32_bf16 v[88:91], a[24:27], a[124:127], v[88:91]
    v_and_b32 v15, 0xffff0000, v35
    v_lshlrev_b32 v16, 16, v36
    v_mfma_f32_16x16x32_bf16 v[88:91], a[28:31], v[156:159], v[88:91]
    ds_write_b128 v40, v[64:67] offset:1024
    v_and_b32 v17, 0xffff0000, v36
    v_mfma_f32_16x16x32_bf16 v[84:87], a[28:31], v[148:151], v[84:87]
    v_lshlrev_b32 v18, 16, v37
    v_and_b32 v19, 0xffff0000, v37
    v_mfma_f32_16x16x32_bf16 v[80:83], a[28:31], v[140:143], v[80:83]
    v_lshlrev_b32 v20, 16, v38
    v_and_b32 v21, 0xffff0000, v38
    v_mfma_f32_16x16x32_bf16 v[76:79], a[28:31], v[132:135], v[76:79]
    s_waitcnt lgkmcnt(4)
    ds_write_b128 v41, v[68:71] offset:1024
    v_mfma_f32_16x16x32_bf16 v[76:79], a[32:35], v[164:167], v[76:79]
    v_lshlrev_b32 v22, 16, v39
    v_and_b32 v23, 0xffff0000, v39
    v_mfma_f32_16x16x32_bf16 v[80:83], a[32:35], v[172:175], v[80:83]
    v_mfma_f32_16x16x32_bf16 v[84:87], a[32:35], v[180:183], v[84:87]
    v_mfma_f32_16x16x32_bf16 v[88:91], a[32:35], v[188:191], v[88:91]
    ds_write_b128 v42, v[72:75] offset:1024
    v_mfma_f32_16x16x32_bf16 v[104:107], a[36:39], a[124:127], v[104:107]
    v_mfma_f32_16x16x32_bf16 v[100:103], a[36:39], a[120:123], v[100:103]
    v_mfma_f32_16x16x32_bf16 v[96:99], a[36:39], a[116:119], v[96:99]
    v_mfma_f32_16x16x32_bf16 v[92:95], a[36:39], a[112:115], v[92:95]
    v_mfma_f32_16x16x32_bf16 v[92:95], a[40:43], v[132:135], v[92:95]
    ds_write_b128 v40, v[80:83] offset:2048
    v_mfma_f32_16x16x32_bf16 v[96:99], a[40:43], v[140:143], v[96:99]
    v_mfma_f32_16x16x32_bf16 v[100:103], a[40:43], v[148:151], v[100:103]
    ds_write_b128 v41, v[84:87] offset:2048
    v_mfma_f32_16x16x32_bf16 v[104:107], a[40:43], v[156:159], v[104:107]
    v_mfma_f32_16x16x32_bf16 v[104:107], a[44:47], v[188:191], v[104:107]
    v_mfma_f32_16x16x32_bf16 v[100:103], a[44:47], v[180:183], v[100:103]
    ds_write_b128 v42, v[88:91] offset:2048
    v_mfma_f32_16x16x32_bf16 v[96:99], a[44:47], v[172:175], v[96:99]
    v_mfma_f32_16x16x32_bf16 v[92:95], a[44:47], v[164:167], v[92:95]
    s_waitcnt vmcnt(0)
    v_cmp_ne_u32 vcc, 1, v30
    s_nop 0
    s_cbranch_vccnz L_spin2
L_spin2_ret:
    s_add_u32 s70, s89, 10240
    buffer_load_dwordx4 a[144:147], v2, s[56:59], s70 offen offset:0 sc1
    buffer_load_dwordx4 a[152:155], v2, s[56:59], s70 offen offset:1024 sc1
    s_add_u32 s70, s89, 43008
    buffer_load_dwordx4 a[148:151], v2, s[56:59], s70 offen offset:0 sc1
    buffer_load_dwordx4 a[156:159], v2, s[56:59], s70 offen offset:1024 sc1
    ds_write_b128 v40, v[96:99] offset:3072
    v_mfma_f32_16x16x32_bf16 v[196:199], v[110:113], v[128:131], 0
    ds_write_b128 v41, v[100:103] offset:3072
    v_mfma_f32_16x16x32_bf16 v[204:207], v[108:111], v[128:131], 0
    ds_write_b128 v42, v[104:107] offset:3072
    v_mfma_f32_16x16x32_bf16 v[196:199], v[110:113], v[144:147], v[196:199]
    s_add_u32 s70, s89, 12288
    buffer_load_dwordx4 a[160:163], v2, s[56:59], s70 offen offset:0 sc1
    v_mfma_f32_16x16x32_bf16 v[204:207], v[108:111], v[144:147], v[204:207]
    buffer_load_dwordx4 a[168:171], v2, s[56:59], s70 offen offset:1024 sc1
    v_mfma_f32_16x16x32_bf16 v[212:215], v[110:113], v[136:139], 0
    s_add_u32 s70, s89, 45056
    buffer_load_dwordx4 a[164:167], v2, s[56:59], s70 offen offset:0 sc1
    v_mfma_f32_16x16x32_bf16 v[220:223], v[108:111], v[136:139], 0
    buffer_load_dwordx4 a[172:175], v2, s[56:59], s70 offen offset:1024 sc1
    v_mfma_f32_16x16x32_bf16 v[212:215], v[110:113], v[152:155], v[212:215]
    s_add_u32 s70, s89, 14336
    buffer_load_dwordx4 a[176:179], v2, s[56:59], s70 offen offset:0 sc1
    v_mfma_f32_16x16x32_bf16 v[220:223], v[108:111], v[152:155], v[220:223]
    buffer_load_dwordx4 a[184:187], v2, s[56:59], s70 offen offset:1024 sc1
    v_mfma_f32_16x16x32_bf16 v[196:199], v[110:113], v[160:163], v[196:199]
    s_add_u32 s70, s89, 47104
    buffer_load_dwordx4 a[180:183], v2, s[56:59], s70 offen offset:0 sc1
    v_mfma_f32_16x16x32_bf16 v[204:207], v[108:111], v[160:163], v[204:207]
    buffer_load_dwordx4 a[188:191], v2, s[56:59], s70 offen offset:1024 sc1
    v_mfma_f32_16x16x32_bf16 v[196:199], v[110:113], v[176:179], v[196:199]
    s_waitcnt lgkmcnt(0)
    s_barrier
    ds_read_b128 v[48:51], v120 offset:0
    v_mfma_f32_16x16x32_bf16 v[204:207], v[108:111], v[176:179], v[204:207]
    ds_read_b128 v[52:55], v121 offset:0
    v_mfma_f32_16x16x32_bf16 v[212:215], v[110:113], v[168:171], v[212:215]
    ds_read_b128 v[56:59], v124 offset:0
    v_mfma_f32_16x16x32_bf16 v[220:223], v[108:111], v[168:171], v[220:223]
    ds_read_b128 v[64:67], v120 offset:1024
    v_mfma_f32_16x16x32_bf16 v[212:215], v[110:113], v[184:187], v[212:215]
    ds_read_b128 v[68:71], v121 offset:1024
    v_mfma_f32_16x16x32_bf16 v[220:223], v[108:111], v[184:187], v[220:223]
    ds_read_b128 v[72:75], v124 offset:1024
    v_mfma_f32_16x16x32_bf16 v[196:199], v[110:113], v[192:195], v[196:199]
    ds_read_b128 v[80:83], v120 offset:2048
    v_mfma_f32_16x16x32_bf16 v[204:207], v[108:111], v[192:195], v[204:207]
    ds_read_b128 v[84:87], v121 offset:2048
    v_mfma_f32_16x16x32_bf16 v[196:199], v[110:113], v[208:211], v[196:199]
    ds_read_b128 v[88:91], v124 offset:2048
    v_mfma_f32_16x16x32_bf16 v[204:207], v[108:111], v[208:211], v[204:207]
    ds_read_b128 v[96:99], v120 offset:3072
    v_mfma_f32_16x16x32_bf16 v[212:215], v[110:113], v[200:203], v[212:215]
    ds_read_b128 v[100:103], v121 offset:3072
    v_mfma_f32_16x16x32_bf16 v[220:223], v[108:111], v[200:203], v[220:223]
    ds_read_b128 v[104:107], v124 offset:3072
    v_mfma_f32_16x16x32_bf16 v[212:215], v[110:113], v[216:219], v[212:215]
    s_waitcnt lgkmcnt(11)
    v_pk_add_f32 v[44:45], v[44:45], v[48:49]
    s_waitcnt lgkmcnt(9)
    v_pk_add_f32 v[52:53], v[52:53], v[56:57]
    v_pk_add_f32 v[46:47], v[46:47], v[50:51]
    v_pk_add_f32 v[54:55], v[54:55], v[58:59]
    v_pk_add_f32 v[44:45], v[44:45], v[52:53]
    v_pk_add_f32 v[46:47], v[46:47], v[54:55]
    v_pk_mul_f32 v[48:49], v[44:45], v[24:25] op_sel:[0,0] op_sel_hi:[1,0]
    v_pk_mul_f32 v[50:51], v[46:47], v[24:25] op_sel:[0,0] op_sel_hi:[1,0]
    v_pk_mul_f32 v[44:45], v[44:45], v[24:25] op_sel:[0,1] op_sel_hi:[1,1]
    v_pk_mul_f32 v[46:47], v[46:47], v[24:25] op_sel:[0,1] op_sel_hi:[1,1]
    s_waitcnt lgkmcnt(8)
    v_pk_add_f32 v[60:61], v[60:61], v[64:65]
    s_waitcnt lgkmcnt(6)
    v_pk_add_f32 v[68:69], v[68:69], v[72:73]
    v_pk_add_f32 v[62:63], v[62:63], v[66:67]
    v_pk_add_f32 v[70:71], v[70:71], v[74:75]
    v_pk_add_f32 v[60:61], v[60:61], v[68:69]
    v_pk_add_f32 v[62:63], v[62:63], v[70:71]
    v_pk_mul_f32 v[64:65], v[60:61], v[24:25] op_sel:[0,0] op_sel_hi:[1,0]
    v_pk_mul_f32 v[66:67], v[62:63], v[24:25] op_sel:[0,0] op_sel_hi:[1,0]
    v_pk_mul_f32 v[60:61], v[60:61], v[24:25] op_sel:[0,1] op_sel_hi:[1,1]
    v_pk_mul_f32 v[62:63], v[62:63], v[24:25] op_sel:[0,1] op_sel_hi:[1,1]
    s_waitcnt lgkmcnt(5)
    v_pk_add_f32 v[76:77], v[76:77], v[80:81]
    s_waitcnt lgkmcnt(3)
    v_pk_add_f32 v[84:85], v[84:85], v[88:89]
    v_pk_add_f32 v[78:79], v[78:79], v[82:83]
    v_pk_add_f32 v[86:87], v[86:87], v[90:91]
    v_pk_add_f32 v[76:77], v[76:77], v[84:85]
    v_pk_add_f32 v[78:79], v[78:79], v[86:87]
    v_pk_mul_f32 v[80:81], v[76:77], v[24:25] op_sel:[0,0] op_sel_hi:[1,0]
    v_pk_mul_f32 v[82:83], v[78:79], v[24:25] op_sel:[0,0] op_sel_hi:[1,0]
    v_pk_mul_f32 v[76:77], v[76:77], v[24:25] op_sel:[0,1] op_sel_hi:[1,1]
    v_pk_mul_f32 v[78:79], v[78:79], v[24:25] op_sel:[0,1] op_sel_hi:[1,1]
    s_waitcnt lgkmcnt(2)
    v_pk_add_f32 v[92:93], v[92:93], v[96:97]
    s_waitcnt lgkmcnt(0)
    v_pk_add_f32 v[100:101], v[100:101], v[104:105]
    v_pk_add_f32 v[94:95], v[94:95], v[98:99]
    v_pk_add_f32 v[102:103], v[102:103], v[106:107]
    v_pk_add_f32 v[92:93], v[92:93], v[100:101]
    v_pk_add_f32 v[94:95], v[94:95], v[102:103]
    v_pk_mul_f32 v[96:97], v[92:93], v[24:25] op_sel:[0,0] op_sel_hi:[1,0]
    v_pk_mul_f32 v[98:99], v[94:95], v[24:25] op_sel:[0,0] op_sel_hi:[1,0]
    v_pk_mul_f32 v[92:93], v[92:93], v[24:25] op_sel:[0,1] op_sel_hi:[1,1]
    v_pk_mul_f32 v[94:95], v[94:95], v[24:25] op_sel:[0,1] op_sel_hi:[1,1]
    s_nop 2
    v_mfma_f32_16x16x32_bf16 v[220:223], v[108:111], v[216:219], v[220:223]
    v_exp_f32 v48, v48
    v_mfma_f32_16x16x32_bf16 v[196:199], v[110:113], v[224:227], v[196:199]
    v_exp_f32 v49, v49
    v_mfma_f32_16x16x32_bf16 v[204:207], v[108:111], v[224:227], v[204:207]
    v_exp_f32 v50, v50
    v_mfma_f32_16x16x32_bf16 v[196:199], v[110:113], v[240:243], v[196:199]
    v_exp_f32 v51, v51
    v_mfma_f32_16x16x32_bf16 v[204:207], v[108:111], v[240:243], v[204:207]
    v_exp_f32 v64, v64
    v_mfma_f32_16x16x32_bf16 v[212:215], v[110:113], v[232:235], v[212:215]
    v_exp_f32 v65, v65
    v_mfma_f32_16x16x32_bf16 v[220:223], v[108:111], v[232:235], v[220:223]
    v_exp_f32 v66, v66
    v_mfma_f32_16x16x32_bf16 v[212:215], v[110:113], v[248:251], v[212:215]
    v_exp_f32 v67, v67
    v_mfma_f32_16x16x32_bf16 v[220:223], v[108:111], v[248:251], v[220:223]
    v_exp_f32 v80, v80
    v_mfma_f32_16x16x32_bf16 v[196:199], v[110:113], a[128:131], v[196:199]
    v_exp_f32 v81, v81
    v_mfma_f32_16x16x32_bf16 v[204:207], v[108:111], a[128:131], v[204:207]
    v_exp_f32 v82, v82
    v_mfma_f32_16x16x32_bf16 v[196:199], v[110:113], a[136:139], v[196:199]
    v_exp_f32 v83, v83
    v_mfma_f32_16x16x32_bf16 v[204:207], v[108:111], a[136:139], v[204:207]
    v_exp_f32 v96, v96
    v_mfma_f32_16x16x32_bf16 v[212:215], v[110:113], a[132:135], v[212:215]
    v_exp_f32 v97, v97
    v_mfma_f32_16x16x32_bf16 v[220:223], v[108:111], a[132:135], v[220:223]
    v_exp_f32 v98, v98
    v_mfma_f32_16x16x32_bf16 v[212:215], v[110:113], a[140:143], v[212:215]
    v_exp_f32 v99, v99
    v_pk_add_f32 v[48:49], v[48:49], 1.0 op_sel_hi:[1,0]
    v_pk_add_f32 v[50:51], v[50:51], 1.0 op_sel_hi:[1,0]
    v_pk_add_f32 v[64:65], v[64:65], 1.0 op_sel_hi:[1,0]
    v_pk_add_f32 v[66:67], v[66:67], 1.0 op_sel_hi:[1,0]
    v_pk_add_f32 v[80:81], v[80:81], 1.0 op_sel_hi:[1,0]
    v_pk_add_f32 v[82:83], v[82:83], 1.0 op_sel_hi:[1,0]
    v_pk_add_f32 v[96:97], v[96:97], 1.0 op_sel_hi:[1,0]
    v_pk_add_f32 v[98:99], v[98:99], 1.0 op_sel_hi:[1,0]
    s_nop 2
    v_mfma_f32_16x16x32_bf16 v[220:223], v[108:111], a[140:143], v[220:223]
    v_rcp_f32 v48, v48
    s_waitcnt vmcnt(11)
    v_mfma_f32_16x16x32_bf16 v[196:199], v[110:113], a[144:147], v[196:199]
    v_rcp_f32 v49, v49
    v_mfma_f32_16x16x32_bf16 v[204:207], v[108:111], a[144:147], v[204:207]
    v_rcp_f32 v50, v50
    s_waitcnt vmcnt(10)
    v_mfma_f32_16x16x32_bf16 v[196:199], v[110:113], a[152:155], v[196:199]
    v_rcp_f32 v51, v51
    v_mfma_f32_16x16x32_bf16 v[204:207], v[108:111], a[152:155], v[204:207]
    v_rcp_f32 v64, v64
    s_waitcnt vmcnt(9)
    v_mfma_f32_16x16x32_bf16 v[212:215], v[110:113], a[148:151], v[212:215]
    v_rcp_f32 v65, v65
    v_mfma_f32_16x16x32_bf16 v[220:223], v[108:111], a[148:151], v[220:223]
    v_rcp_f32 v66, v66
    s_waitcnt vmcnt(8)
    v_mfma_f32_16x16x32_bf16 v[212:215], v[110:113], a[156:159], v[212:215]
    v_rcp_f32 v67, v67
    v_mfma_f32_16x16x32_bf16 v[220:223], v[108:111], a[156:159], v[220:223]
    v_rcp_f32 v80, v80
    s_waitcnt vmcnt(7)
    v_mfma_f32_16x16x32_bf16 v[196:199], v[110:113], a[160:163], v[196:199]
    v_rcp_f32 v81, v81
    v_mfma_f32_16x16x32_bf16 v[204:207], v[108:111], a[160:163], v[204:207]
    v_rcp_f32 v82, v82
    s_waitcnt vmcnt(6)
    v_mfma_f32_16x16x32_bf16 v[196:199], v[110:113], a[168:171], v[196:199]
    v_rcp_f32 v83, v83
    v_mfma_f32_16x16x32_bf16 v[204:207], v[108:111], a[168:171], v[204:207]
    v_rcp_f32 v96, v96
    v_rcp_f32 v97, v97
    v_rcp_f32 v98, v98
    v_rcp_f32 v99, v99
    s_waitcnt vmcnt(5)
    v_mfma_f32_16x16x32_bf16 v[212:215], v[110:113], a[164:167], v[212:215]
    v_mul_f32 v44, v44, v48
    v_mul_f32 v45, v45, v49
    v_mfma_f32_16x16x32_bf16 v[220:223], v[108:111], a[164:167], v[220:223]
    v_mul_f32 v46, v46, v50
    v_mul_f32 v47, v47, v51
    s_waitcnt vmcnt(4)
    v_mfma_f32_16x16x32_bf16 v[212:215], v[110:113], a[172:175], v[212:215]
    v_mul_f32 v60, v60, v64
    v_mul_f32 v61, v61, v65
    v_mfma_f32_16x16x32_bf16 v[220:223], v[108:111], a[172:175], v[220:223]
    v_mul_f32 v62, v62, v66
    v_mul_f32 v63, v63, v67
    s_waitcnt vmcnt(3)
    v_mfma_f32_16x16x32_bf16 v[196:199], v[110:113], a[176:179], v[196:199]
    v_mul_f32 v76, v76, v80
    v_mul_f32 v77, v77, v81
    v_mfma_f32_16x16x32_bf16 v[204:207], v[108:111], a[176:179], v[204:207]
    v_mul_f32 v78, v78, v82
    v_mul_f32 v79, v79, v83
    s_waitcnt vmcnt(2)
    v_mfma_f32_16x16x32_bf16 v[196:199], v[110:113], a[184:187], v[196:199]
    v_mul_f32 v92, v92, v96
    v_mul_f32 v93, v93, v97
    v_mfma_f32_16x16x32_bf16 v[204:207], v[108:111], a[184:187], v[204:207]
    v_mul_f32 v94, v94, v98
    v_mul_f32 v95, v95, v99
    s_waitcnt vmcnt(1)
    v_mfma_f32_16x16x32_bf16 v[212:215], v[110:113], a[180:183], v[212:215]
    v_mfma_f32_16x16x32_bf16 v[220:223], v[108:111], a[180:183], v[220:223]
    s_waitcnt vmcnt(0)
    v_mfma_f32_16x16x32_bf16 v[212:215], v[110:113], a[188:191], v[212:215]
    v_mfma_f32_16x16x32_bf16 v[220:223], v[108:111], a[188:191], v[220:223]
    v_pk_fma_f32 v[44:45], v[196:197], v[44:45], v[8:9]
    v_pk_fma_f32 v[46:47], v[198:199], v[46:47], v[10:11]
    v_cvt_pk_bf16_f32 v44, v44, v45
    v_cvt_pk_bf16_f32 v45, v46, v47
    ds_write_b64 v26, v[44:45] offset:0
    v_pk_fma_f32 v[60:61], v[204:205], v[60:61], v[12:13]
    v_pk_fma_f32 v[62:63], v[206:207], v[62:63], v[14:15]
    v_cvt_pk_bf16_f32 v60, v60, v61
    v_cvt_pk_bf16_f32 v61, v62, v63
    ds_write_b64 v26, v[60:61] offset:32
    v_pk_fma_f32 v[76:77], v[212:213], v[76:77], v[16:17]
    v_pk_fma_f32 v[78:79], v[214:215], v[78:79], v[18:19]
    v_cvt_pk_bf16_f32 v76, v76, v77
    v_cvt_pk_bf16_f32 v77, v78, v79
    ds_write_b64 v26, v[76:77] offset:64
    v_pk_fma_f32 v[92:93], v[220:221], v[92:93], v[20:21]
    v_pk_fma_f32 v[94:95], v[222:223], v[94:95], v[22:23]
    v_cvt_pk_bf16_f32 v92, v92, v93
    v_cvt_pk_bf16_f32 v93, v94, v95
    ds_write_b64 v26, v[92:93] offset:96
    ds_read_b128 v[32:35], v7
    ds_read_b128 v[36:39], v7 offset:1152
    s_waitcnt lgkmcnt(1)
    buffer_store_dwordx4 v[32:35], v125, s[60:63], 0 offen
    s_waitcnt lgkmcnt(0)
    buffer_store_dwordx4 v[36:39], v125, s[60:63], s13 offen
L_end:
    s_endpgm
L_spinh:
    s_mov_b32 s92, 131072
L_spinh_loop:
    s_sleep 1
    s_lshl_b32 s69, s19, 4
    v_mov_b32 v3, s69
    global_load_dword v30, v3, s[22:23] sc1
    s_waitcnt vmcnt(0)
    v_cmp_gt_u32 vcc, 16, v30
    s_sub_u32 s92, s92, 1
    s_cmp_eq_u32 s92, 0
    s_cbranch_scc1 L_spinh_ret
    s_cbranch_vccnz L_spinh_loop
    s_branch L_spinh_ret
L_spin1:
    s_mov_b32 s92, 131072
L_spin1_loop:
    s_sleep 1
    buffer_load_ubyte v30, v123, s[56:59], s91 offen offset:128 sc1
    s_waitcnt vmcnt(0)
    v_cmp_ne_u32 vcc, 1, v30
    s_sub_u32 s92, s92, 1
    s_cmp_eq_u32 s92, 0
    s_cbranch_scc1 L_spin1_ret
    s_cbranch_vccnz L_spin1_loop
    s_branch L_spin1_ret
L_spin2:
    s_mov_b32 s92, 131072
L_spin2_loop:
    s_sleep 1
    buffer_load_ubyte v30, v123, s[56:59], s91 offen offset:256 sc1
    s_waitcnt vmcnt(0)
    v_cmp_ne_u32 vcc, 1, v30
    s_sub_u32 s92, s92, 1
    s_cmp_eq_u32 s92, 0
    s_cbranch_scc1 L_spin2_ret
    s_cbranch_vccnz L_spin2_loop
    s_branch L_spin2_ret
L_redo:
    s_waitcnt vmcnt(0)
    s_add_u32 s70, s89, 0
    buffer_load_dwordx4 v[128:131], v2, s[56:59], s70 offen offset:0 sc1
    buffer_load_dwordx4 v[144:147], v2, s[56:59], s70 offen offset:1024 sc1
    s_add_u32 s70, s89, 32768
    buffer_load_dwordx4 v[136:139], v2, s[56:59], s70 offen offset:0 sc1
    buffer_load_dwordx4 v[152:155], v2, s[56:59], s70 offen offset:1024 sc1
    s_add_u32 s70, s89, 2048
    buffer_load_dwordx4 v[160:163], v2, s[56:59], s70 offen offset:0 sc1
    buffer_load_dwordx4 v[176:179], v2, s[56:59], s70 offen offset:1024 sc1
    s_add_u32 s70, s89, 34816
    buffer_load_dwordx4 v[168:171], v2, s[56:59], s70 offen offset:0 sc1
    buffer_load_dwordx4 v[184:187], v2, s[56:59], s70 offen offset:1024 sc1
    s_add_u32 s70, s89, 4096
    buffer_load_dwordx4 v[192:195], v2, s[56:59], s70 offen offset:0 sc1
    buffer_load_dwordx4 v[208:211], v2, s[56:59], s70 offen offset:1024 sc1
    s_add_u32 s70, s89, 36864
    buffer_load_dwordx4 v[200:203], v2, s[56:59], s70 offen offset:0 sc1
    buffer_load_dwordx4 v[216:219], v2, s[56:59], s70 offen offset:1024 sc1
    s_branch L_redo_ret
L_exact:
    s_waitcnt vmcnt(0) lgkmcnt(0)
    s_nop 15
    s_mov_b32 s12, m0
    v_and_b32 v116, 15, v0
    v_lshlrev_b32 v116, 9, v116
    v_and_b32 v102, 48, v0
    v_add_u32 v116, v116, v102
    s_lshl_b32 s13, s64, 7
    s_add_u32 s14, s67, 147456
    v_subrev_u32 v117, s13, v40
    v_add_u32 v121, s14, v8
    v_subrev_u32 v118, s13, v41
    v_add_u32 v122, s14, v9
    v_subrev_u32 v119, s13, v42
    v_add_u32 v123, s14, v10
    v_subrev_u32 v120, s13, v43
    v_add_u32 v124, s14, v11
    v_mov_b32 v102, 0xff800000
    v_mov_b32 v103, 0xff800000
    s_mov_b32 s13, 0
L_exact_p1:
    buffer_load_dwordx4 v[44:47], v116, s[40:43], s13 offen offset:0
    buffer_load_dwordx4 v[48:51], v116, s[40:43], s13 offen offset:64
    buffer_load_dwordx4 v[52:55], v116, s[40:43], s13 offen offset:128
    buffer_load_dwordx4 v[56:59], v116, s[40:43], s13 offen offset:192
    buffer_load_dwordx4 v[60:63], v116, s[40:43], s13 offen offset:256
    buffer_load_dwordx4 v[64:67], v116, s[40:43], s13 offen offset:320
    buffer_load_dwordx4 v[68:71], v116, s[40:43], s13 offen offset:384
    buffer_load_dwordx4 v[72:75], v116, s[40:43], s13 offen offset:448
    s_add_u32 s13, s13, 8192
    s_waitcnt vmcnt(0)
    v_mfma_f32_16x16x32_bf16 v[76:79], v[44:47], a[64:67], 0
    v_mfma_f32_16x16x32_bf16 v[84:87], v[44:47], a[68:71], 0
    v_mfma_f32_16x16x32_bf16 v[76:79], v[48:51], a[72:75], v[76:79]
    v_mfma_f32_16x16x32_bf16 v[84:87], v[48:51], a[76:79], v[84:87]
    v_mfma_f32_16x16x32_bf16 v[76:79], v[52:55], a[80:83], v[76:79]
    v_mfma_f32_16x16x32_bf16 v[84:87], v[52:55], a[84:87], v[84:87]
    v_mfma_f32_16x16x32_bf16 v[76:79], v[56:59], a[88:91], v[76:79]
    v_mfma_f32_16x16x32_bf16 v[84:87], v[56:59], a[92:95], v[84:87]
    v_mfma_f32_16x16x32_bf16 v[76:79], v[60:63], a[96:99], v[76:79]
    v_mfma_f32_16x16x32_bf16 v[84:87], v[60:63], a[100:103], v[84:87]
    v_mfma_f32_16x16x32_bf16 v[76:79], v[64:67], a[104:107], v[76:79]
    v_mfma_f32_16x16x32_bf16 v[84:87], v[64:67], a[108:111], v[84:87]
    v_mfma_f32_16x16x32_bf16 v[76:79], v[68:71], a[112:115], v[76:79]
    v_mfma_f32_16x16x32_bf16 v[84:87], v[68:71], a[116:119], v[84:87]
    v_mfma_f32_16x16x32_bf16 v[76:79], v[72:75], a[120:123], v[76:79]
    v_mfma_f32_16x16x32_bf16 v[84:87], v[72:75], a[124:127], v[84:87]
    s_nop 15
    v_max3_f32 v102, v102, v76, v77
    v_max3_f32 v102, v102, v78, v79
    v_max3_f32 v103, v103, v84, v85
    v_max3_f32 v103, v103, v86, v87
    s_cmp_lt_u32 s13, 262144
    s_cbranch_scc1 L_exact_p1
    v_mov_b32 v104, v102
    s_nop 1
    v_permlane32_swap_b32 v102, v104
    v_max_f32 v102, v102, v104
    v_mov_b32 v104, v102
    s_nop 1
    v_permlane16_swap_b32 v102, v104
    v_max_f32 v102, v102, v104
    v_sub_f32 v92, 0, v102
    v_sub_f32 v93, 0, v102
    v_sub_f32 v94, 0, v102
    v_sub_f32 v95, 0, v102
    v_mov_b32 v104, v103
    s_nop 1
    v_permlane32_swap_b32 v103, v104
    v_max_f32 v103, v103, v104
    v_mov_b32 v104, v103
    s_nop 1
    v_permlane16_swap_b32 v103, v104
    v_max_f32 v103, v103, v104
    v_sub_f32 v96, 0, v103
    v_sub_f32 v97, 0, v103
    v_sub_f32 v98, 0, v103
    v_sub_f32 v99, 0, v103
    v_mov_b32 v128, 0
    v_mov_b32 v129, 0
    v_mov_b32 v130, 0
    v_mov_b32 v131, 0
    v_mov_b32 v132, 0
    v_mov_b32 v133, 0
    v_mov_b32 v134, 0
    v_mov_b32 v135, 0
    v_mov_b32 v136, 0
    v_mov_b32 v137, 0
    v_mov_b32 v138, 0
    v_mov_b32 v139, 0
    v_mov_b32 v140, 0
    v_mov_b32 v141, 0
    v_mov_b32 v142, 0
    v_mov_b32 v143, 0
    v_mov_b32 v144, 0
    v_mov_b32 v145, 0
    v_mov_b32 v146, 0
    v_mov_b32 v147, 0
    v_mov_b32 v148, 0
    v_mov_b32 v149, 0
    v_mov_b32 v150, 0
    v_mov_b32 v151, 0
    v_mov_b32 v152, 0
    v_mov_b32 v153, 0
    v_mov_b32 v154, 0
    v_mov_b32 v155, 0
    v_mov_b32 v156, 0
    v_mov_b32 v157, 0
    v_mov_b32 v158, 0
    v_mov_b32 v159, 0
    v_mov_b32 v160, 0
    v_mov_b32 v161, 0
    v_mov_b32 v162, 0
    v_mov_b32 v163, 0
    v_mov_b32 v164, 0
    v_mov_b32 v165, 0
    v_mov_b32 v166, 0
    v_mov_b32 v167, 0
    v_mov_b32 v168, 0
    v_mov_b32 v169, 0
    v_mov_b32 v170, 0
    v_mov_b32 v171, 0
    v_mov_b32 v172, 0
    v_mov_b32 v173, 0
    v_mov_b32 v174, 0
    v_mov_b32 v175, 0
    v_mov_b32 v176, 0
    v_mov_b32 v177, 0
    v_mov_b32 v178, 0
    v_mov_b32 v179, 0
    v_mov_b32 v180, 0
    v_mov_b32 v181, 0
    v_mov_b32 v182, 0
    v_mov_b32 v183, 0
    v_mov_b32 v184, 0
    v_mov_b32 v185, 0
    v_mov_b32 v186, 0
    v_mov_b32 v187, 0
    v_mov_b32 v188, 0
    v_mov_b32 v189, 0
    v_mov_b32 v190, 0
    v_mov_b32 v191, 0
    v_mov_b32 v192, 0
    v_mov_b32 v193, 0
    v_mov_b32 v194, 0
    v_mov_b32 v195, 0
    v_mov_b32 v196, 0
    v_mov_b32 v197, 0
    v_mov_b32 v198, 0
    v_mov_b32 v199, 0
    v_mov_b32 v200, 0
    v_mov_b32 v201, 0
    v_mov_b32 v202, 0
    v_mov_b32 v203, 0
    v_mov_b32 v204, 0
    v_mov_b32 v205, 0
    v_mov_b32 v206, 0
    v_mov_b32 v207, 0
    v_mov_b32 v208, 0
    v_mov_b32 v209, 0
    v_mov_b32 v210, 0
    v_mov_b32 v211, 0
    v_mov_b32 v212, 0
    v_mov_b32 v213, 0
    v_mov_b32 v214, 0
    v_mov_b32 v215, 0
    v_mov_b32 v216, 0
    v_mov_b32 v217, 0
    v_mov_b32 v218, 0
    v_mov_b32 v219, 0
    v_mov_b32 v220, 0
    v_mov_b32 v221, 0
    v_mov_b32 v222, 0
    v_mov_b32 v223, 0
    v_mov_b32 v224, 0
    v_mov_b32 v225, 0
    v_mov_b32 v226, 0
    v_mov_b32 v227, 0
    v_mov_b32 v228, 0
    v_mov_b32 v229, 0
    v_mov_b32 v230, 0
    v_mov_b32 v231, 0
    v_mov_b32 v232, 0
    v_mov_b32 v233, 0
    v_mov_b32 v234, 0
    v_mov_b32 v235, 0
    v_mov_b32 v236, 0
    v_mov_b32 v237, 0
    v_mov_b32 v238, 0
    v_mov_b32 v239, 0
    v_mov_b32 v240, 0
    v_mov_b32 v241, 0
    v_mov_b32 v242, 0
    v_mov_b32 v243, 0
    v_mov_b32 v244, 0
    v_mov_b32 v245, 0
    v_mov_b32 v246, 0
    v_mov_b32 v247, 0
    v_mov_b32 v248, 0
    v_mov_b32 v249, 0
    v_mov_b32 v250, 0
    v_mov_b32 v251, 0
    v_mov_b32 v252, 0
    v_mov_b32 v253, 0
    v_mov_b32 v254, 0
    v_mov_b32 v255, 0
    v_mov_b32 v100, 0
    v_mov_b32 v101, 0
    s_mov_b32 s13, 0
    s_add_u32 m0, s67, 147456
    s_nop 3
L_exact_p2:
    s_mov_b32 s14, s13
    buffer_load_dwordx4 v[44:47], v116, s[40:43], s13 offen offset:0
    buffer_load_dwordx4 v[48:51], v116, s[40:43], s13 offen offset:64
    buffer_load_dwordx4 v[52:55], v116, s[40:43], s13 offen offset:128
    buffer_load_dwordx4 v[56:59], v116, s[40:43], s13 offen offset:192
    buffer_load_dwordx4 v[60:63], v116, s[40:43], s13 offen offset:256
    buffer_load_dwordx4 v[64:67], v116, s[40:43], s13 offen offset:320
    buffer_load_dwordx4 v[68:71], v116, s[40:43], s13 offen offset:384
    buffer_load_dwordx4 v[72:75], v116, s[40:43], s13 offen offset:448
    s_add_u32 s13, s13, 8192
    s_waitcnt vmcnt(0)
    v_mfma_f32_16x16x32_bf16 v[76:79], v[44:47], a[64:67], v[92:95]
    v_mfma_f32_16x16x32_bf16 v[84:87], v[44:47], a[68:71], v[96:99]
    v_mfma_f32_16x16x32_bf16 v[76:79], v[48:51], a[72:75], v[76:79]
    v_mfma_f32_16x16x32_bf16 v[84:87], v[48:51], a[76:79], v[84:87]
    v_mfma_f32_16x16x32_bf16 v[76:79], v[52:55], a[80:83], v[76:79]
    v_mfma_f32_16x16x32_bf16 v[84:87], v[52:55], a[84:87], v[84:87]
    v_mfma_f32_16x16x32_bf16 v[76:79], v[56:59], a[88:91], v[76:79]
    v_mfma_f32_16x16x32_bf16 v[84:87], v[56:59], a[92:95], v[84:87]
    v_mfma_f32_16x16x32_bf16 v[76:79], v[60:63], a[96:99], v[76:79]
    v_mfma_f32_16x16x32_bf16 v[84:87], v[60:63], a[100:103], v[84:87]
    v_mfma_f32_16x16x32_bf16 v[76:79], v[64:67], a[104:107], v[76:79]
    v_mfma_f32_16x16x32_bf16 v[84:87], v[64:67], a[108:111], v[84:87]
    v_mfma_f32_16x16x32_bf16 v[76:79], v[68:71], a[112:115], v[76:79]
    v_mfma_f32_16x16x32_bf16 v[84:87], v[68:71], a[116:119], v[84:87]
    v_mfma_f32_16x16x32_bf16 v[76:79], v[72:75], a[120:123], v[76:79]
    v_mfma_f32_16x16x32_bf16 v[84:87], v[72:75], a[124:127], v[84:87]
    s_nop 15
    buffer_load_dwordx4 v[44:47], v116, s[40:43], s13 offen offset:0
    buffer_load_dwordx4 v[48:51], v116, s[40:43], s13 offen offset:64
    buffer_load_dwordx4 v[52:55], v116, s[40:43], s13 offen offset:128
    buffer_load_dwordx4 v[56:59], v116, s[40:43], s13 offen offset:192
    buffer_load_dwordx4 v[60:63], v116, s[40:43], s13 offen offset:256
    buffer_load_dwordx4 v[64:67], v116, s[40:43], s13 offen offset:320
    buffer_load_dwordx4 v[68:71], v116, s[40:43], s13 offen offset:384
    buffer_load_dwordx4 v[72:75], v116, s[40:43], s13 offen offset:448
    s_add_u32 s13, s13, 8192
    s_waitcnt vmcnt(0)
    v_mfma_f32_16x16x32_bf16 v[80:83], v[44:47], a[64:67], v[92:95]
    v_mfma_f32_16x16x32_bf16 v[88:91], v[44:47], a[68:71], v[96:99]
    v_mfma_f32_16x16x32_bf16 v[80:83], v[48:51], a[72:75], v[80:83]
    v_mfma_f32_16x16x32_bf16 v[88:91], v[48:51], a[76:79], v[88:91]
    v_mfma_f32_16x16x32_bf16 v[80:83], v[52:55], a[80:83], v[80:83]
    v_mfma_f32_16x16x32_bf16 v[88:91], v[52:55], a[84:87], v[88:91]
    v_mfma_f32_16x16x32_bf16 v[80:83], v[56:59], a[88:91], v[80:83]
    v_mfma_f32_16x16x32_bf16 v[88:91], v[56:59], a[92:95], v[88:91]
    v_mfma_f32_16x16x32_bf16 v[80:83], v[60:63], a[96:99], v[80:83]
    v_mfma_f32_16x16x32_bf16 v[88:91], v[60:63], a[100:103], v[88:91]
    v_mfma_f32_16x16x32_bf16 v[80:83], v[64:67], a[104:107], v[80:83]
    v_mfma_f32_16x16x32_bf16 v[88:91], v[64:67], a[108:111], v[88:91]
    v_mfma_f32_16x16x32_bf16 v[80:83], v[68:71], a[112:115], v[80:83]
    v_mfma_f32_16x16x32_bf16 v[88:91], v[68:71], a[116:119], v[88:91]
    v_mfma_f32_16x16x32_bf16 v[80:83], v[72:75], a[120:123], v[80:83]
    v_mfma_f32_16x16x32_bf16 v[88:91], v[72:75], a[124:127], v[88:91]
    s_nop 15
    v_exp_f32 v76, v76
    v_exp_f32 v77, v77
    v_exp_f32 v78, v78
    v_exp_f32 v79, v79
    v_exp_f32 v80, v80
    v_exp_f32 v81, v81
    v_exp_f32 v82, v82
    v_exp_f32 v83, v83
    v_exp_f32 v84, v84
    v_exp_f32 v85, v85
    v_exp_f32 v86, v86
    v_exp_f32 v87, v87
    v_exp_f32 v88, v88
    v_exp_f32 v89, v89
    v_exp_f32 v90, v90
    v_exp_f32 v91, v91
    v_add_f32 v100, v100, v76
    v_add_f32 v100, v100, v77
    v_add_f32 v100, v100, v78
    v_add_f32 v100, v100, v79
    v_add_f32 v100, v100, v80
    v_add_f32 v100, v100, v81
    v_add_f32 v100, v100, v82
    v_add_f32 v100, v100, v83
    v_add_f32 v101, v101, v84
    v_add_f32 v101, v101, v85
    v_add_f32 v101, v101, v86
    v_add_f32 v101, v101, v87
    v_add_f32 v101, v101, v88
    v_add_f32 v101, v101, v89
    v_add_f32 v101, v101, v90
    v_add_f32 v101, v101, v91
    v_cvt_pk_bf16_f32 v108, v76, v77
    v_cvt_pk_bf16_f32 v109, v78, v79
    v_cvt_pk_bf16_f32 v110, v80, v81
    v_cvt_pk_bf16_f32 v111, v82, v83
    v_cvt_pk_bf16_f32 v112, v84, v85
    v_cvt_pk_bf16_f32 v113, v86, v87
    v_cvt_pk_bf16_f32 v114, v88, v89
    v_cvt_pk_bf16_f32 v115, v90, v91
    buffer_load_dwordx4 v117, s[44:47], s14 offen offset:0 lds
    buffer_load_dwordx4 v118, s[44:47], s14 offen offset:1024 lds
    buffer_load_dwordx4 v119, s[44:47], s14 offen offset:2048 lds
    buffer_load_dwordx4 v120, s[44:47], s14 offen offset:3072 lds
    s_add_u32 s14, s14, 128
    s_waitcnt vmcnt(0)
    ds_read_b64_tr_b16 v[44:45], v121
    ds_read_b64_tr_b16 v[46:47], v121 offset:2048
    ds_read_b64_tr_b16 v[48:49], v122
    ds_read_b64_tr_b16 v[50:51], v122 offset:2048
    ds_read_b64_tr_b16 v[52:53], v123
    ds_read_b64_tr_b16 v[54:55], v123 offset:2048
    ds_read_b64_tr_b16 v[56:57], v124
    ds_read_b64_tr_b16 v[58:59], v124 offset:2048
    s_waitcnt lgkmcnt(0)
    v_mfma_f32_16x16x32_bf16 v[128:131], v[44:47], v[108:111], v[128:131]
    v_mfma_f32_16x16x32_bf16 v[136:139], v[44:47], v[112:115], v[136:139]
    v_mfma_f32_16x16x32_bf16 v[132:135], v[48:51], v[108:111], v[132:135]
    v_mfma_f32_16x16x32_bf16 v[140:143], v[48:51], v[112:115], v[140:143]
    v_mfma_f32_16x16x32_bf16 v[144:147], v[52:55], v[108:111], v[144:147]
    v_mfma_f32_16x16x32_bf16 v[152:155], v[52:55], v[112:115], v[152:155]
    v_mfma_f32_16x16x32_bf16 v[148:151], v[56:59], v[108:111], v[148:151]
    v_mfma_f32_16x16x32_bf16 v[156:159], v[56:59], v[112:115], v[156:159]
    s_nop 7
    buffer_load_dwordx4 v117, s[44:47], s14 offen offset:0 lds
    buffer_load_dwordx4 v118, s[44:47], s14 offen offset:1024 lds
    buffer_load_dwordx4 v119, s[44:47], s14 offen offset:2048 lds
    buffer_load_dwordx4 v120, s[44:47], s14 offen offset:3072 lds
    s_add_u32 s14, s14, 128
    s_waitcnt vmcnt(0)
    ds_read_b64_tr_b16 v[44:45], v121
    ds_read_b64_tr_b16 v[46:47], v121 offset:2048
    ds_read_b64_tr_b16 v[48:49], v122
    ds_read_b64_tr_b16 v[50:51], v122 offset:2048
    ds_read_b64_tr_b16 v[52:53], v123
    ds_read_b64_tr_b16 v[54:55], v123 offset:2048
    ds_read_b64_tr_b16 v[56:57], v124
    ds_read_b64_tr_b16 v[58:59], v124 offset:2048
    s_waitcnt lgkmcnt(0)
    v_mfma_f32_16x16x32_bf16 v[160:163], v[44:47], v[108:111], v[160:163]
    v_mfma_f32_16x16x32_bf16 v[168:171], v[44:47], v[112:115], v[168:171]
    v_mfma_f32_16x16x32_bf16 v[164:167], v[48:51], v[108:111], v[164:167]
    v_mfma_f32_16x16x32_bf16 v[172:175], v[48:51], v[112:115], v[172:175]
    v_mfma_f32_16x16x32_bf16 v[176:179], v[52:55], v[108:111], v[176:179]
    v_mfma_f32_16x16x32_bf16 v[184:187], v[52:55], v[112:115], v[184:187]
    v_mfma_f32_16x16x32_bf16 v[180:183], v[56:59], v[108:111], v[180:183]
    v_mfma_f32_16x16x32_bf16 v[188:191], v[56:59], v[112:115], v[188:191]
    s_nop 7
    buffer_load_dwordx4 v117, s[44:47], s14 offen offset:0 lds
    buffer_load_dwordx4 v118, s[44:47], s14 offen offset:1024 lds
    buffer_load_dwordx4 v119, s[44:47], s14 offen offset:2048 lds
    buffer_load_dwordx4 v120, s[44:47], s14 offen offset:3072 lds
    s_add_u32 s14, s14, 128
    s_waitcnt vmcnt(0)
    ds_read_b64_tr_b16 v[44:45], v121
    ds_read_b64_tr_b16 v[46:47], v121 offset:2048
    ds_read_b64_tr_b16 v[48:49], v122
    ds_read_b64_tr_b16 v[50:51], v122 offset:2048
    ds_read_b64_tr_b16 v[52:53], v123
    ds_read_b64_tr_b16 v[54:55], v123 offset:2048
    ds_read_b64_tr_b16 v[56:57], v124
    ds_read_b64_tr_b16 v[58:59], v124 offset:2048
    s_waitcnt lgkmcnt(0)
    v_mfma_f32_16x16x32_bf16 v[192:195], v[44:47], v[108:111], v[192:195]
    v_mfma_f32_16x16x32_bf16 v[200:203], v[44:47], v[112:115], v[200:203]
    v_mfma_f32_16x16x32_bf16 v[196:199], v[48:51], v[108:111], v[196:199]
    v_mfma_f32_16x16x32_bf16 v[204:207], v[48:51], v[112:115], v[204:207]
    v_mfma_f32_16x16x32_bf16 v[208:211], v[52:55], v[108:111], v[208:211]
    v_mfma_f32_16x16x32_bf16 v[216:219], v[52:55], v[112:115], v[216:219]
    v_mfma_f32_16x16x32_bf16 v[212:215], v[56:59], v[108:111], v[212:215]
    v_mfma_f32_16x16x32_bf16 v[220:223], v[56:59], v[112:115], v[220:223]
    s_nop 7
    buffer_load_dwordx4 v117, s[44:47], s14 offen offset:0 lds
    buffer_load_dwordx4 v118, s[44:47], s14 offen offset:1024 lds
    buffer_load_dwordx4 v119, s[44:47], s14 offen offset:2048 lds
    buffer_load_dwordx4 v120, s[44:47], s14 offen offset:3072 lds
    s_add_u32 s14, s14, 128
    s_waitcnt vmcnt(0)
    ds_read_b64_tr_b16 v[44:45], v121
    ds_read_b64_tr_b16 v[46:47], v121 offset:2048
    ds_read_b64_tr_b16 v[48:49], v122
    ds_read_b64_tr_b16 v[50:51], v122 offset:2048
    ds_read_b64_tr_b16 v[52:53], v123
    ds_read_b64_tr_b16 v[54:55], v123 offset:2048
    ds_read_b64_tr_b16 v[56:57], v124
    ds_read_b64_tr_b16 v[58:59], v124 offset:2048
    s_waitcnt lgkmcnt(0)
    v_mfma_f32_16x16x32_bf16 v[224:227], v[44:47], v[108:111], v[224:227]
    v_mfma_f32_16x16x32_bf16 v[232:235], v[44:47], v[112:115], v[232:235]
    v_mfma_f32_16x16x32_bf16 v[228:231], v[48:51], v[108:111], v[228:231]
    v_mfma_f32_16x16x32_bf16 v[236:239], v[48:51], v[112:115], v[236:239]
    v_mfma_f32_16x16x32_bf16 v[240:243], v[52:55], v[108:111], v[240:243]
    v_mfma_f32_16x16x32_bf16 v[248:251], v[52:55], v[112:115], v[248:251]
    v_mfma_f32_16x16x32_bf16 v[244:247], v[56:59], v[108:111], v[244:247]
    v_mfma_f32_16x16x32_bf16 v[252:255], v[56:59], v[112:115], v[252:255]
    s_nop 7
    s_cmp_lt_u32 s13, 262144
    s_cbranch_scc1 L_exact_p2
    v_mov_b32 v104, v100
    s_nop 1
    v_permlane32_swap_b32 v100, v104
    v_add_f32 v100, v100, v104
    v_mov_b32 v104, v100
    s_nop 1
    v_permlane16_swap_b32 v100, v104
    v_add_f32 v100, v100, v104
    v_rcp_f32 v126, v100
    v_mov_b32 v104, v101
    s_nop 1
    v_permlane32_swap_b32 v101, v104
    v_add_f32 v101, v101, v104
    v_mov_b32 v104, v101
    s_nop 1
    v_permlane16_swap_b32 v101, v104
    v_add_f32 v101, v101, v104
    v_rcp_f32 v127, v101
    s_nop 15
    v_add_u32 v108, s67, v8
    v_add_u32 v109, s67, v9
    v_add_u32 v110, s67, v10
    v_add_u32 v111, s67, v11
    v_add_u32 v112, s67, v12
    v_add_u32 v113, s67, v13
    v_add_u32 v114, s67, v14
    v_add_u32 v115, s67, v15
    v_add_u32 v116, s67, v16
    v_add_u32 v117, s67, v17
    v_add_u32 v118, s67, v18
    v_add_u32 v119, s67, v19
    s_mov_b32 m0, s12
    s_nop 15
    s_branch L_exact_ret
L_pad:
    s_endpgm
.if (L_pad - L_main) < 65536
.fill ((65536 - (L_pad - L_main)) / 4) + 16, 4, 0xbf810000
.endif
.section .rodata,"a"
.p2align 6
.amdhsa_kernel recurrent_scan__sliding_block_cached__dense_activation_relu__prompt_kernel
  .amdhsa_next_free_vgpr 512
  .amdhsa_next_free_sgpr 102
  .amdhsa_accum_offset 256
  .amdhsa_group_segment_fixed_size 0
  .amdhsa_kernarg_size 88
  .amdhsa_user_sgpr_count 2
  .amdhsa_user_sgpr_kernarg_segment_ptr 1
  .amdhsa_system_sgpr_workgroup_id_x 1
.end_amdhsa_kernel
```
